```python
import torch

def _softmax(x, axis=-1):
    return torch.softmax(x, dim=axis)
def _gelu(x):
    return torch.nn.functional.gelu(x, approximate="tanh")
def _silu(x):
    return torch.nn.functional.silu(x)
def _sigmoid(x):
    return torch.sigmoid(x)
def _layernorm(x, axis=-1, eps=1e-5):
    m = x.mean(dim=axis, keepdim=True)
    v = x.var(dim=axis, keepdim=True, unbiased=False)
    return (x - m) / torch.sqrt(v + eps)
def _scatter_add(tgt, idx, src, axis=0):
    return tgt.clone().index_add_(axis, idx, src)
def _segment_sum(src, seg, n):
    out = torch.zeros((n,) + src.shape[1:], dtype=src.dtype)
    return out.index_add_(0, seg, src)
def _pad(x, pw):
    flat = tuple(v for pair in reversed(pw) for v in pair)
    return torch.nn.functional.pad(x, flat)

kernel_name = 'recurrent_scan__linear_kernel_hedgehog__glu_gated_swiglu__prompt'

def setup_inputs():

    _w = (lambda a: (lambda t: t.to(torch.bfloat16) if t.is_floating_point() else t)(torch.as_tensor(a)))
    def _A_setup():
        B, S, D, H = 1, 2048, 512, 32
        Dh = D // H
        return {
            "x": _w((lambda *s: torch.randn(*s, dtype=torch.bfloat16) * 0.05)(B, S, D)),
            "wqkv": _w((lambda *s: torch.randn(*s, dtype=torch.bfloat16) * 0.8)(D, 3 * D)),
            "w_phi": _w((lambda *s: torch.randn(*s, dtype=torch.bfloat16) * 0.8)(H, Dh, Dh) * (Dh ** -0.5)),
            "wo": _w((lambda *s: torch.randn(*s, dtype=torch.bfloat16) * 0.8)(D, D)),
        }
    _A_in = _A_setup()

    def _B_setup():
        B, S, D, F = 1, 2048, 512, 1376
        return {
            "x": _w((lambda *s: torch.randn(*s, dtype=torch.bfloat16) * 0.05)(B, S, D)),
            "w1": _w((lambda *s: torch.randn(*s, dtype=torch.bfloat16) * 0.2)(D, F) * (2.0 / D) ** 0.5),
            "w3": _w((lambda *s: torch.randn(*s, dtype=torch.bfloat16) * 0.2)(D, F) * (2.0 / D) ** 0.5),
            "w2": _w((lambda *s: torch.randn(*s, dtype=torch.bfloat16) * 0.2)(F, D) * (2.0 / F) ** 0.5),
        }
    _B_in = _B_setup()

    return {
        "A_x": _A_in["x"],
        "A_wqkv": _A_in["wqkv"],
        "A_w_phi": _A_in["w_phi"],
        "A_wo": _A_in["wo"],
        "B_x": _B_in["x"],
        "B_w1": _B_in["w1"],
        "B_w3": _B_in["w3"],
        "B_w2": _B_in["w2"],
    }

def reference(A_x, A_wqkv, A_w_phi, A_wo, B_x, B_w1, B_w3, B_w2):
    def _A_ref(x, wqkv, w_phi, wo):
        B, S, D = x.shape
        H = 32; Dh = D // H
        qkv = (lambda x, *d: x.permute(*d))((x @ wqkv).reshape(B, S, 3, H, Dh), 2, 0, 3, 1, 4)
        q, k, v = qkv[0], qkv[1], qkv[2]
        pq = torch.einsum("bhsd,hdf->bhsf", q, w_phi)
        pk = torch.einsum("bhsd,hdf->bhsf", k, w_phi)
        phi_q = torch.concatenate([_softmax(pq, axis=-1), _softmax(-pq, axis=-1)], axis=-1)
        phi_k = torch.concatenate([_softmax(pk, axis=-1), _softmax(-pk, axis=-1)], axis=-1)
        kv = torch.einsum("bhsf,bhsd->bhfd", phi_k, v)
        z  = torch.einsum("bhsf->bhf", phi_k)
        num = torch.einsum("bhqf,bhfd->bhqd", phi_q, kv)
        den = torch.einsum("bhqf,bhf->bhq", phi_q, z)[..., None] + 1e-6
        o = num / den
        return (lambda x, *d: x.permute(*d))(o, 0, 2, 1, 3).reshape(B, S, D) @ wo

    def _B_ref(x, w1, w3, w2):
        gate = torch.einsum("bsd,df->bsf", x, w1)
        up = torch.einsum("bsd,df->bsf", x, w3)
        h = _silu(gate) * up
        out = torch.einsum("bsf,fd->bsd", h, w2)
        return out

    x = A_x
    xn = _layernorm(x, axis=-1)
    s = _A_ref(xn, A_wqkv, A_w_phi, A_wo)
    g = _silu(_B_ref(xn, B_w1, B_w3, B_w2))
    return x + s * g
```

```asm
; @launch kernel=k0_kernel grid=(512,1,1) block=(64,1,1) lds=0
; @launch kernel=k1_kernel grid=(256,1,1) block=(512,1,1) lds=160768
; @launch kernel=k3_kernel grid=(256,1,1) block=(512,1,1) lds=135168
.amdgcn_target "amdgcn-amd-amdhsa--gfx950"
.text
.p2align 8
.globl k0_kernel
.type k0_kernel,@function
k0_kernel:
    s_cmp_ge_u32 s2, 512
    s_cbranch_scc1 k0_end
    s_load_dwordx2 s[4:5], s[0:1], 0
    s_load_dwordx2 s[6:7], s[0:1], 80
    v_and_b32 v1, 15, v0
    v_lshrrev_b32 v2, 4, v0
    s_lshl_b32 s3, s2, 12
    v_lshlrev_b32 v3, 10, v2
    v_lshl_add_u32 v3, v1, 4, v3
    v_add_u32 v3, s3, v3
    s_waitcnt lgkmcnt(0)
    s_mov_b32 s8, s4
    s_and_b32 s9, s5, 0xffff
    s_mov_b32 s10, 2097152
    s_mov_b32 s11, 0x00020000
    s_mov_b32 s12, s6
    s_and_b32 s13, s7, 0xffff
    s_mov_b32 s14, 16777216
    s_mov_b32 s15, 0x00020000
    buffer_load_dwordx4 v[4:7], v3, s[8:11], 0 offen offset:0
    buffer_load_dwordx4 v[8:11], v3, s[8:11], 0 offen offset:256
    buffer_load_dwordx4 v[12:15], v3, s[8:11], 0 offen offset:512
    buffer_load_dwordx4 v[16:19], v3, s[8:11], 0 offen offset:768
    s_load_dwordx2 s[20:21], s[0:1], 8
    s_load_dwordx2 s[22:23], s[0:1], 24
    s_load_dwordx4 s[24:27], s[0:1], 40
    s_load_dwordx2 s[28:29], s[0:1], 56
    s_and_b32 s30, s2, 7
    s_lshr_b32 s31, s2, 3
    v_lshrrev_b32 v70, 3, v0
    s_lshl_b32 s32, s31, 3
    v_add_u32 v70, s32, v70
    v_and_b32 v71, 7, v0
    s_waitcnt lgkmcnt(0)
    s_mov_b32 s36, s20
    s_and_b32 s37, s21, 0xffff
    s_mov_b32 s38, 1572864
    s_mov_b32 s39, 0x00020000
    s_mov_b32 s40, s24
    s_and_b32 s41, s25, 0xffff
    s_mov_b32 s42, 1409024
    s_mov_b32 s43, 0x00020000
    s_mov_b32 s44, s26
    s_and_b32 s45, s27, 0xffff
    s_mov_b32 s46, 1409024
    s_mov_b32 s47, 0x00020000
    v_lshrrev_b32 v72, 1, v71
    v_cmp_eq_u32 vcc, 3, v72
    s_nop 1
    v_cndmask_b32 v72, v72, 0, vcc
    v_lshlrev_b32 v72, 10, v72
    v_and_b32 v73, 1, v71
    v_lshl_add_u32 v72, v73, 6, v72
    v_mul_u32_u24 v73, 3072, v70
    v_add_u32 v72, v72, v73
    s_lshl_b32 s33, s30, 7
    buffer_load_dword v128, v72, s[36:39], s33 offen
    v_mul_u32_u24 v72, 48, v71
    v_mul_u32_u24 v73, 2752, v70
    v_add_u32 v72, v72, v73
    s_mul_i32 s33, s30, 352
    buffer_load_dword v129, v72, s[40:43], s33 offen
    buffer_load_dword v130, v72, s[44:47], s33 offen
    s_cmp_ge_u32 s2, 68
    s_cbranch_scc1 k0_nz
    v_mov_b32 v20, 0
    v_mov_b32 v21, 0
    v_mov_b32 v22, 0
    v_mov_b32 v23, 0
    s_lshl_b32 s16, s2, 10
    s_add_u32 s16, s16, 12582912
    v_lshlrev_b32 v24, 4, v0
    v_add_u32 v24, s16, v24
    buffer_store_dwordx4 v[20:23], v24, s[12:15], 0 offen sc1
k0_nz:
    s_waitcnt vmcnt(3)
    v_lshlrev_b32 v32, 16, v4
    v_and_b32 v33, 0xffff0000, v4
    v_lshlrev_b32 v34, 16, v5
    v_and_b32 v35, 0xffff0000, v5
    v_lshlrev_b32 v36, 16, v6
    v_and_b32 v37, 0xffff0000, v6
    v_lshlrev_b32 v38, 16, v7
    v_and_b32 v39, 0xffff0000, v7
    v_lshlrev_b32 v40, 16, v8
    v_and_b32 v41, 0xffff0000, v8
    v_lshlrev_b32 v42, 16, v9
    v_and_b32 v43, 0xffff0000, v9
    v_lshlrev_b32 v44, 16, v10
    v_and_b32 v45, 0xffff0000, v10
    v_lshlrev_b32 v46, 16, v11
    v_and_b32 v47, 0xffff0000, v11
    v_lshlrev_b32 v48, 16, v12
    v_and_b32 v49, 0xffff0000, v12
    v_lshlrev_b32 v50, 16, v13
    v_and_b32 v51, 0xffff0000, v13
    v_lshlrev_b32 v52, 16, v14
    v_and_b32 v53, 0xffff0000, v14
    v_lshlrev_b32 v54, 16, v15
    v_and_b32 v55, 0xffff0000, v15
    v_lshlrev_b32 v56, 16, v16
    v_and_b32 v57, 0xffff0000, v16
    v_lshlrev_b32 v58, 16, v17
    v_and_b32 v59, 0xffff0000, v17
    v_lshlrev_b32 v60, 16, v18
    v_and_b32 v61, 0xffff0000, v18
    v_lshlrev_b32 v62, 16, v19
    v_and_b32 v63, 0xffff0000, v19
    v_add_f32 v64, v32, v33
    v_add_f32 v65, v34, v35
    v_add_f32 v66, v36, v37
    v_add_f32 v67, v38, v39
    v_add_f32 v68, v40, v41
    v_add_f32 v69, v42, v43
    v_add_f32 v70, v44, v45
    v_add_f32 v71, v46, v47
    v_add_f32 v72, v48, v49
    v_add_f32 v73, v50, v51
    v_add_f32 v74, v52, v53
    v_add_f32 v75, v54, v55
    v_add_f32 v76, v56, v57
    v_add_f32 v77, v58, v59
    v_add_f32 v78, v60, v61
    v_add_f32 v79, v62, v63
    v_add_f32 v64, v64, v72
    v_add_f32 v65, v65, v73
    v_add_f32 v66, v66, v74
    v_add_f32 v67, v67, v75
    v_add_f32 v68, v68, v76
    v_add_f32 v69, v69, v77
    v_add_f32 v70, v70, v78
    v_add_f32 v71, v71, v79
    v_add_f32 v64, v64, v68
    v_add_f32 v65, v65, v69
    v_add_f32 v66, v66, v70
    v_add_f32 v67, v67, v71
    v_add_f32 v64, v64, v66
    v_add_f32 v65, v65, v67
    v_add_f32 v64, v64, v65
    s_nop 1
    v_add_f32_dpp v64, v64, v64 row_ror:8 row_mask:0xf bank_mask:0xf
    s_nop 1
    v_add_f32_dpp v64, v64, v64 row_ror:4 row_mask:0xf bank_mask:0xf
    s_nop 1
    v_add_f32_dpp v64, v64, v64 row_ror:2 row_mask:0xf bank_mask:0xf
    s_nop 1
    v_add_f32_dpp v64, v64, v64 row_ror:1 row_mask:0xf bank_mask:0xf
    v_mul_f32 v64, 0x3b000000, v64
    v_cvt_pk_bf16_f32 v65, v64, v64
    v_lshlrev_b32 v65, 16, v65
    v_sub_f32 v80, v32, v64
    v_sub_f32 v81, v33, v64
    v_sub_f32 v82, v34, v64
    v_sub_f32 v83, v35, v64
    v_sub_f32 v84, v36, v64
    v_sub_f32 v85, v37, v64
    v_sub_f32 v86, v38, v64
    v_sub_f32 v87, v39, v64
    v_sub_f32 v88, v40, v64
    v_sub_f32 v89, v41, v64
    v_sub_f32 v90, v42, v64
    v_sub_f32 v91, v43, v64
    v_sub_f32 v92, v44, v64
    v_sub_f32 v93, v45, v64
    v_sub_f32 v94, v46, v64
    v_sub_f32 v95, v47, v64
    v_sub_f32 v96, v48, v64
    v_sub_f32 v97, v49, v64
    v_sub_f32 v98, v50, v64
    v_sub_f32 v99, v51, v64
    v_sub_f32 v100, v52, v64
    v_sub_f32 v101, v53, v64
    v_sub_f32 v102, v54, v64
    v_sub_f32 v103, v55, v64
    v_sub_f32 v104, v56, v64
    v_sub_f32 v105, v57, v64
    v_sub_f32 v106, v58, v64
    v_sub_f32 v107, v59, v64
    v_sub_f32 v108, v60, v64
    v_sub_f32 v109, v61, v64
    v_sub_f32 v110, v62, v64
    v_sub_f32 v111, v63, v64
    v_mul_f32 v112, v80, v80
    v_mul_f32 v113, v82, v82
    v_mul_f32 v114, v84, v84
    v_mul_f32 v115, v86, v86
    v_mul_f32 v116, v88, v88
    v_mul_f32 v117, v90, v90
    v_mul_f32 v118, v92, v92
    v_mul_f32 v119, v94, v94
    v_mul_f32 v120, v96, v96
    v_mul_f32 v121, v98, v98
    v_mul_f32 v122, v100, v100
    v_mul_f32 v123, v102, v102
    v_mul_f32 v124, v104, v104
    v_mul_f32 v125, v106, v106
    v_mul_f32 v126, v108, v108
    v_mul_f32 v127, v110, v110
    v_fmac_f32 v112, v81, v81
    v_fmac_f32 v113, v83, v83
    v_fmac_f32 v114, v85, v85
    v_fmac_f32 v115, v87, v87
    v_fmac_f32 v116, v89, v89
    v_fmac_f32 v117, v91, v91
    v_fmac_f32 v118, v93, v93
    v_fmac_f32 v119, v95, v95
    v_fmac_f32 v120, v97, v97
    v_fmac_f32 v121, v99, v99
    v_fmac_f32 v122, v101, v101
    v_fmac_f32 v123, v103, v103
    v_fmac_f32 v124, v105, v105
    v_fmac_f32 v125, v107, v107
    v_fmac_f32 v126, v109, v109
    v_fmac_f32 v127, v111, v111
    v_add_f32 v112, v112, v120
    v_add_f32 v113, v113, v121
    v_add_f32 v114, v114, v122
    v_add_f32 v115, v115, v123
    v_add_f32 v116, v116, v124
    v_add_f32 v117, v117, v125
    v_add_f32 v118, v118, v126
    v_add_f32 v119, v119, v127
    v_add_f32 v112, v112, v116
    v_add_f32 v113, v113, v117
    v_add_f32 v114, v114, v118
    v_add_f32 v115, v115, v119
    v_add_f32 v112, v112, v114
    v_add_f32 v113, v113, v115
    v_add_f32 v112, v112, v113
    s_nop 1
    v_add_f32_dpp v112, v112, v112 row_ror:8 row_mask:0xf bank_mask:0xf
    s_nop 1
    v_add_f32_dpp v112, v112, v112 row_ror:4 row_mask:0xf bank_mask:0xf
    s_nop 1
    v_add_f32_dpp v112, v112, v112 row_ror:2 row_mask:0xf bank_mask:0xf
    s_nop 1
    v_add_f32_dpp v112, v112, v112 row_ror:1 row_mask:0xf bank_mask:0xf
    v_mul_f32 v66, 0x3b000000, v112
    v_cvt_pk_bf16_f32 v66, v66, v66
    v_lshlrev_b32 v66, 16, v66
    v_add_f32 v66, 0x3727c5ac, v66
    v_cvt_pk_bf16_f32 v66, v66, v66
    v_lshlrev_b32 v66, 16, v66
    v_sqrt_f32 v66, v66
    s_nop 0
    v_cvt_pk_bf16_f32 v66, v66, v66
    v_lshlrev_b32 v66, 16, v66
    v_rcp_f32 v66, v66
    s_nop 0
    v_sub_f32 v80, v32, v65
    v_sub_f32 v81, v33, v65
    v_sub_f32 v82, v34, v65
    v_sub_f32 v83, v35, v65
    v_sub_f32 v84, v36, v65
    v_sub_f32 v85, v37, v65
    v_sub_f32 v86, v38, v65
    v_sub_f32 v87, v39, v65
    v_sub_f32 v88, v40, v65
    v_sub_f32 v89, v41, v65
    v_sub_f32 v90, v42, v65
    v_sub_f32 v91, v43, v65
    v_sub_f32 v92, v44, v65
    v_sub_f32 v93, v45, v65
    v_sub_f32 v94, v46, v65
    v_sub_f32 v95, v47, v65
    v_sub_f32 v96, v48, v65
    v_sub_f32 v97, v49, v65
    v_sub_f32 v98, v50, v65
    v_sub_f32 v99, v51, v65
    v_sub_f32 v100, v52, v65
    v_sub_f32 v101, v53, v65
    v_sub_f32 v102, v54, v65
    v_sub_f32 v103, v55, v65
    v_sub_f32 v104, v56, v65
    v_sub_f32 v105, v57, v65
    v_sub_f32 v106, v58, v65
    v_sub_f32 v107, v59, v65
    v_sub_f32 v108, v60, v65
    v_sub_f32 v109, v61, v65
    v_sub_f32 v110, v62, v65
    v_sub_f32 v111, v63, v65
    v_cvt_pk_bf16_f32 v112, v80, v81
    v_cvt_pk_bf16_f32 v113, v82, v83
    v_cvt_pk_bf16_f32 v114, v84, v85
    v_cvt_pk_bf16_f32 v115, v86, v87
    v_cvt_pk_bf16_f32 v116, v88, v89
    v_cvt_pk_bf16_f32 v117, v90, v91
    v_cvt_pk_bf16_f32 v118, v92, v93
    v_cvt_pk_bf16_f32 v119, v94, v95
    v_cvt_pk_bf16_f32 v120, v96, v97
    v_cvt_pk_bf16_f32 v121, v98, v99
    v_cvt_pk_bf16_f32 v122, v100, v101
    v_cvt_pk_bf16_f32 v123, v102, v103
    v_cvt_pk_bf16_f32 v124, v104, v105
    v_cvt_pk_bf16_f32 v125, v106, v107
    v_cvt_pk_bf16_f32 v126, v108, v109
    v_cvt_pk_bf16_f32 v127, v110, v111
    v_lshlrev_b32 v80, 16, v112
    v_and_b32 v81, 0xffff0000, v112
    v_lshlrev_b32 v82, 16, v113
    v_and_b32 v83, 0xffff0000, v113
    v_lshlrev_b32 v84, 16, v114
    v_and_b32 v85, 0xffff0000, v114
    v_lshlrev_b32 v86, 16, v115
    v_and_b32 v87, 0xffff0000, v115
    v_lshlrev_b32 v88, 16, v116
    v_and_b32 v89, 0xffff0000, v116
    v_lshlrev_b32 v90, 16, v117
    v_and_b32 v91, 0xffff0000, v117
    v_lshlrev_b32 v92, 16, v118
    v_and_b32 v93, 0xffff0000, v118
    v_lshlrev_b32 v94, 16, v119
    v_and_b32 v95, 0xffff0000, v119
    v_lshlrev_b32 v96, 16, v120
    v_and_b32 v97, 0xffff0000, v120
    v_lshlrev_b32 v98, 16, v121
    v_and_b32 v99, 0xffff0000, v121
    v_lshlrev_b32 v100, 16, v122
    v_and_b32 v101, 0xffff0000, v122
    v_lshlrev_b32 v102, 16, v123
    v_and_b32 v103, 0xffff0000, v123
    v_lshlrev_b32 v104, 16, v124
    v_and_b32 v105, 0xffff0000, v124
    v_lshlrev_b32 v106, 16, v125
    v_and_b32 v107, 0xffff0000, v125
    v_lshlrev_b32 v108, 16, v126
    v_and_b32 v109, 0xffff0000, v126
    v_lshlrev_b32 v110, 16, v127
    v_and_b32 v111, 0xffff0000, v127
    v_mul_f32 v80, v80, v66
    v_mul_f32 v81, v81, v66
    v_mul_f32 v82, v82, v66
    v_mul_f32 v83, v83, v66
    v_mul_f32 v84, v84, v66
    v_mul_f32 v85, v85, v66
    v_mul_f32 v86, v86, v66
    v_mul_f32 v87, v87, v66
    v_mul_f32 v88, v88, v66
    v_mul_f32 v89, v89, v66
    v_mul_f32 v90, v90, v66
    v_mul_f32 v91, v91, v66
    v_mul_f32 v92, v92, v66
    v_mul_f32 v93, v93, v66
    v_mul_f32 v94, v94, v66
    v_mul_f32 v95, v95, v66
    v_mul_f32 v96, v96, v66
    v_mul_f32 v97, v97, v66
    v_mul_f32 v98, v98, v66
    v_mul_f32 v99, v99, v66
    v_mul_f32 v100, v100, v66
    v_mul_f32 v101, v101, v66
    v_mul_f32 v102, v102, v66
    v_mul_f32 v103, v103, v66
    v_mul_f32 v104, v104, v66
    v_mul_f32 v105, v105, v66
    v_mul_f32 v106, v106, v66
    v_mul_f32 v107, v107, v66
    v_mul_f32 v108, v108, v66
    v_mul_f32 v109, v109, v66
    v_mul_f32 v110, v110, v66
    v_mul_f32 v111, v111, v66
    v_cvt_pk_bf16_f32 v4, v80, v81
    v_cvt_pk_bf16_f32 v5, v82, v83
    v_cvt_pk_bf16_f32 v6, v84, v85
    v_cvt_pk_bf16_f32 v7, v86, v87
    v_cvt_pk_bf16_f32 v8, v88, v89
    v_cvt_pk_bf16_f32 v9, v90, v91
    v_cvt_pk_bf16_f32 v10, v92, v93
    v_cvt_pk_bf16_f32 v11, v94, v95
    v_cvt_pk_bf16_f32 v12, v96, v97
    v_cvt_pk_bf16_f32 v13, v98, v99
    v_cvt_pk_bf16_f32 v14, v100, v101
    v_cvt_pk_bf16_f32 v15, v102, v103
    v_cvt_pk_bf16_f32 v16, v104, v105
    v_cvt_pk_bf16_f32 v17, v106, v107
    v_cvt_pk_bf16_f32 v18, v108, v109
    v_cvt_pk_bf16_f32 v19, v110, v111
    s_lshr_b32 s16, s2, 2
    s_lshl_b32 s16, s16, 14
    s_and_b32 s17, s2, 3
    s_lshl_b32 s17, s17, 6
    s_add_u32 s16, s16, s17
    v_lshrrev_b32 v20, 2, v1
    v_lshlrev_b32 v20, 10, v20
    v_and_b32 v21, 3, v1
    v_lshl_add_u32 v20, v21, 8, v20
    v_lshl_add_u32 v20, v2, 4, v20
    v_add_u32 v20, s16, v20
    s_movk_i32 s17, 0
    buffer_store_dwordx4 v[4:7], v20, s[12:15], s17 offen sc1
    s_movk_i32 s17, 4096
    buffer_store_dwordx4 v[8:11], v20, s[12:15], s17 offen sc1
    s_movk_i32 s17, 8192
    buffer_store_dwordx4 v[12:15], v20, s[12:15], s17 offen sc1
    s_movk_i32 s17, 12288
    buffer_store_dwordx4 v[16:19], v20, s[12:15], s17 offen sc1
k0_end:
    s_endpgm
.p2align 8
.globl k1_kernel
.type k1_kernel,@function
k1_kernel:
    s_cmp_ge_u32 s2, 256
    s_cbranch_scc1 k1_end
    s_load_dwordx4 s[4:7], s[0:1], 8
    s_load_dwordx4 s[8:11], s[0:1], 40
    s_load_dwordx2 s[12:13], s[0:1], 80
    s_load_dwordx2 s[96:97], s[0:1], 24
    s_load_dwordx2 s[98:99], s[0:1], 56
    v_lshrrev_b32 v1, 6, v0
    v_and_b32 v2, 63, v0
    s_nop 0
    v_readfirstlane_b32 s14, v1
    s_and_b32 s66, s2, 7
    s_lshr_b32 s15, s2, 3
    s_and_b32 s67, s15, 1
    s_lshr_b32 s68, s15, 1
    s_and_b32 s69, s14, 3
    s_lshr_b32 s70, s14, 2
    s_mov_b32 s62, 0x3fb8aa3b
    s_mov_b32 s63, 0x3fb8aa3b
    s_mov_b32 s64, 1.0
    s_mov_b32 s65, 1.0
    s_lshl_b32 s71, s68, 7
    s_lshl_b32 s72, s69, 5
    s_add_u32 s73, s71, s72
    v_lshlrev_b32 v3, 4, v2
    s_waitcnt lgkmcnt(0)
    s_mov_b32 s24, s12
    s_and_b32 s25, s13, 0xffff
    s_mov_b32 s26, 16777216
    s_mov_b32 s27, 0x00020000
    s_mov_b32 s16, s4
    s_and_b32 s17, s5, 0xffff
    s_mov_b32 s18, 1572864
    s_mov_b32 s19, 0x00020000
    s_mov_b32 s28, s8
    s_and_b32 s29, s9, 0xffff
    s_mov_b32 s30, 1409024
    s_mov_b32 s31, 0x00020000
    s_mov_b32 s32, s10
    s_and_b32 s33, s11, 0xffff
    s_mov_b32 s34, 1409024
    s_mov_b32 s35, 0x00020000
    s_lshl_b32 s71, s69, 11
    s_add_u32 s71, s71, 22528
    v_add_u32 v27, s71, v3
    v_add_u32 v28, 63488, v27
    v_add_u32 v29, 126976, v27
    s_cmp_eq_u32 s67, 1
    s_cbranch_scc1 k1_gu
    s_mov_b32 s20, s6
    s_and_b32 s21, s7, 0xffff
    s_mov_b32 s22, 16384
    s_mov_b32 s23, 0x00020000
    s_cmp_ge_u32 s14, 2
    s_cbranch_scc1 k1_q_nophi
    s_lshl_b32 s71, s66, 11
    s_lshl_b32 s72, s14, 10
    s_add_u32 s71, s71, s72
    s_add_u32 m0, s72, 158720
    s_nop 0
    buffer_load_dwordx4 v3, s[20:23], s71 offen lds
k1_q_nophi:
    s_mul_i32 s71, s14, 3
    s_add_u32 s71, s71, 0
    s_cmp_lt_u32 s71, 13
    s_cbranch_scc0 k1_qa0
    s_mov_b32 s36, s16
    s_mov_b32 s37, s17
    s_mov_b32 s38, s18
    s_mov_b32 s39, s19
    s_lshl_b32 s52, s71, 10
    s_mov_b32 s56, 98304
    v_add_u32 v4, s52, v3
    v_mul_u32_u24 v5, 40330, v4
    v_lshrrev_b32 v5, 24, v5
    v_mul_u32_u24 v6, 416, v5
    v_sub_u32 v6, v4, v6
    v_bfe_u32 v7, v5, 2, 2
    v_lshlrev_b32 v7, 3, v7
    v_lshrrev_b32 v8, 4, v5
    v_lshl_add_u32 v7, v8, 2, v7
    v_and_b32 v8, 3, v5
    v_add_u32 v7, v7, v8
    v_mul_u32_u24 v7, 3072, v7
    v_lshrrev_b32 v8, 7, v6
    v_cmp_eq_u32 vcc, 3, v8
    s_nop 1
    v_cndmask_b32 v8, v8, 0, vcc
    v_lshl_add_u32 v7, v8, 10, v7
    v_and_b32 v6, 127, v6
    v_add_u32 v7, v7, v6
    s_lshl_b32 s72, s66, 7
    v_add_u32 v20, s72, v7
    s_branch k1_qb0
k1_qa0:
    s_mov_b32 s36, s24
    s_mov_b32 s37, s25
    s_mov_b32 s38, s26
    s_mov_b32 s39, s27
    s_sub_u32 s71, s71, 13
    s_lshl_b32 s52, s71, 10
    s_add_u32 s52, s52, 22528
    s_movk_i32 s56, 1024
    s_lshl_b32 s72, s68, 3
    s_add_u32 s72, s72, s71
    s_lshl_b32 s72, s72, 14
    s_cmp_lt_u32 s71, 8
    s_cselect_b32 s72, s72, 0x40000000
    v_add_u32 v20, s72, v3
    s_cselect_b32 s52, s52, 30720
    s_cselect_b32 s56, s56, 0
k1_qb0:
    s_add_u32 m0, s52, 0
    s_mul_i32 s60, s56, 0
    buffer_load_dwordx4 v20, s[36:39], s60 offen lds
    s_mul_i32 s71, s14, 3
    s_add_u32 s71, s71, 1
    s_cmp_lt_u32 s71, 13
    s_cbranch_scc0 k1_qa1
    s_mov_b32 s40, s16
    s_mov_b32 s41, s17
    s_mov_b32 s42, s18
    s_mov_b32 s43, s19
    s_lshl_b32 s53, s71, 10
    s_mov_b32 s57, 98304
    v_add_u32 v4, s53, v3
    v_mul_u32_u24 v5, 40330, v4
    v_lshrrev_b32 v5, 24, v5
    v_mul_u32_u24 v6, 416, v5
    v_sub_u32 v6, v4, v6
    v_bfe_u32 v7, v5, 2, 2
    v_lshlrev_b32 v7, 3, v7
    v_lshrrev_b32 v8, 4, v5
    v_lshl_add_u32 v7, v8, 2, v7
    v_and_b32 v8, 3, v5
    v_add_u32 v7, v7, v8
    v_mul_u32_u24 v7, 3072, v7
    v_lshrrev_b32 v8, 7, v6
    v_cmp_eq_u32 vcc, 3, v8
    s_nop 1
    v_cndmask_b32 v8, v8, 0, vcc
    v_lshl_add_u32 v7, v8, 10, v7
    v_and_b32 v6, 127, v6
    v_add_u32 v7, v7, v6
    s_lshl_b32 s72, s66, 7
    v_add_u32 v21, s72, v7
    s_branch k1_qb1
k1_qa1:
    s_mov_b32 s40, s24
    s_mov_b32 s41, s25
    s_mov_b32 s42, s26
    s_mov_b32 s43, s27
    s_sub_u32 s71, s71, 13
    s_lshl_b32 s53, s71, 10
    s_add_u32 s53, s53, 22528
    s_movk_i32 s57, 1024
    s_lshl_b32 s72, s68, 3
    s_add_u32 s72, s72, s71
    s_lshl_b32 s72, s72, 14
    s_cmp_lt_u32 s71, 8
    s_cselect_b32 s72, s72, 0x40000000
    v_add_u32 v21, s72, v3
    s_cselect_b32 s53, s53, 30720
    s_cselect_b32 s57, s57, 0
k1_qb1:
    s_add_u32 m0, s53, 0
    s_mul_i32 s60, s57, 0
    buffer_load_dwordx4 v21, s[40:43], s60 offen lds
    s_mul_i32 s71, s14, 3
    s_add_u32 s71, s71, 2
    s_cmp_lt_u32 s71, 13
    s_cbranch_scc0 k1_qa2
    s_mov_b32 s44, s16
    s_mov_b32 s45, s17
    s_mov_b32 s46, s18
    s_mov_b32 s47, s19
    s_lshl_b32 s54, s71, 10
    s_mov_b32 s58, 98304
    v_add_u32 v4, s54, v3
    v_mul_u32_u24 v5, 40330, v4
    v_lshrrev_b32 v5, 24, v5
    v_mul_u32_u24 v6, 416, v5
    v_sub_u32 v6, v4, v6
    v_bfe_u32 v7, v5, 2, 2
    v_lshlrev_b32 v7, 3, v7
    v_lshrrev_b32 v8, 4, v5
    v_lshl_add_u32 v7, v8, 2, v7
    v_and_b32 v8, 3, v5
    v_add_u32 v7, v7, v8
    v_mul_u32_u24 v7, 3072, v7
    v_lshrrev_b32 v8, 7, v6
    v_cmp_eq_u32 vcc, 3, v8
    s_nop 1
    v_cndmask_b32 v8, v8, 0, vcc
    v_lshl_add_u32 v7, v8, 10, v7
    v_and_b32 v6, 127, v6
    v_add_u32 v7, v7, v6
    s_lshl_b32 s72, s66, 7
    v_add_u32 v22, s72, v7
    s_branch k1_qb2
k1_qa2:
    s_mov_b32 s44, s24
    s_mov_b32 s45, s25
    s_mov_b32 s46, s26
    s_mov_b32 s47, s27
    s_sub_u32 s71, s71, 13
    s_lshl_b32 s54, s71, 10
    s_add_u32 s54, s54, 22528
    s_movk_i32 s58, 1024
    s_lshl_b32 s72, s68, 3
    s_add_u32 s72, s72, s71
    s_lshl_b32 s72, s72, 14
    s_cmp_lt_u32 s71, 8
    s_cselect_b32 s72, s72, 0x40000000
    v_add_u32 v22, s72, v3
    s_cselect_b32 s54, s54, 30720
    s_cselect_b32 s58, s58, 0
k1_qb2:
    s_add_u32 m0, s54, 0
    s_mul_i32 s60, s58, 0
    buffer_load_dwordx4 v22, s[44:47], s60 offen lds
    v_lshrrev_b32 v4, 2, v2
    v_mul_u32_u24 v4, 416, v4
    v_and_b32 v5, 3, v2
    v_lshl_add_u32 v4, v5, 3, v4
    s_lshl_b32 s71, s70, 6
    v_add_u32 v16, s71, v4
    v_add_u32 v17, 63488, v16
    v_add_u32 v18, 126976, v16
    s_add_u32 m0, s52, 31744
    s_mul_i32 s60, s56, 1
    buffer_load_dwordx4 v20, s[36:39], s60 offen lds
    s_add_u32 m0, s53, 31744
    s_mul_i32 s60, s57, 1
    buffer_load_dwordx4 v21, s[40:43], s60 offen lds
    s_add_u32 m0, s54, 31744
    s_mul_i32 s60, s58, 1
    buffer_load_dwordx4 v22, s[44:47], s60 offen lds
    s_add_u32 m0, s52, 63488
    s_mul_i32 s60, s56, 2
    buffer_load_dwordx4 v20, s[36:39], s60 offen lds
    s_add_u32 m0, s53, 63488
    s_mul_i32 s60, s57, 2
    buffer_load_dwordx4 v21, s[40:43], s60 offen lds
    s_add_u32 m0, s54, 63488
    s_mul_i32 s60, s58, 2
    buffer_load_dwordx4 v22, s[44:47], s60 offen lds
    s_add_u32 m0, s52, 95232
    s_mul_i32 s60, s56, 3
    buffer_load_dwordx4 v20, s[36:39], s60 offen lds
    s_add_u32 m0, s53, 95232
    s_mul_i32 s60, s57, 3
    buffer_load_dwordx4 v21, s[40:43], s60 offen lds
    s_add_u32 m0, s54, 95232
    s_mul_i32 s60, s58, 3
    buffer_load_dwordx4 v22, s[44:47], s60 offen lds
    s_waitcnt vmcnt(6)
    s_barrier
    ds_read_b128 v[48:51], v27 offset:0
    ds_read_b128 v[52:55], v27 offset:1024
    ds_read_b64_tr_b16 v[32:33], v16 offset:0
    ds_read_b64_tr_b16 v[34:35], v16 offset:6656
    ds_read_b64_tr_b16 v[36:37], v16 offset:32
    ds_read_b64_tr_b16 v[38:39], v16 offset:6688
    ds_read_b64_tr_b16 v[40:41], v16 offset:128
    ds_read_b64_tr_b16 v[42:43], v16 offset:6784
    ds_read_b64_tr_b16 v[44:45], v16 offset:160
    ds_read_b64_tr_b16 v[46:47], v16 offset:6816
    s_waitcnt lgkmcnt(6)
    v_mfma_f32_16x16x32_bf16 v[160:163], v[32:35], v[48:51], 0
    v_mfma_f32_16x16x32_bf16 v[164:167], v[32:35], v[52:55], 0
    s_add_u32 m0, s52, 126976
    s_mul_i32 s60, s56, 4
    buffer_load_dwordx4 v20, s[36:39], s60 offen lds
    ds_read_b64_tr_b16 v[32:33], v16 offset:256
    ds_read_b64_tr_b16 v[34:35], v16 offset:6912
    s_waitcnt lgkmcnt(6)
    v_mfma_f32_16x16x32_bf16 v[168:171], v[36:39], v[48:51], 0
    v_mfma_f32_16x16x32_bf16 v[172:175], v[36:39], v[52:55], 0
    ds_read_b64_tr_b16 v[36:37], v16 offset:288
    ds_read_b64_tr_b16 v[38:39], v16 offset:6944
    s_waitcnt lgkmcnt(6)
    v_mfma_f32_16x16x32_bf16 v[176:179], v[40:43], v[48:51], 0
    v_mfma_f32_16x16x32_bf16 v[180:183], v[40:43], v[52:55], 0
    s_add_u32 m0, s53, 126976
    s_mul_i32 s60, s57, 4
    buffer_load_dwordx4 v21, s[40:43], s60 offen lds
    ds_read_b128 v[56:59], v27 offset:31744
    ds_read_b128 v[60:63], v27 offset:32768
    ds_read_b64_tr_b16 v[40:41], v16 offset:31744
    ds_read_b64_tr_b16 v[42:43], v16 offset:38400
    s_waitcnt lgkmcnt(8)
    v_mfma_f32_16x16x32_bf16 v[184:187], v[44:47], v[48:51], 0
    v_mfma_f32_16x16x32_bf16 v[188:191], v[44:47], v[52:55], 0
    ds_read_b64_tr_b16 v[44:45], v16 offset:31776
    ds_read_b64_tr_b16 v[46:47], v16 offset:38432
    s_waitcnt lgkmcnt(8)
    v_mfma_f32_16x16x32_bf16 v[192:195], v[48:51], v[32:35], 0
    v_mfma_f32_16x16x32_bf16 v[196:199], v[52:55], v[32:35], 0
    s_add_u32 m0, s54, 126976
    s_mul_i32 s60, s58, 4
    buffer_load_dwordx4 v22, s[44:47], s60 offen lds
    ds_read_b64_tr_b16 v[32:33], v16 offset:31872
    ds_read_b64_tr_b16 v[34:35], v16 offset:38528
    s_waitcnt lgkmcnt(8)
    v_mfma_f32_16x16x32_bf16 v[200:203], v[48:51], v[36:39], 0
    v_mfma_f32_16x16x32_bf16 v[204:207], v[52:55], v[36:39], 0
    s_waitcnt vmcnt(6)
    s_barrier
    ds_read_b64_tr_b16 v[36:37], v16 offset:31904
    ds_read_b64_tr_b16 v[38:39], v16 offset:38560
    s_waitcnt lgkmcnt(6)
    v_mfma_f32_16x16x32_bf16 v[160:163], v[40:43], v[56:59], v[160:163]
    v_mfma_f32_16x16x32_bf16 v[164:167], v[40:43], v[60:63], v[164:167]
    s_add_u32 m0, s52, 0
    s_mul_i32 s60, s56, 5
    buffer_load_dwordx4 v20, s[36:39], s60 offen lds
    ds_read_b64_tr_b16 v[40:41], v16 offset:32000
    ds_read_b64_tr_b16 v[42:43], v16 offset:38656
    s_waitcnt lgkmcnt(6)
    v_mfma_f32_16x16x32_bf16 v[168:171], v[44:47], v[56:59], v[168:171]
    v_mfma_f32_16x16x32_bf16 v[172:175], v[44:47], v[60:63], v[172:175]
    ds_read_b64_tr_b16 v[44:45], v16 offset:32032
    ds_read_b64_tr_b16 v[46:47], v16 offset:38688
    s_waitcnt lgkmcnt(6)
    v_mfma_f32_16x16x32_bf16 v[176:179], v[32:35], v[56:59], v[176:179]
    v_mfma_f32_16x16x32_bf16 v[180:183], v[32:35], v[60:63], v[180:183]
    s_add_u32 m0, s53, 0
    s_mul_i32 s60, s57, 5
    buffer_load_dwordx4 v21, s[40:43], s60 offen lds
    ds_read_b128 v[48:51], v28 offset:0
    ds_read_b128 v[52:55], v28 offset:1024
    ds_read_b64_tr_b16 v[32:33], v17 offset:0
    ds_read_b64_tr_b16 v[34:35], v17 offset:6656
    s_waitcnt lgkmcnt(8)
    v_mfma_f32_16x16x32_bf16 v[184:187], v[36:39], v[56:59], v[184:187]
    v_mfma_f32_16x16x32_bf16 v[188:191], v[36:39], v[60:63], v[188:191]
    ds_read_b64_tr_b16 v[36:37], v17 offset:32
    ds_read_b64_tr_b16 v[38:39], v17 offset:6688
    s_waitcnt lgkmcnt(8)
    v_mfma_f32_16x16x32_bf16 v[192:195], v[56:59], v[40:43], v[192:195]
    v_mfma_f32_16x16x32_bf16 v[196:199], v[60:63], v[40:43], v[196:199]
    s_add_u32 m0, s54, 0
    s_mul_i32 s60, s58, 5
    buffer_load_dwordx4 v22, s[44:47], s60 offen lds
    ds_read_b64_tr_b16 v[40:41], v17 offset:128
    ds_read_b64_tr_b16 v[42:43], v17 offset:6784
    s_waitcnt lgkmcnt(8)
    v_mfma_f32_16x16x32_bf16 v[200:203], v[56:59], v[44:47], v[200:203]
    v_mfma_f32_16x16x32_bf16 v[204:207], v[60:63], v[44:47], v[204:207]
    s_waitcnt vmcnt(6)
    s_barrier
    ds_read_b64_tr_b16 v[44:45], v17 offset:160
    ds_read_b64_tr_b16 v[46:47], v17 offset:6816
    s_waitcnt lgkmcnt(6)
    v_mfma_f32_16x16x32_bf16 v[160:163], v[32:35], v[48:51], v[160:163]
    v_mfma_f32_16x16x32_bf16 v[164:167], v[32:35], v[52:55], v[164:167]
    s_add_u32 m0, s52, 31744
    s_mul_i32 s60, s56, 6
    buffer_load_dwordx4 v20, s[36:39], s60 offen lds
    ds_read_b64_tr_b16 v[32:33], v17 offset:256
    ds_read_b64_tr_b16 v[34:35], v17 offset:6912
    s_waitcnt lgkmcnt(6)
    v_mfma_f32_16x16x32_bf16 v[168:171], v[36:39], v[48:51], v[168:171]
    v_mfma_f32_16x16x32_bf16 v[172:175], v[36:39], v[52:55], v[172:175]
    ds_read_b64_tr_b16 v[36:37], v17 offset:288
    ds_read_b64_tr_b16 v[38:39], v17 offset:6944
    s_waitcnt lgkmcnt(6)
    v_mfma_f32_16x16x32_bf16 v[176:179], v[40:43], v[48:51], v[176:179]
    v_mfma_f32_16x16x32_bf16 v[180:183], v[40:43], v[52:55], v[180:183]
    s_add_u32 m0, s53, 31744
    s_mul_i32 s60, s57, 6
    buffer_load_dwordx4 v21, s[40:43], s60 offen lds
    ds_read_b128 v[56:59], v28 offset:31744
    ds_read_b128 v[60:63], v28 offset:32768
    ds_read_b64_tr_b16 v[40:41], v17 offset:31744
    ds_read_b64_tr_b16 v[42:43], v17 offset:38400
    s_waitcnt lgkmcnt(8)
    v_mfma_f32_16x16x32_bf16 v[184:187], v[44:47], v[48:51], v[184:187]
    v_mfma_f32_16x16x32_bf16 v[188:191], v[44:47], v[52:55], v[188:191]
    ds_read_b64_tr_b16 v[44:45], v17 offset:31776
    ds_read_b64_tr_b16 v[46:47], v17 offset:38432
    s_waitcnt lgkmcnt(8)
    v_mfma_f32_16x16x32_bf16 v[192:195], v[48:51], v[32:35], v[192:195]
    v_mfma_f32_16x16x32_bf16 v[196:199], v[52:55], v[32:35], v[196:199]
    s_add_u32 m0, s54, 31744
    s_mul_i32 s60, s58, 6
    buffer_load_dwordx4 v22, s[44:47], s60 offen lds
    ds_read_b64_tr_b16 v[32:33], v17 offset:31872
    ds_read_b64_tr_b16 v[34:35], v17 offset:38528
    s_waitcnt lgkmcnt(8)
    v_mfma_f32_16x16x32_bf16 v[200:203], v[48:51], v[36:39], v[200:203]
    v_mfma_f32_16x16x32_bf16 v[204:207], v[52:55], v[36:39], v[204:207]
    s_waitcnt vmcnt(6)
    s_barrier
    ds_read_b64_tr_b16 v[36:37], v17 offset:31904
    ds_read_b64_tr_b16 v[38:39], v17 offset:38560
    s_waitcnt lgkmcnt(6)
    v_mfma_f32_16x16x32_bf16 v[160:163], v[40:43], v[56:59], v[160:163]
    v_mfma_f32_16x16x32_bf16 v[164:167], v[40:43], v[60:63], v[164:167]
    s_add_u32 m0, s52, 63488
    s_mul_i32 s60, s56, 7
    buffer_load_dwordx4 v20, s[36:39], s60 offen lds
    ds_read_b64_tr_b16 v[40:41], v17 offset:32000
    ds_read_b64_tr_b16 v[42:43], v17 offset:38656
    s_waitcnt lgkmcnt(6)
    v_mfma_f32_16x16x32_bf16 v[168:171], v[44:47], v[56:59], v[168:171]
    v_mfma_f32_16x16x32_bf16 v[172:175], v[44:47], v[60:63], v[172:175]
    ds_read_b64_tr_b16 v[44:45], v17 offset:32032
    ds_read_b64_tr_b16 v[46:47], v17 offset:38688
    s_waitcnt lgkmcnt(6)
    v_mfma_f32_16x16x32_bf16 v[176:179], v[32:35], v[56:59], v[176:179]
    v_mfma_f32_16x16x32_bf16 v[180:183], v[32:35], v[60:63], v[180:183]
    s_add_u32 m0, s53, 63488
    s_mul_i32 s60, s57, 7
    buffer_load_dwordx4 v21, s[40:43], s60 offen lds
    ds_read_b128 v[48:51], v29 offset:0
    ds_read_b128 v[52:55], v29 offset:1024
    ds_read_b64_tr_b16 v[32:33], v18 offset:0
    ds_read_b64_tr_b16 v[34:35], v18 offset:6656
    s_waitcnt lgkmcnt(8)
    v_mfma_f32_16x16x32_bf16 v[184:187], v[36:39], v[56:59], v[184:187]
    v_mfma_f32_16x16x32_bf16 v[188:191], v[36:39], v[60:63], v[188:191]
    ds_read_b64_tr_b16 v[36:37], v18 offset:32
    ds_read_b64_tr_b16 v[38:39], v18 offset:6688
    s_waitcnt lgkmcnt(8)
    v_mfma_f32_16x16x32_bf16 v[192:195], v[56:59], v[40:43], v[192:195]
    v_mfma_f32_16x16x32_bf16 v[196:199], v[60:63], v[40:43], v[196:199]
    s_add_u32 m0, s54, 63488
    s_mul_i32 s60, s58, 7
    buffer_load_dwordx4 v22, s[44:47], s60 offen lds
    ds_read_b64_tr_b16 v[40:41], v18 offset:128
    ds_read_b64_tr_b16 v[42:43], v18 offset:6784
    s_waitcnt lgkmcnt(8)
    v_mfma_f32_16x16x32_bf16 v[200:203], v[56:59], v[44:47], v[200:203]
    v_mfma_f32_16x16x32_bf16 v[204:207], v[60:63], v[44:47], v[204:207]
    s_waitcnt vmcnt(6)
    s_barrier
    ds_read_b64_tr_b16 v[44:45], v18 offset:160
    ds_read_b64_tr_b16 v[46:47], v18 offset:6816
    s_waitcnt lgkmcnt(6)
    v_mfma_f32_16x16x32_bf16 v[160:163], v[32:35], v[48:51], v[160:163]
    v_mfma_f32_16x16x32_bf16 v[164:167], v[32:35], v[52:55], v[164:167]
    s_add_u32 m0, s52, 95232
    s_mul_i32 s60, s56, 8
    buffer_load_dwordx4 v20, s[36:39], s60 offen lds
    ds_read_b64_tr_b16 v[32:33], v18 offset:256
    ds_read_b64_tr_b16 v[34:35], v18 offset:6912
    s_waitcnt lgkmcnt(6)
    v_mfma_f32_16x16x32_bf16 v[168:171], v[36:39], v[48:51], v[168:171]
    v_mfma_f32_16x16x32_bf16 v[172:175], v[36:39], v[52:55], v[172:175]
    ds_read_b64_tr_b16 v[36:37], v18 offset:288
    ds_read_b64_tr_b16 v[38:39], v18 offset:6944
    s_waitcnt lgkmcnt(6)
    v_mfma_f32_16x16x32_bf16 v[176:179], v[40:43], v[48:51], v[176:179]
    v_mfma_f32_16x16x32_bf16 v[180:183], v[40:43], v[52:55], v[180:183]
    s_add_u32 m0, s53, 95232
    s_mul_i32 s60, s57, 8
    buffer_load_dwordx4 v21, s[40:43], s60 offen lds
    ds_read_b128 v[56:59], v27 offset:0
    ds_read_b128 v[60:63], v27 offset:1024
    ds_read_b64_tr_b16 v[40:41], v16 offset:0
    ds_read_b64_tr_b16 v[42:43], v16 offset:6656
    s_waitcnt lgkmcnt(8)
    v_mfma_f32_16x16x32_bf16 v[184:187], v[44:47], v[48:51], v[184:187]
    v_mfma_f32_16x16x32_bf16 v[188:191], v[44:47], v[52:55], v[188:191]
    ds_read_b64_tr_b16 v[44:45], v16 offset:32
    ds_read_b64_tr_b16 v[46:47], v16 offset:6688
    s_waitcnt lgkmcnt(8)
    v_mfma_f32_16x16x32_bf16 v[192:195], v[48:51], v[32:35], v[192:195]
    v_mfma_f32_16x16x32_bf16 v[196:199], v[52:55], v[32:35], v[196:199]
    s_add_u32 m0, s54, 95232
    s_mul_i32 s60, s58, 8
    buffer_load_dwordx4 v22, s[44:47], s60 offen lds
    ds_read_b64_tr_b16 v[32:33], v16 offset:128
    ds_read_b64_tr_b16 v[34:35], v16 offset:6784
    s_waitcnt lgkmcnt(8)
    v_mfma_f32_16x16x32_bf16 v[200:203], v[48:51], v[36:39], v[200:203]
    v_mfma_f32_16x16x32_bf16 v[204:207], v[52:55], v[36:39], v[204:207]
    s_waitcnt vmcnt(6)
    s_barrier
    ds_read_b64_tr_b16 v[36:37], v16 offset:160
    ds_read_b64_tr_b16 v[38:39], v16 offset:6816
    s_waitcnt lgkmcnt(6)
    v_mfma_f32_16x16x32_bf16 v[160:163], v[40:43], v[56:59], v[160:163]
    v_mfma_f32_16x16x32_bf16 v[164:167], v[40:43], v[60:63], v[164:167]
    s_add_u32 m0, s52, 126976
    s_mul_i32 s60, s56, 9
    buffer_load_dwordx4 v20, s[36:39], s60 offen lds
    ds_read_b64_tr_b16 v[40:41], v16 offset:256
    ds_read_b64_tr_b16 v[42:43], v16 offset:6912
    s_waitcnt lgkmcnt(6)
    v_mfma_f32_16x16x32_bf16 v[168:171], v[44:47], v[56:59], v[168:171]
    v_mfma_f32_16x16x32_bf16 v[172:175], v[44:47], v[60:63], v[172:175]
    ds_read_b64_tr_b16 v[44:45], v16 offset:288
    ds_read_b64_tr_b16 v[46:47], v16 offset:6944
    s_waitcnt lgkmcnt(6)
    v_mfma_f32_16x16x32_bf16 v[176:179], v[32:35], v[56:59], v[176:179]
    v_mfma_f32_16x16x32_bf16 v[180:183], v[32:35], v[60:63], v[180:183]
    s_add_u32 m0, s53, 126976
    s_mul_i32 s60, s57, 9
    buffer_load_dwordx4 v21, s[40:43], s60 offen lds
    ds_read_b128 v[48:51], v27 offset:31744
    ds_read_b128 v[52:55], v27 offset:32768
    ds_read_b64_tr_b16 v[32:33], v16 offset:31744
    ds_read_b64_tr_b16 v[34:35], v16 offset:38400
    s_waitcnt lgkmcnt(8)
    v_mfma_f32_16x16x32_bf16 v[184:187], v[36:39], v[56:59], v[184:187]
    v_mfma_f32_16x16x32_bf16 v[188:191], v[36:39], v[60:63], v[188:191]
    ds_read_b64_tr_b16 v[36:37], v16 offset:31776
    ds_read_b64_tr_b16 v[38:39], v16 offset:38432
    s_waitcnt lgkmcnt(8)
    v_mfma_f32_16x16x32_bf16 v[192:195], v[56:59], v[40:43], v[192:195]
    v_mfma_f32_16x16x32_bf16 v[196:199], v[60:63], v[40:43], v[196:199]
    s_add_u32 m0, s54, 126976
    s_mul_i32 s60, s58, 9
    buffer_load_dwordx4 v22, s[44:47], s60 offen lds
    ds_read_b64_tr_b16 v[40:41], v16 offset:31872
    ds_read_b64_tr_b16 v[42:43], v16 offset:38528
    s_waitcnt lgkmcnt(8)
    v_mfma_f32_16x16x32_bf16 v[200:203], v[56:59], v[44:47], v[200:203]
    v_mfma_f32_16x16x32_bf16 v[204:207], v[60:63], v[44:47], v[204:207]
    s_waitcnt vmcnt(6)
    s_barrier
    ds_read_b64_tr_b16 v[44:45], v16 offset:31904
    ds_read_b64_tr_b16 v[46:47], v16 offset:38560
    s_waitcnt lgkmcnt(6)
    v_mfma_f32_16x16x32_bf16 v[160:163], v[32:35], v[48:51], v[160:163]
    v_mfma_f32_16x16x32_bf16 v[164:167], v[32:35], v[52:55], v[164:167]
    s_add_u32 m0, s52, 0
    s_mul_i32 s60, s56, 10
    buffer_load_dwordx4 v20, s[36:39], s60 offen lds
    ds_read_b64_tr_b16 v[32:33], v16 offset:32000
    ds_read_b64_tr_b16 v[34:35], v16 offset:38656
    s_waitcnt lgkmcnt(6)
    v_mfma_f32_16x16x32_bf16 v[168:171], v[36:39], v[48:51], v[168:171]
    v_mfma_f32_16x16x32_bf16 v[172:175], v[36:39], v[52:55], v[172:175]
    ds_read_b64_tr_b16 v[36:37], v16 offset:32032
    ds_read_b64_tr_b16 v[38:39], v16 offset:38688
    s_waitcnt lgkmcnt(6)
    v_mfma_f32_16x16x32_bf16 v[176:179], v[40:43], v[48:51], v[176:179]
    v_mfma_f32_16x16x32_bf16 v[180:183], v[40:43], v[52:55], v[180:183]
    s_add_u32 m0, s53, 0
    s_mul_i32 s60, s57, 10
    buffer_load_dwordx4 v21, s[40:43], s60 offen lds
    ds_read_b128 v[56:59], v28 offset:0
    ds_read_b128 v[60:63], v28 offset:1024
    ds_read_b64_tr_b16 v[40:41], v17 offset:0
    ds_read_b64_tr_b16 v[42:43], v17 offset:6656
    s_waitcnt lgkmcnt(8)
    v_mfma_f32_16x16x32_bf16 v[184:187], v[44:47], v[48:51], v[184:187]
    v_mfma_f32_16x16x32_bf16 v[188:191], v[44:47], v[52:55], v[188:191]
    ds_read_b64_tr_b16 v[44:45], v17 offset:32
    ds_read_b64_tr_b16 v[46:47], v17 offset:6688
    s_waitcnt lgkmcnt(8)
    v_mfma_f32_16x16x32_bf16 v[192:195], v[48:51], v[32:35], v[192:195]
    v_mfma_f32_16x16x32_bf16 v[196:199], v[52:55], v[32:35], v[196:199]
    s_add_u32 m0, s54, 0
    s_mul_i32 s60, s58, 10
    buffer_load_dwordx4 v22, s[44:47], s60 offen lds
    ds_read_b64_tr_b16 v[32:33], v17 offset:128
    ds_read_b64_tr_b16 v[34:35], v17 offset:6784
    s_waitcnt lgkmcnt(8)
    v_mfma_f32_16x16x32_bf16 v[200:203], v[48:51], v[36:39], v[200:203]
    v_mfma_f32_16x16x32_bf16 v[204:207], v[52:55], v[36:39], v[204:207]
    s_waitcnt vmcnt(6)
    s_barrier
    ds_read_b64_tr_b16 v[36:37], v17 offset:160
    ds_read_b64_tr_b16 v[38:39], v17 offset:6816
    s_waitcnt lgkmcnt(6)
    v_mfma_f32_16x16x32_bf16 v[160:163], v[40:43], v[56:59], v[160:163]
    v_mfma_f32_16x16x32_bf16 v[164:167], v[40:43], v[60:63], v[164:167]
    s_add_u32 m0, s52, 31744
    s_mul_i32 s60, s56, 11
    buffer_load_dwordx4 v20, s[36:39], s60 offen lds
    ds_read_b64_tr_b16 v[40:41], v17 offset:256
    ds_read_b64_tr_b16 v[42:43], v17 offset:6912
    s_waitcnt lgkmcnt(6)
    v_mfma_f32_16x16x32_bf16 v[168:171], v[44:47], v[56:59], v[168:171]
    v_mfma_f32_16x16x32_bf16 v[172:175], v[44:47], v[60:63], v[172:175]
    ds_read_b64_tr_b16 v[44:45], v17 offset:288
    ds_read_b64_tr_b16 v[46:47], v17 offset:6944
    s_waitcnt lgkmcnt(6)
    v_mfma_f32_16x16x32_bf16 v[176:179], v[32:35], v[56:59], v[176:179]
    v_mfma_f32_16x16x32_bf16 v[180:183], v[32:35], v[60:63], v[180:183]
    s_add_u32 m0, s53, 31744
    s_mul_i32 s60, s57, 11
    buffer_load_dwordx4 v21, s[40:43], s60 offen lds
    ds_read_b128 v[48:51], v28 offset:31744
    ds_read_b128 v[52:55], v28 offset:32768
    ds_read_b64_tr_b16 v[32:33], v17 offset:31744
    ds_read_b64_tr_b16 v[34:35], v17 offset:38400
    s_waitcnt lgkmcnt(8)
    v_mfma_f32_16x16x32_bf16 v[184:187], v[36:39], v[56:59], v[184:187]
    v_mfma_f32_16x16x32_bf16 v[188:191], v[36:39], v[60:63], v[188:191]
    ds_read_b64_tr_b16 v[36:37], v17 offset:31776
    ds_read_b64_tr_b16 v[38:39], v17 offset:38432
    s_waitcnt lgkmcnt(8)
    v_mfma_f32_16x16x32_bf16 v[192:195], v[56:59], v[40:43], v[192:195]
    v_mfma_f32_16x16x32_bf16 v[196:199], v[60:63], v[40:43], v[196:199]
    s_add_u32 m0, s54, 31744
    s_mul_i32 s60, s58, 11
    buffer_load_dwordx4 v22, s[44:47], s60 offen lds
    ds_read_b64_tr_b16 v[40:41], v17 offset:31872
    ds_read_b64_tr_b16 v[42:43], v17 offset:38528
    s_waitcnt lgkmcnt(8)
    v_mfma_f32_16x16x32_bf16 v[200:203], v[56:59], v[44:47], v[200:203]
    v_mfma_f32_16x16x32_bf16 v[204:207], v[60:63], v[44:47], v[204:207]
    s_waitcnt vmcnt(6)
    s_barrier
    ds_read_b64_tr_b16 v[44:45], v17 offset:31904
    ds_read_b64_tr_b16 v[46:47], v17 offset:38560
    s_waitcnt lgkmcnt(6)
    v_mfma_f32_16x16x32_bf16 v[160:163], v[32:35], v[48:51], v[160:163]
    v_mfma_f32_16x16x32_bf16 v[164:167], v[32:35], v[52:55], v[164:167]
    s_add_u32 m0, s52, 63488
    s_mul_i32 s60, s56, 12
    buffer_load_dwordx4 v20, s[36:39], s60 offen lds
    ds_read_b64_tr_b16 v[32:33], v17 offset:32000
    ds_read_b64_tr_b16 v[34:35], v17 offset:38656
    s_waitcnt lgkmcnt(6)
    v_mfma_f32_16x16x32_bf16 v[168:171], v[36:39], v[48:51], v[168:171]
    v_mfma_f32_16x16x32_bf16 v[172:175], v[36:39], v[52:55], v[172:175]
    ds_read_b64_tr_b16 v[36:37], v17 offset:32032
    ds_read_b64_tr_b16 v[38:39], v17 offset:38688
    s_waitcnt lgkmcnt(6)
    v_mfma_f32_16x16x32_bf16 v[176:179], v[40:43], v[48:51], v[176:179]
    v_mfma_f32_16x16x32_bf16 v[180:183], v[40:43], v[52:55], v[180:183]
    s_add_u32 m0, s53, 63488
    s_mul_i32 s60, s57, 12
    buffer_load_dwordx4 v21, s[40:43], s60 offen lds
    ds_read_b128 v[56:59], v29 offset:0
    ds_read_b128 v[60:63], v29 offset:1024
    ds_read_b64_tr_b16 v[40:41], v18 offset:0
    ds_read_b64_tr_b16 v[42:43], v18 offset:6656
    s_waitcnt lgkmcnt(8)
    v_mfma_f32_16x16x32_bf16 v[184:187], v[44:47], v[48:51], v[184:187]
    v_mfma_f32_16x16x32_bf16 v[188:191], v[44:47], v[52:55], v[188:191]
    ds_read_b64_tr_b16 v[44:45], v18 offset:32
    ds_read_b64_tr_b16 v[46:47], v18 offset:6688
    s_waitcnt lgkmcnt(8)
    v_mfma_f32_16x16x32_bf16 v[192:195], v[48:51], v[32:35], v[192:195]
    v_mfma_f32_16x16x32_bf16 v[196:199], v[52:55], v[32:35], v[196:199]
    s_add_u32 m0, s54, 63488
    s_mul_i32 s60, s58, 12
    buffer_load_dwordx4 v22, s[44:47], s60 offen lds
    ds_read_b64_tr_b16 v[32:33], v18 offset:128
    ds_read_b64_tr_b16 v[34:35], v18 offset:6784
    s_waitcnt lgkmcnt(8)
    v_mfma_f32_16x16x32_bf16 v[200:203], v[48:51], v[36:39], v[200:203]
    v_mfma_f32_16x16x32_bf16 v[204:207], v[52:55], v[36:39], v[204:207]
    s_waitcnt vmcnt(6)
    s_barrier
    ds_read_b64_tr_b16 v[36:37], v18 offset:160
    ds_read_b64_tr_b16 v[38:39], v18 offset:6816
    s_waitcnt lgkmcnt(6)
    v_mfma_f32_16x16x32_bf16 v[160:163], v[40:43], v[56:59], v[160:163]
    v_mfma_f32_16x16x32_bf16 v[164:167], v[40:43], v[60:63], v[164:167]
    s_add_u32 m0, s52, 95232
    s_mul_i32 s60, s56, 13
    buffer_load_dwordx4 v20, s[36:39], s60 offen lds
    ds_read_b64_tr_b16 v[40:41], v18 offset:256
    ds_read_b64_tr_b16 v[42:43], v18 offset:6912
    s_waitcnt lgkmcnt(6)
    v_mfma_f32_16x16x32_bf16 v[168:171], v[44:47], v[56:59], v[168:171]
    v_mfma_f32_16x16x32_bf16 v[172:175], v[44:47], v[60:63], v[172:175]
    ds_read_b64_tr_b16 v[44:45], v18 offset:288
    ds_read_b64_tr_b16 v[46:47], v18 offset:6944
    s_waitcnt lgkmcnt(6)
    v_mfma_f32_16x16x32_bf16 v[176:179], v[32:35], v[56:59], v[176:179]
    v_mfma_f32_16x16x32_bf16 v[180:183], v[32:35], v[60:63], v[180:183]
    s_add_u32 m0, s53, 95232
    s_mul_i32 s60, s57, 13
    buffer_load_dwordx4 v21, s[40:43], s60 offen lds
    ds_read_b128 v[48:51], v27 offset:0
    ds_read_b128 v[52:55], v27 offset:1024
    ds_read_b64_tr_b16 v[32:33], v16 offset:0
    ds_read_b64_tr_b16 v[34:35], v16 offset:6656
    s_waitcnt lgkmcnt(8)
    v_mfma_f32_16x16x32_bf16 v[184:187], v[36:39], v[56:59], v[184:187]
    v_mfma_f32_16x16x32_bf16 v[188:191], v[36:39], v[60:63], v[188:191]
    ds_read_b64_tr_b16 v[36:37], v16 offset:32
    ds_read_b64_tr_b16 v[38:39], v16 offset:6688
    s_waitcnt lgkmcnt(8)
    v_mfma_f32_16x16x32_bf16 v[192:195], v[56:59], v[40:43], v[192:195]
    v_mfma_f32_16x16x32_bf16 v[196:199], v[60:63], v[40:43], v[196:199]
    s_add_u32 m0, s54, 95232
    s_mul_i32 s60, s58, 13
    buffer_load_dwordx4 v22, s[44:47], s60 offen lds
    ds_read_b64_tr_b16 v[40:41], v16 offset:128
    ds_read_b64_tr_b16 v[42:43], v16 offset:6784
    s_waitcnt lgkmcnt(8)
    v_mfma_f32_16x16x32_bf16 v[200:203], v[56:59], v[44:47], v[200:203]
    v_mfma_f32_16x16x32_bf16 v[204:207], v[60:63], v[44:47], v[204:207]
    s_waitcnt vmcnt(6)
    s_barrier
    ds_read_b64_tr_b16 v[44:45], v16 offset:160
    ds_read_b64_tr_b16 v[46:47], v16 offset:6816
    s_waitcnt lgkmcnt(6)
    v_mfma_f32_16x16x32_bf16 v[160:163], v[32:35], v[48:51], v[160:163]
    v_mfma_f32_16x16x32_bf16 v[164:167], v[32:35], v[52:55], v[164:167]
    s_add_u32 m0, s52, 126976
    s_mul_i32 s60, s56, 14
    buffer_load_dwordx4 v20, s[36:39], s60 offen lds
    ds_read_b64_tr_b16 v[32:33], v16 offset:256
    ds_read_b64_tr_b16 v[34:35], v16 offset:6912
    s_waitcnt lgkmcnt(6)
    v_mfma_f32_16x16x32_bf16 v[168:171], v[36:39], v[48:51], v[168:171]
    v_mfma_f32_16x16x32_bf16 v[172:175], v[36:39], v[52:55], v[172:175]
    ds_read_b64_tr_b16 v[36:37], v16 offset:288
    ds_read_b64_tr_b16 v[38:39], v16 offset:6944
    s_waitcnt lgkmcnt(6)
    v_mfma_f32_16x16x32_bf16 v[176:179], v[40:43], v[48:51], v[176:179]
    v_mfma_f32_16x16x32_bf16 v[180:183], v[40:43], v[52:55], v[180:183]
    s_add_u32 m0, s53, 126976
    s_mul_i32 s60, s57, 14
    buffer_load_dwordx4 v21, s[40:43], s60 offen lds
    ds_read_b128 v[56:59], v27 offset:31744
    ds_read_b128 v[60:63], v27 offset:32768
    ds_read_b64_tr_b16 v[40:41], v16 offset:31744
    ds_read_b64_tr_b16 v[42:43], v16 offset:38400
    s_waitcnt lgkmcnt(8)
    v_mfma_f32_16x16x32_bf16 v[184:187], v[44:47], v[48:51], v[184:187]
    v_mfma_f32_16x16x32_bf16 v[188:191], v[44:47], v[52:55], v[188:191]
    ds_read_b64_tr_b16 v[44:45], v16 offset:31776
    ds_read_b64_tr_b16 v[46:47], v16 offset:38432
    s_waitcnt lgkmcnt(8)
    v_mfma_f32_16x16x32_bf16 v[192:195], v[48:51], v[32:35], v[192:195]
    v_mfma_f32_16x16x32_bf16 v[196:199], v[52:55], v[32:35], v[196:199]
    s_add_u32 m0, s54, 126976
    s_mul_i32 s60, s58, 14
    buffer_load_dwordx4 v22, s[44:47], s60 offen lds
    ds_read_b64_tr_b16 v[32:33], v16 offset:31872
    ds_read_b64_tr_b16 v[34:35], v16 offset:38528
    s_waitcnt lgkmcnt(8)
    v_mfma_f32_16x16x32_bf16 v[200:203], v[48:51], v[36:39], v[200:203]
    v_mfma_f32_16x16x32_bf16 v[204:207], v[52:55], v[36:39], v[204:207]
    s_waitcnt vmcnt(6)
    s_barrier
    ds_read_b64_tr_b16 v[36:37], v16 offset:31904
    ds_read_b64_tr_b16 v[38:39], v16 offset:38560
    s_waitcnt lgkmcnt(6)
    v_mfma_f32_16x16x32_bf16 v[160:163], v[40:43], v[56:59], v[160:163]
    v_mfma_f32_16x16x32_bf16 v[164:167], v[40:43], v[60:63], v[164:167]
    s_add_u32 m0, s52, 0
    s_mul_i32 s60, s56, 15
    buffer_load_dwordx4 v20, s[36:39], s60 offen lds
    ds_read_b64_tr_b16 v[40:41], v16 offset:32000
    ds_read_b64_tr_b16 v[42:43], v16 offset:38656
    s_waitcnt lgkmcnt(6)
    v_mfma_f32_16x16x32_bf16 v[168:171], v[44:47], v[56:59], v[168:171]
    v_mfma_f32_16x16x32_bf16 v[172:175], v[44:47], v[60:63], v[172:175]
    ds_read_b64_tr_b16 v[44:45], v16 offset:32032
    ds_read_b64_tr_b16 v[46:47], v16 offset:38688
    s_waitcnt lgkmcnt(6)
    v_mfma_f32_16x16x32_bf16 v[176:179], v[32:35], v[56:59], v[176:179]
    v_mfma_f32_16x16x32_bf16 v[180:183], v[32:35], v[60:63], v[180:183]
    s_add_u32 m0, s53, 0
    s_mul_i32 s60, s57, 15
    buffer_load_dwordx4 v21, s[40:43], s60 offen lds
    ds_read_b128 v[48:51], v28 offset:0
    ds_read_b128 v[52:55], v28 offset:1024
    ds_read_b64_tr_b16 v[32:33], v17 offset:0
    ds_read_b64_tr_b16 v[34:35], v17 offset:6656
    s_waitcnt lgkmcnt(8)
    v_mfma_f32_16x16x32_bf16 v[184:187], v[36:39], v[56:59], v[184:187]
    v_mfma_f32_16x16x32_bf16 v[188:191], v[36:39], v[60:63], v[188:191]
    ds_read_b64_tr_b16 v[36:37], v17 offset:32
    ds_read_b64_tr_b16 v[38:39], v17 offset:6688
    s_waitcnt lgkmcnt(8)
    v_mfma_f32_16x16x32_bf16 v[192:195], v[56:59], v[40:43], v[192:195]
    v_mfma_f32_16x16x32_bf16 v[196:199], v[60:63], v[40:43], v[196:199]
    s_add_u32 m0, s54, 0
    s_mul_i32 s60, s58, 15
    buffer_load_dwordx4 v22, s[44:47], s60 offen lds
    ds_read_b64_tr_b16 v[40:41], v17 offset:128
    ds_read_b64_tr_b16 v[42:43], v17 offset:6784
    s_waitcnt lgkmcnt(8)
    v_mfma_f32_16x16x32_bf16 v[200:203], v[56:59], v[44:47], v[200:203]
    v_mfma_f32_16x16x32_bf16 v[204:207], v[60:63], v[44:47], v[204:207]
    s_waitcnt vmcnt(6)
    s_barrier
    ds_read_b64_tr_b16 v[44:45], v17 offset:160
    ds_read_b64_tr_b16 v[46:47], v17 offset:6816
    s_waitcnt lgkmcnt(6)
    v_mfma_f32_16x16x32_bf16 v[160:163], v[32:35], v[48:51], v[160:163]
    v_mfma_f32_16x16x32_bf16 v[164:167], v[32:35], v[52:55], v[164:167]
    ds_read_b64_tr_b16 v[32:33], v17 offset:256
    ds_read_b64_tr_b16 v[34:35], v17 offset:6912
    s_waitcnt lgkmcnt(6)
    v_mfma_f32_16x16x32_bf16 v[168:171], v[36:39], v[48:51], v[168:171]
    v_mfma_f32_16x16x32_bf16 v[172:175], v[36:39], v[52:55], v[172:175]
    ds_read_b64_tr_b16 v[36:37], v17 offset:288
    ds_read_b64_tr_b16 v[38:39], v17 offset:6944
    s_waitcnt lgkmcnt(6)
    v_mfma_f32_16x16x32_bf16 v[176:179], v[40:43], v[48:51], v[176:179]
    v_mfma_f32_16x16x32_bf16 v[180:183], v[40:43], v[52:55], v[180:183]
    ds_read_b128 v[56:59], v28 offset:31744
    ds_read_b128 v[60:63], v28 offset:32768
    ds_read_b64_tr_b16 v[40:41], v17 offset:31744
    ds_read_b64_tr_b16 v[42:43], v17 offset:38400
    s_waitcnt lgkmcnt(8)
    v_mfma_f32_16x16x32_bf16 v[184:187], v[44:47], v[48:51], v[184:187]
    v_mfma_f32_16x16x32_bf16 v[188:191], v[44:47], v[52:55], v[188:191]
    ds_read_b64_tr_b16 v[44:45], v17 offset:31776
    ds_read_b64_tr_b16 v[46:47], v17 offset:38432
    s_waitcnt lgkmcnt(8)
    v_mfma_f32_16x16x32_bf16 v[192:195], v[48:51], v[32:35], v[192:195]
    v_mfma_f32_16x16x32_bf16 v[196:199], v[52:55], v[32:35], v[196:199]
    ds_read_b64_tr_b16 v[32:33], v17 offset:31872
    ds_read_b64_tr_b16 v[34:35], v17 offset:38528
    s_waitcnt lgkmcnt(8)
    v_mfma_f32_16x16x32_bf16 v[200:203], v[48:51], v[36:39], v[200:203]
    v_mfma_f32_16x16x32_bf16 v[204:207], v[52:55], v[36:39], v[204:207]
    s_waitcnt vmcnt(3)
    s_barrier
    ds_read_b64_tr_b16 v[36:37], v17 offset:31904
    ds_read_b64_tr_b16 v[38:39], v17 offset:38560
    s_waitcnt lgkmcnt(6)
    v_mfma_f32_16x16x32_bf16 v[160:163], v[40:43], v[56:59], v[160:163]
    v_mfma_f32_16x16x32_bf16 v[164:167], v[40:43], v[60:63], v[164:167]
    ds_read_b64_tr_b16 v[40:41], v17 offset:32000
    ds_read_b64_tr_b16 v[42:43], v17 offset:38656
    s_waitcnt lgkmcnt(6)
    v_mfma_f32_16x16x32_bf16 v[168:171], v[44:47], v[56:59], v[168:171]
    v_mfma_f32_16x16x32_bf16 v[172:175], v[44:47], v[60:63], v[172:175]
    ds_read_b64_tr_b16 v[44:45], v17 offset:32032
    ds_read_b64_tr_b16 v[46:47], v17 offset:38688
    s_waitcnt lgkmcnt(6)
    v_mfma_f32_16x16x32_bf16 v[176:179], v[32:35], v[56:59], v[176:179]
    v_mfma_f32_16x16x32_bf16 v[180:183], v[32:35], v[60:63], v[180:183]
    ds_read_b128 v[48:51], v29 offset:0
    ds_read_b128 v[52:55], v29 offset:1024
    ds_read_b64_tr_b16 v[32:33], v18 offset:0
    ds_read_b64_tr_b16 v[34:35], v18 offset:6656
    s_waitcnt lgkmcnt(8)
    v_mfma_f32_16x16x32_bf16 v[184:187], v[36:39], v[56:59], v[184:187]
    v_mfma_f32_16x16x32_bf16 v[188:191], v[36:39], v[60:63], v[188:191]
    ds_read_b64_tr_b16 v[36:37], v18 offset:32
    ds_read_b64_tr_b16 v[38:39], v18 offset:6688
    s_waitcnt lgkmcnt(8)
    v_mfma_f32_16x16x32_bf16 v[192:195], v[56:59], v[40:43], v[192:195]
    v_mfma_f32_16x16x32_bf16 v[196:199], v[60:63], v[40:43], v[196:199]
    ds_read_b64_tr_b16 v[40:41], v18 offset:128
    ds_read_b64_tr_b16 v[42:43], v18 offset:6784
    s_waitcnt lgkmcnt(8)
    v_mfma_f32_16x16x32_bf16 v[200:203], v[56:59], v[44:47], v[200:203]
    v_mfma_f32_16x16x32_bf16 v[204:207], v[60:63], v[44:47], v[204:207]
    s_waitcnt vmcnt(0)
    s_barrier
    ds_read_b64_tr_b16 v[44:45], v18 offset:160
    ds_read_b64_tr_b16 v[46:47], v18 offset:6816
    s_waitcnt lgkmcnt(6)
    v_mfma_f32_16x16x32_bf16 v[160:163], v[32:35], v[48:51], v[160:163]
    v_mfma_f32_16x16x32_bf16 v[164:167], v[32:35], v[52:55], v[164:167]
    ds_read_b64_tr_b16 v[32:33], v18 offset:256
    ds_read_b64_tr_b16 v[34:35], v18 offset:6912
    s_waitcnt lgkmcnt(6)
    v_mfma_f32_16x16x32_bf16 v[168:171], v[36:39], v[48:51], v[168:171]
    v_mfma_f32_16x16x32_bf16 v[172:175], v[36:39], v[52:55], v[172:175]
    ds_read_b64_tr_b16 v[36:37], v18 offset:288
    ds_read_b64_tr_b16 v[38:39], v18 offset:6944
    s_waitcnt lgkmcnt(6)
    v_mfma_f32_16x16x32_bf16 v[176:179], v[40:43], v[48:51], v[176:179]
    v_mfma_f32_16x16x32_bf16 v[180:183], v[40:43], v[52:55], v[180:183]
    ds_read_b128 v[56:59], v27 offset:0
    ds_read_b128 v[60:63], v27 offset:1024
    ds_read_b64_tr_b16 v[40:41], v16 offset:0
    ds_read_b64_tr_b16 v[42:43], v16 offset:6656
    s_waitcnt lgkmcnt(8)
    v_mfma_f32_16x16x32_bf16 v[184:187], v[44:47], v[48:51], v[184:187]
    v_mfma_f32_16x16x32_bf16 v[188:191], v[44:47], v[52:55], v[188:191]
    ds_read_b64_tr_b16 v[44:45], v16 offset:32
    ds_read_b64_tr_b16 v[46:47], v16 offset:6688
    s_waitcnt lgkmcnt(8)
    v_mfma_f32_16x16x32_bf16 v[192:195], v[48:51], v[32:35], v[192:195]
    v_mfma_f32_16x16x32_bf16 v[196:199], v[52:55], v[32:35], v[196:199]
    ds_read_b64_tr_b16 v[32:33], v16 offset:128
    ds_read_b64_tr_b16 v[34:35], v16 offset:6784
    s_waitcnt lgkmcnt(8)
    v_mfma_f32_16x16x32_bf16 v[200:203], v[48:51], v[36:39], v[200:203]
    v_mfma_f32_16x16x32_bf16 v[204:207], v[52:55], v[36:39], v[204:207]
    s_waitcnt vmcnt(0)
    s_barrier
    ds_read_b64_tr_b16 v[36:37], v16 offset:160
    ds_read_b64_tr_b16 v[38:39], v16 offset:6816
    s_waitcnt lgkmcnt(6)
    v_mfma_f32_16x16x32_bf16 v[160:163], v[40:43], v[56:59], v[160:163]
    v_mfma_f32_16x16x32_bf16 v[164:167], v[40:43], v[60:63], v[164:167]
    ds_read_b64_tr_b16 v[40:41], v16 offset:256
    ds_read_b64_tr_b16 v[42:43], v16 offset:6912
    s_waitcnt lgkmcnt(6)
    v_mfma_f32_16x16x32_bf16 v[168:171], v[44:47], v[56:59], v[168:171]
    v_mfma_f32_16x16x32_bf16 v[172:175], v[44:47], v[60:63], v[172:175]
    ds_read_b64_tr_b16 v[44:45], v16 offset:288
    ds_read_b64_tr_b16 v[46:47], v16 offset:6944
    s_waitcnt lgkmcnt(6)
    v_mfma_f32_16x16x32_bf16 v[176:179], v[32:35], v[56:59], v[176:179]
    v_mfma_f32_16x16x32_bf16 v[180:183], v[32:35], v[60:63], v[180:183]
    s_waitcnt lgkmcnt(4)
    v_mfma_f32_16x16x32_bf16 v[184:187], v[36:39], v[56:59], v[184:187]
    v_mfma_f32_16x16x32_bf16 v[188:191], v[36:39], v[60:63], v[188:191]
    s_waitcnt lgkmcnt(2)
    v_mfma_f32_16x16x32_bf16 v[192:195], v[56:59], v[40:43], v[192:195]
    v_mfma_f32_16x16x32_bf16 v[196:199], v[60:63], v[40:43], v[196:199]
    s_waitcnt lgkmcnt(0)
    v_mfma_f32_16x16x32_bf16 v[200:203], v[56:59], v[44:47], v[200:203]
    v_mfma_f32_16x16x32_bf16 v[204:207], v[60:63], v[44:47], v[204:207]
    s_nop 7
    s_barrier
    v_lshlrev_b32 v3, 3, v2
    v_add_u32 v3, 158720, v3
    s_lshl_b32 s71, s70, 10
    v_add_u32 v3, s71, v3
    ds_read_b64_tr_b16 v[32:33], v3 offset:0
    ds_read_b64_tr_b16 v[34:35], v3 offset:512
    v_mov_b32 v10, 1.0
    v_lshlrev_b32 v4, 4, v2
    s_lshl_b32 s71, s66, 12
    s_lshl_b32 s72, s70, 11
    s_add_u32 s71, s71, s72
    s_lshl_b32 s72, s73, 11
    s_add_u32 s71, s71, s72
    s_add_u32 s71, s71, 8388608
    v_add_u32 v4, s71, v4
    v_add_u32 v5, 0x8000, v4
    s_waitcnt lgkmcnt(0)
    v_cvt_pk_bf16_f32 v64, v160, v161
    v_cvt_pk_bf16_f32 v65, v162, v163
    v_cvt_pk_bf16_f32 v88, v164, v165
    v_cvt_pk_bf16_f32 v89, v166, v167
    v_cvt_pk_bf16_f32 v112, v168, v169
    v_cvt_pk_bf16_f32 v113, v170, v171
    v_cvt_pk_bf16_f32 v136, v172, v173
    v_cvt_pk_bf16_f32 v137, v174, v175
    s_nop 0
    v_mfma_f32_16x16x16_bf16 v[66:69], v[32:33], v[64:65], 0
    v_mfma_f32_16x16x16_bf16 v[90:93], v[32:33], v[88:89], 0
    v_mfma_f32_16x16x16_bf16 v[114:117], v[34:35], v[112:113], 0
    v_mfma_f32_16x16x16_bf16 v[138:141], v[34:35], v[136:137], 0
    s_nop 7
    v_cvt_pk_bf16_f32 v64, v66, v67
    v_cvt_pk_bf16_f32 v65, v68, v69
    v_cvt_pk_bf16_f32 v88, v90, v91
    v_cvt_pk_bf16_f32 v89, v92, v93
    v_cvt_pk_bf16_f32 v112, v114, v115
    v_cvt_pk_bf16_f32 v113, v116, v117
    v_cvt_pk_bf16_f32 v136, v138, v139
    v_cvt_pk_bf16_f32 v137, v140, v141
    v_lshlrev_b32 v66, 16, v64
    v_and_b32 v67, 0xffff0000, v64
    v_lshlrev_b32 v68, 16, v65
    v_and_b32 v69, 0xffff0000, v65
    v_lshlrev_b32 v90, 16, v88
    v_and_b32 v91, 0xffff0000, v88
    v_lshlrev_b32 v92, 16, v89
    v_and_b32 v93, 0xffff0000, v89
    v_lshlrev_b32 v114, 16, v112
    v_and_b32 v115, 0xffff0000, v112
    v_lshlrev_b32 v116, 16, v113
    v_and_b32 v117, 0xffff0000, v113
    v_lshlrev_b32 v138, 16, v136
    v_and_b32 v139, 0xffff0000, v136
    v_lshlrev_b32 v140, 16, v137
    v_and_b32 v141, 0xffff0000, v137
    v_max3_f32 v78, v66, v67, v68
    v_max3_f32 v79, -v66, -v67, -v68
    v_max3_f32 v102, v90, v91, v92
    v_max3_f32 v103, -v90, -v91, -v92
    v_max3_f32 v126, v114, v115, v116
    v_max3_f32 v127, -v114, -v115, -v116
    v_max3_f32 v150, v138, v139, v140
    v_max3_f32 v151, -v138, -v139, -v140
    v_max_f32 v78, v78, v69
    v_max_f32_e64 v79, v79, -v69
    v_max_f32 v102, v102, v93
    v_max_f32_e64 v103, v103, -v93
    v_max_f32 v126, v126, v117
    v_max_f32_e64 v127, v127, -v117
    v_max_f32 v150, v150, v141
    v_max_f32_e64 v151, v151, -v141
    s_nop 0
    v_permlane32_swap_b32 v78, v79
    v_permlane32_swap_b32 v102, v103
    v_permlane32_swap_b32 v126, v127
    v_permlane32_swap_b32 v150, v151
    v_max_f32 v80, v78, v79
    v_max_f32 v104, v102, v103
    v_max_f32 v128, v126, v127
    v_max_f32 v152, v150, v151
    v_mov_b32 v81, v80
    v_mov_b32 v105, v104
    v_mov_b32 v129, v128
    v_mov_b32 v153, v152
    v_permlane16_swap_b32 v80, v81
    v_permlane16_swap_b32 v104, v105
    v_permlane16_swap_b32 v128, v129
    v_permlane16_swap_b32 v152, v153
    v_max_f32 v78, v80, v81
    v_max_f32 v102, v104, v105
    v_max_f32 v126, v128, v129
    v_max_f32 v150, v152, v153
    v_mov_b32 v79, v78
    v_mov_b32 v103, v102
    v_mov_b32 v127, v126
    v_mov_b32 v151, v150
    v_permlane32_swap_b32 v78, v79
    v_permlane32_swap_b32 v102, v103
    v_permlane32_swap_b32 v126, v127
    v_permlane32_swap_b32 v150, v151
    v_pk_mul_f32 v[78:79], v[78:79], s[62:63]
    v_pk_mul_f32 v[102:103], v[102:103], s[62:63]
    v_pk_mul_f32 v[126:127], v[126:127], s[62:63]
    v_pk_mul_f32 v[150:151], v[150:151], s[62:63]
    v_pk_fma_f32 v[70:71], v[66:67], s[62:63], v[78:79] op_sel_hi:[1,1,0] neg_lo:[0,0,1] neg_hi:[0,0,1]
    v_pk_fma_f32 v[94:95], v[90:91], s[62:63], v[102:103] op_sel_hi:[1,1,0] neg_lo:[0,0,1] neg_hi:[0,0,1]
    v_pk_fma_f32 v[118:119], v[114:115], s[62:63], v[126:127] op_sel_hi:[1,1,0] neg_lo:[0,0,1] neg_hi:[0,0,1]
    v_pk_fma_f32 v[142:143], v[138:139], s[62:63], v[150:151] op_sel_hi:[1,1,0] neg_lo:[0,0,1] neg_hi:[0,0,1]
    v_pk_fma_f32 v[74:75], v[66:67], s[62:63], v[78:79] op_sel:[0,0,1] op_sel_hi:[1,1,1] neg_lo:[1,0,1] neg_hi:[1,0,1]
    v_pk_fma_f32 v[98:99], v[90:91], s[62:63], v[102:103] op_sel:[0,0,1] op_sel_hi:[1,1,1] neg_lo:[1,0,1] neg_hi:[1,0,1]
    v_pk_fma_f32 v[122:123], v[114:115], s[62:63], v[126:127] op_sel:[0,0,1] op_sel_hi:[1,1,1] neg_lo:[1,0,1] neg_hi:[1,0,1]
    v_pk_fma_f32 v[146:147], v[138:139], s[62:63], v[150:151] op_sel:[0,0,1] op_sel_hi:[1,1,1] neg_lo:[1,0,1] neg_hi:[1,0,1]
    v_pk_fma_f32 v[72:73], v[68:69], s[62:63], v[78:79] op_sel_hi:[1,1,0] neg_lo:[0,0,1] neg_hi:[0,0,1]
    v_pk_fma_f32 v[96:97], v[92:93], s[62:63], v[102:103] op_sel_hi:[1,1,0] neg_lo:[0,0,1] neg_hi:[0,0,1]
    v_pk_fma_f32 v[120:121], v[116:117], s[62:63], v[126:127] op_sel_hi:[1,1,0] neg_lo:[0,0,1] neg_hi:[0,0,1]
    v_pk_fma_f32 v[144:145], v[140:141], s[62:63], v[150:151] op_sel_hi:[1,1,0] neg_lo:[0,0,1] neg_hi:[0,0,1]
    v_pk_fma_f32 v[76:77], v[68:69], s[62:63], v[78:79] op_sel:[0,0,1] op_sel_hi:[1,1,1] neg_lo:[1,0,1] neg_hi:[1,0,1]
    v_pk_fma_f32 v[100:101], v[92:93], s[62:63], v[102:103] op_sel:[0,0,1] op_sel_hi:[1,1,1] neg_lo:[1,0,1] neg_hi:[1,0,1]
    v_pk_fma_f32 v[124:125], v[116:117], s[62:63], v[126:127] op_sel:[0,0,1] op_sel_hi:[1,1,1] neg_lo:[1,0,1] neg_hi:[1,0,1]
    v_pk_fma_f32 v[148:149], v[140:141], s[62:63], v[150:151] op_sel:[0,0,1] op_sel_hi:[1,1,1] neg_lo:[1,0,1] neg_hi:[1,0,1]
    v_exp_f32 v70, v70
    v_exp_f32 v74, v74
    v_exp_f32 v94, v94
    v_exp_f32 v98, v98
    v_exp_f32 v118, v118
    v_exp_f32 v122, v122
    v_exp_f32 v142, v142
    v_exp_f32 v146, v146
    v_exp_f32 v71, v71
    v_exp_f32 v75, v75
    v_exp_f32 v95, v95
    v_exp_f32 v99, v99
    v_exp_f32 v119, v119
    v_exp_f32 v123, v123
    v_exp_f32 v143, v143
    v_exp_f32 v147, v147
    v_exp_f32 v72, v72
    v_exp_f32 v76, v76
    v_exp_f32 v96, v96
    v_exp_f32 v100, v100
    v_exp_f32 v120, v120
    v_exp_f32 v124, v124
    v_exp_f32 v144, v144
    v_exp_f32 v148, v148
    v_exp_f32 v73, v73
    v_exp_f32 v77, v77
    v_exp_f32 v97, v97
    v_exp_f32 v101, v101
    v_exp_f32 v121, v121
    v_exp_f32 v125, v125
    v_exp_f32 v145, v145
    v_exp_f32 v149, v149
    s_nop 0
    v_pk_add_f32 v[78:79], v[70:71], v[72:73]
    v_pk_add_f32 v[80:81], v[74:75], v[76:77]
    v_pk_add_f32 v[102:103], v[94:95], v[96:97]
    v_pk_add_f32 v[104:105], v[98:99], v[100:101]
    v_pk_add_f32 v[126:127], v[118:119], v[120:121]
    v_pk_add_f32 v[128:129], v[122:123], v[124:125]
    v_pk_add_f32 v[150:151], v[142:143], v[144:145]
    v_pk_add_f32 v[152:153], v[146:147], v[148:149]
    v_add_f32 v78, v78, v79
    v_add_f32 v80, v80, v81
    v_add_f32 v102, v102, v103
    v_add_f32 v104, v104, v105
    v_add_f32 v126, v126, v127
    v_add_f32 v128, v128, v129
    v_add_f32 v150, v150, v151
    v_add_f32 v152, v152, v153
    s_nop 0
    v_mfma_f32_16x16x4_f32 v[66:69], v10, v78, 0
    v_mfma_f32_16x16x4_f32 v[82:85], v10, v80, 0
    v_mfma_f32_16x16x4_f32 v[90:93], v10, v102, 0
    v_mfma_f32_16x16x4_f32 v[106:109], v10, v104, 0
    v_mfma_f32_16x16x4_f32 v[114:117], v10, v126, 0
    v_mfma_f32_16x16x4_f32 v[130:133], v10, v128, 0
    v_mfma_f32_16x16x4_f32 v[138:141], v10, v150, 0
    v_mfma_f32_16x16x4_f32 v[154:157], v10, v152, 0
    s_nop 9
    v_rcp_f32 v78, v66
    v_rcp_f32 v80, v82
    v_rcp_f32 v102, v90
    v_rcp_f32 v104, v106
    v_rcp_f32 v126, v114
    v_rcp_f32 v128, v130
    v_rcp_f32 v150, v138
    v_rcp_f32 v152, v154
    s_nop 0
    v_pk_mul_f32 v[70:71], v[70:71], v[78:79] op_sel_hi:[1,0]
    v_pk_mul_f32 v[74:75], v[74:75], v[80:81] op_sel_hi:[1,0]
    v_pk_mul_f32 v[94:95], v[94:95], v[102:103] op_sel_hi:[1,0]
    v_pk_mul_f32 v[98:99], v[98:99], v[104:105] op_sel_hi:[1,0]
    v_pk_mul_f32 v[118:119], v[118:119], v[126:127] op_sel_hi:[1,0]
    v_pk_mul_f32 v[122:123], v[122:123], v[128:129] op_sel_hi:[1,0]
    v_pk_mul_f32 v[142:143], v[142:143], v[150:151] op_sel_hi:[1,0]
    v_pk_mul_f32 v[146:147], v[146:147], v[152:153] op_sel_hi:[1,0]
    v_pk_mul_f32 v[72:73], v[72:73], v[78:79] op_sel_hi:[1,0]
    v_pk_mul_f32 v[76:77], v[76:77], v[80:81] op_sel_hi:[1,0]
    v_pk_mul_f32 v[96:97], v[96:97], v[102:103] op_sel_hi:[1,0]
    v_pk_mul_f32 v[100:101], v[100:101], v[104:105] op_sel_hi:[1,0]
    v_pk_mul_f32 v[120:121], v[120:121], v[126:127] op_sel_hi:[1,0]
    v_pk_mul_f32 v[124:125], v[124:125], v[128:129] op_sel_hi:[1,0]
    v_pk_mul_f32 v[144:145], v[144:145], v[150:151] op_sel_hi:[1,0]
    v_pk_mul_f32 v[148:149], v[148:149], v[152:153] op_sel_hi:[1,0]
    v_cvt_pk_bf16_f32 v48, v70, v71
    v_cvt_pk_bf16_f32 v49, v72, v73
    v_cvt_pk_bf16_f32 v50, v74, v75
    v_cvt_pk_bf16_f32 v51, v76, v77
    v_cvt_pk_bf16_f32 v52, v94, v95
    v_cvt_pk_bf16_f32 v53, v96, v97
    v_cvt_pk_bf16_f32 v54, v98, v99
    v_cvt_pk_bf16_f32 v55, v100, v101
    v_cvt_pk_bf16_f32 v56, v118, v119
    v_cvt_pk_bf16_f32 v57, v120, v121
    v_cvt_pk_bf16_f32 v58, v122, v123
    v_cvt_pk_bf16_f32 v59, v124, v125
    v_cvt_pk_bf16_f32 v60, v142, v143
    v_cvt_pk_bf16_f32 v61, v144, v145
    v_cvt_pk_bf16_f32 v62, v146, v147
    v_cvt_pk_bf16_f32 v63, v148, v149
    buffer_store_dwordx4 v[48:51], v4, s[24:27], 0 offen offset:0 sc1
    buffer_store_dwordx4 v[52:55], v5, s[24:27], 0 offen offset:0 sc1
    buffer_store_dwordx4 v[56:59], v4, s[24:27], 0 offen offset:1024 sc1
    buffer_store_dwordx4 v[60:63], v5, s[24:27], 0 offen offset:1024 sc1
    v_and_b32 v6, 15, v2
    v_lshrrev_b32 v7, 4, v2
    v_lshlrev_b32 v11, 2, v7
    v_sub_u32 v6, v6, v11
    v_mov_b32 v12, 0x3f80
    v_mov_b32 v13, 0x3f800000
    v_mov_b32 v8, 0
    v_mov_b32 v9, 0
    v_cmp_eq_u32 vcc, 0, v6
    s_nop 1
    v_cndmask_b32 v8, v8, v12, vcc
    v_cmp_eq_u32 vcc, 1, v6
    s_nop 1
    v_cndmask_b32 v8, v8, v13, vcc
    v_cmp_eq_u32 vcc, 2, v6
    s_nop 1
    v_cndmask_b32 v9, v9, v12, vcc
    v_cmp_eq_u32 vcc, 3, v6
    s_nop 1
    v_cndmask_b32 v9, v9, v13, vcc
    v_mov_b32 v12, 0x3f803f80
    v_mov_b32 v13, 0x3f803f80
    v_mov_b32 v14, 0x3f803f80
    v_mov_b32 v15, 0x3f803f80
    v_and_b32 v6, 15, v2
    v_lshlrev_b32 v6, 7, v6
    v_lshl_add_u32 v6, v7, 5, v6
    s_mul_i32 s71, s69, 8704
    s_lshl_b32 s72, s70, 12
    s_add_u32 s72, s72, s71
    v_add_u32 v6, s72, v6
    s_lshl_b32 s72, s70, 8
    s_add_u32 s72, s72, s71
    s_add_u32 s72, s72, 8192
    v_lshlrev_b32 v7, 5, v7
    v_add_u32 v7, s72, v7
    v_cvt_pk_bf16_f32 v64, v176, v177
    v_cvt_pk_bf16_f32 v65, v178, v179
    v_cvt_pk_bf16_f32 v88, v180, v181
    v_cvt_pk_bf16_f32 v89, v182, v183
    v_cvt_pk_bf16_f32 v112, v184, v185
    v_cvt_pk_bf16_f32 v113, v186, v187
    v_cvt_pk_bf16_f32 v136, v188, v189
    v_cvt_pk_bf16_f32 v137, v190, v191
    s_nop 0
    v_mfma_f32_16x16x16_bf16 v[66:69], v[32:33], v[64:65], 0
    v_mfma_f32_16x16x16_bf16 v[90:93], v[32:33], v[88:89], 0
    v_mfma_f32_16x16x16_bf16 v[114:117], v[34:35], v[112:113], 0
    v_mfma_f32_16x16x16_bf16 v[138:141], v[34:35], v[136:137], 0
    s_nop 7
    v_cvt_pk_bf16_f32 v64, v66, v67
    v_cvt_pk_bf16_f32 v65, v68, v69
    v_cvt_pk_bf16_f32 v88, v90, v91
    v_cvt_pk_bf16_f32 v89, v92, v93
    v_cvt_pk_bf16_f32 v112, v114, v115
    v_cvt_pk_bf16_f32 v113, v116, v117
    v_cvt_pk_bf16_f32 v136, v138, v139
    v_cvt_pk_bf16_f32 v137, v140, v141
    v_lshlrev_b32 v66, 16, v64
    v_and_b32 v67, 0xffff0000, v64
    v_lshlrev_b32 v68, 16, v65
    v_and_b32 v69, 0xffff0000, v65
    v_lshlrev_b32 v90, 16, v88
    v_and_b32 v91, 0xffff0000, v88
    v_lshlrev_b32 v92, 16, v89
    v_and_b32 v93, 0xffff0000, v89
    v_lshlrev_b32 v114, 16, v112
    v_and_b32 v115, 0xffff0000, v112
    v_lshlrev_b32 v116, 16, v113
    v_and_b32 v117, 0xffff0000, v113
    v_lshlrev_b32 v138, 16, v136
    v_and_b32 v139, 0xffff0000, v136
    v_lshlrev_b32 v140, 16, v137
    v_and_b32 v141, 0xffff0000, v137
    v_max3_f32 v78, v66, v67, v68
    v_max3_f32 v79, -v66, -v67, -v68
    v_max3_f32 v102, v90, v91, v92
    v_max3_f32 v103, -v90, -v91, -v92
    v_max3_f32 v126, v114, v115, v116
    v_max3_f32 v127, -v114, -v115, -v116
    v_max3_f32 v150, v138, v139, v140
    v_max3_f32 v151, -v138, -v139, -v140
    v_max_f32 v78, v78, v69
    v_max_f32_e64 v79, v79, -v69
    v_max_f32 v102, v102, v93
    v_max_f32_e64 v103, v103, -v93
    v_max_f32 v126, v126, v117
    v_max_f32_e64 v127, v127, -v117
    v_max_f32 v150, v150, v141
    v_max_f32_e64 v151, v151, -v141
    s_nop 0
    v_permlane32_swap_b32 v78, v79
    v_permlane32_swap_b32 v102, v103
    v_permlane32_swap_b32 v126, v127
    v_permlane32_swap_b32 v150, v151
    v_max_f32 v80, v78, v79
    v_max_f32 v104, v102, v103
    v_max_f32 v128, v126, v127
    v_max_f32 v152, v150, v151
    v_mov_b32 v81, v80
    v_mov_b32 v105, v104
    v_mov_b32 v129, v128
    v_mov_b32 v153, v152
    v_permlane16_swap_b32 v80, v81
    v_permlane16_swap_b32 v104, v105
    v_permlane16_swap_b32 v128, v129
    v_permlane16_swap_b32 v152, v153
    v_max_f32 v78, v80, v81
    v_max_f32 v102, v104, v105
    v_max_f32 v126, v128, v129
    v_max_f32 v150, v152, v153
    v_mov_b32 v79, v78
    v_mov_b32 v103, v102
    v_mov_b32 v127, v126
    v_mov_b32 v151, v150
    v_permlane32_swap_b32 v78, v79
    v_permlane32_swap_b32 v102, v103
    v_permlane32_swap_b32 v126, v127
    v_permlane32_swap_b32 v150, v151
    v_pk_mul_f32 v[78:79], v[78:79], s[62:63]
    v_pk_mul_f32 v[102:103], v[102:103], s[62:63]
    v_pk_mul_f32 v[126:127], v[126:127], s[62:63]
    v_pk_mul_f32 v[150:151], v[150:151], s[62:63]
    v_pk_fma_f32 v[70:71], v[66:67], s[62:63], v[78:79] op_sel_hi:[1,1,0] neg_lo:[0,0,1] neg_hi:[0,0,1]
    v_pk_fma_f32 v[94:95], v[90:91], s[62:63], v[102:103] op_sel_hi:[1,1,0] neg_lo:[0,0,1] neg_hi:[0,0,1]
    v_pk_fma_f32 v[118:119], v[114:115], s[62:63], v[126:127] op_sel_hi:[1,1,0] neg_lo:[0,0,1] neg_hi:[0,0,1]
    v_pk_fma_f32 v[142:143], v[138:139], s[62:63], v[150:151] op_sel_hi:[1,1,0] neg_lo:[0,0,1] neg_hi:[0,0,1]
    v_pk_fma_f32 v[74:75], v[66:67], s[62:63], v[78:79] op_sel:[0,0,1] op_sel_hi:[1,1,1] neg_lo:[1,0,1] neg_hi:[1,0,1]
    v_pk_fma_f32 v[98:99], v[90:91], s[62:63], v[102:103] op_sel:[0,0,1] op_sel_hi:[1,1,1] neg_lo:[1,0,1] neg_hi:[1,0,1]
    v_pk_fma_f32 v[122:123], v[114:115], s[62:63], v[126:127] op_sel:[0,0,1] op_sel_hi:[1,1,1] neg_lo:[1,0,1] neg_hi:[1,0,1]
    v_pk_fma_f32 v[146:147], v[138:139], s[62:63], v[150:151] op_sel:[0,0,1] op_sel_hi:[1,1,1] neg_lo:[1,0,1] neg_hi:[1,0,1]
    v_pk_fma_f32 v[72:73], v[68:69], s[62:63], v[78:79] op_sel_hi:[1,1,0] neg_lo:[0,0,1] neg_hi:[0,0,1]
    v_pk_fma_f32 v[96:97], v[92:93], s[62:63], v[102:103] op_sel_hi:[1,1,0] neg_lo:[0,0,1] neg_hi:[0,0,1]
    v_pk_fma_f32 v[120:121], v[116:117], s[62:63], v[126:127] op_sel_hi:[1,1,0] neg_lo:[0,0,1] neg_hi:[0,0,1]
    v_pk_fma_f32 v[144:145], v[140:141], s[62:63], v[150:151] op_sel_hi:[1,1,0] neg_lo:[0,0,1] neg_hi:[0,0,1]
    v_pk_fma_f32 v[76:77], v[68:69], s[62:63], v[78:79] op_sel:[0,0,1] op_sel_hi:[1,1,1] neg_lo:[1,0,1] neg_hi:[1,0,1]
    v_pk_fma_f32 v[100:101], v[92:93], s[62:63], v[102:103] op_sel:[0,0,1] op_sel_hi:[1,1,1] neg_lo:[1,0,1] neg_hi:[1,0,1]
    v_pk_fma_f32 v[124:125], v[116:117], s[62:63], v[126:127] op_sel:[0,0,1] op_sel_hi:[1,1,1] neg_lo:[1,0,1] neg_hi:[1,0,1]
    v_pk_fma_f32 v[148:149], v[140:141], s[62:63], v[150:151] op_sel:[0,0,1] op_sel_hi:[1,1,1] neg_lo:[1,0,1] neg_hi:[1,0,1]
    v_exp_f32 v70, v70
    v_exp_f32 v74, v74
    v_exp_f32 v94, v94
    v_exp_f32 v98, v98
    v_exp_f32 v118, v118
    v_exp_f32 v122, v122
    v_exp_f32 v142, v142
    v_exp_f32 v146, v146
    v_exp_f32 v71, v71
    v_exp_f32 v75, v75
    v_exp_f32 v95, v95
    v_exp_f32 v99, v99
    v_exp_f32 v119, v119
    v_exp_f32 v123, v123
    v_exp_f32 v143, v143
    v_exp_f32 v147, v147
    v_exp_f32 v72, v72
    v_exp_f32 v76, v76
    v_exp_f32 v96, v96
    v_exp_f32 v100, v100
    v_exp_f32 v120, v120
    v_exp_f32 v124, v124
    v_exp_f32 v144, v144
    v_exp_f32 v148, v148
    v_exp_f32 v73, v73
    v_exp_f32 v77, v77
    v_exp_f32 v97, v97
    v_exp_f32 v101, v101
    v_exp_f32 v121, v121
    v_exp_f32 v125, v125
    v_exp_f32 v145, v145
    v_exp_f32 v149, v149
    s_nop 0
    v_pk_add_f32 v[78:79], v[70:71], v[72:73]
    v_pk_add_f32 v[80:81], v[74:75], v[76:77]
    v_pk_add_f32 v[102:103], v[94:95], v[96:97]
    v_pk_add_f32 v[104:105], v[98:99], v[100:101]
    v_pk_add_f32 v[126:127], v[118:119], v[120:121]
    v_pk_add_f32 v[128:129], v[122:123], v[124:125]
    v_pk_add_f32 v[150:151], v[142:143], v[144:145]
    v_pk_add_f32 v[152:153], v[146:147], v[148:149]
    v_add_f32 v78, v78, v79
    v_add_f32 v80, v80, v81
    v_add_f32 v102, v102, v103
    v_add_f32 v104, v104, v105
    v_add_f32 v126, v126, v127
    v_add_f32 v128, v128, v129
    v_add_f32 v150, v150, v151
    v_add_f32 v152, v152, v153
    s_nop 0
    v_mfma_f32_16x16x4_f32 v[66:69], v10, v78, 0
    v_mfma_f32_16x16x4_f32 v[82:85], v10, v80, 0
    v_mfma_f32_16x16x4_f32 v[90:93], v10, v102, 0
    v_mfma_f32_16x16x4_f32 v[106:109], v10, v104, 0
    v_mfma_f32_16x16x4_f32 v[114:117], v10, v126, 0
    v_mfma_f32_16x16x4_f32 v[130:133], v10, v128, 0
    v_mfma_f32_16x16x4_f32 v[138:141], v10, v150, 0
    v_mfma_f32_16x16x4_f32 v[154:157], v10, v152, 0
    s_nop 9
    v_rcp_f32 v78, v66
    v_rcp_f32 v80, v82
    v_rcp_f32 v102, v90
    v_rcp_f32 v104, v106
    v_rcp_f32 v126, v114
    v_rcp_f32 v128, v130
    v_rcp_f32 v150, v138
    v_rcp_f32 v152, v154
    s_nop 0
    v_pk_mul_f32 v[70:71], v[70:71], v[78:79] op_sel_hi:[1,0]
    v_pk_mul_f32 v[74:75], v[74:75], v[80:81] op_sel_hi:[1,0]
    v_pk_mul_f32 v[94:95], v[94:95], v[102:103] op_sel_hi:[1,0]
    v_pk_mul_f32 v[98:99], v[98:99], v[104:105] op_sel_hi:[1,0]
    v_pk_mul_f32 v[118:119], v[118:119], v[126:127] op_sel_hi:[1,0]
    v_pk_mul_f32 v[122:123], v[122:123], v[128:129] op_sel_hi:[1,0]
    v_pk_mul_f32 v[142:143], v[142:143], v[150:151] op_sel_hi:[1,0]
    v_pk_mul_f32 v[146:147], v[146:147], v[152:153] op_sel_hi:[1,0]
    v_pk_mul_f32 v[72:73], v[72:73], v[78:79] op_sel_hi:[1,0]
    v_pk_mul_f32 v[76:77], v[76:77], v[80:81] op_sel_hi:[1,0]
    v_pk_mul_f32 v[96:97], v[96:97], v[102:103] op_sel_hi:[1,0]
    v_pk_mul_f32 v[100:101], v[100:101], v[104:105] op_sel_hi:[1,0]
    v_pk_mul_f32 v[120:121], v[120:121], v[126:127] op_sel_hi:[1,0]
    v_pk_mul_f32 v[124:125], v[124:125], v[128:129] op_sel_hi:[1,0]
    v_pk_mul_f32 v[144:145], v[144:145], v[150:151] op_sel_hi:[1,0]
    v_pk_mul_f32 v[148:149], v[148:149], v[152:153] op_sel_hi:[1,0]
    v_cvt_pk_bf16_f32 v208, v70, v71
    v_cvt_pk_bf16_f32 v209, v72, v73
    v_cvt_pk_bf16_f32 v210, v74, v75
    v_cvt_pk_bf16_f32 v211, v76, v77
    v_cvt_pk_bf16_f32 v212, v94, v95
    v_cvt_pk_bf16_f32 v213, v96, v97
    v_cvt_pk_bf16_f32 v214, v98, v99
    v_cvt_pk_bf16_f32 v215, v100, v101
    v_cvt_pk_bf16_f32 v216, v118, v119
    v_cvt_pk_bf16_f32 v217, v120, v121
    v_cvt_pk_bf16_f32 v218, v122, v123
    v_cvt_pk_bf16_f32 v219, v124, v125
    v_cvt_pk_bf16_f32 v220, v142, v143
    v_cvt_pk_bf16_f32 v221, v144, v145
    v_cvt_pk_bf16_f32 v222, v146, v147
    v_cvt_pk_bf16_f32 v223, v148, v149
    s_nop 0
    v_mfma_f32_16x16x16_bf16 v[64:67], v[208:209], v[8:9], 0
    v_mfma_f32_16x16x16_bf16 v[68:71], v[210:211], v[8:9], 0
    v_mfma_f32_16x16x16_bf16 v[72:75], v[212:213], v[8:9], 0
    v_mfma_f32_16x16x16_bf16 v[76:79], v[214:215], v[8:9], 0
    v_mfma_f32_16x16x16_bf16 v[80:83], v[216:217], v[8:9], 0
    v_mfma_f32_16x16x16_bf16 v[84:87], v[218:219], v[8:9], 0
    v_mfma_f32_16x16x16_bf16 v[88:91], v[220:221], v[8:9], 0
    v_mfma_f32_16x16x16_bf16 v[92:95], v[222:223], v[8:9], 0
    v_cvt_pk_bf16_f32 v112, v192, v193
    v_cvt_pk_bf16_f32 v113, v194, v195
    v_cvt_pk_bf16_f32 v114, v196, v197
    v_cvt_pk_bf16_f32 v115, v198, v199
    v_cvt_pk_bf16_f32 v116, v200, v201
    v_cvt_pk_bf16_f32 v117, v202, v203
    v_cvt_pk_bf16_f32 v118, v204, v205
    v_cvt_pk_bf16_f32 v119, v206, v207
    s_nop 0
    v_cvt_pk_bf16_f32 v96, v64, v65
    v_cvt_pk_bf16_f32 v97, v66, v67
    v_cvt_pk_bf16_f32 v100, v68, v69
    v_cvt_pk_bf16_f32 v101, v70, v71
    v_cvt_pk_bf16_f32 v98, v72, v73
    v_cvt_pk_bf16_f32 v99, v74, v75
    v_cvt_pk_bf16_f32 v102, v76, v77
    v_cvt_pk_bf16_f32 v103, v78, v79
    v_cvt_pk_bf16_f32 v104, v80, v81
    v_cvt_pk_bf16_f32 v105, v82, v83
    v_cvt_pk_bf16_f32 v108, v84, v85
    v_cvt_pk_bf16_f32 v109, v86, v87
    v_cvt_pk_bf16_f32 v106, v88, v89
    v_cvt_pk_bf16_f32 v107, v90, v91
    v_cvt_pk_bf16_f32 v110, v92, v93
    v_cvt_pk_bf16_f32 v111, v94, v95
    s_nop 1
    v_mfma_f32_16x16x32_bf16 v[120:123], v[96:99], v[112:115], 0
    v_mfma_f32_16x16x32_bf16 v[136:139], v[96:99], v[12:15], 0
    v_mfma_f32_16x16x32_bf16 v[124:127], v[100:103], v[112:115], 0
    v_mfma_f32_16x16x32_bf16 v[140:143], v[100:103], v[12:15], 0
    v_mfma_f32_16x16x32_bf16 v[128:131], v[104:107], v[116:119], 0
    v_mfma_f32_16x16x32_bf16 v[144:147], v[104:107], v[12:15], 0
    v_mfma_f32_16x16x32_bf16 v[132:135], v[108:111], v[116:119], 0
    v_mfma_f32_16x16x32_bf16 v[148:151], v[108:111], v[12:15], 0
    s_nop 7
    ds_write_b128 v6, v[120:123] offset:0
    ds_write_b128 v7, v[136:139] offset:0
    ds_write_b128 v6, v[124:127] offset:16
    ds_write_b128 v7, v[140:143] offset:16
    ds_write_b128 v6, v[128:131] offset:2048
    ds_write_b128 v7, v[144:147] offset:128
    ds_write_b128 v6, v[132:135] offset:2064
    ds_write_b128 v7, v[148:151] offset:144
    s_waitcnt lgkmcnt(0)
    s_barrier
    v_lshlrev_b32 v3, 2, v0
    s_lshl_b32 s71, s66, 13
    s_add_u32 s71, s71, 12582912
    v_add_u32 v4, s71, v3
    ds_read_b32 v16, v3 offset:0
    ds_read_b32 v17, v3 offset:8704
    ds_read_b32 v18, v3 offset:17408
    ds_read_b32 v19, v3 offset:26112
    ds_read_b32 v20, v3 offset:2048
    ds_read_b32 v21, v3 offset:10752
    ds_read_b32 v22, v3 offset:19456
    ds_read_b32 v23, v3 offset:28160
    ds_read_b32 v24, v3 offset:4096
    ds_read_b32 v25, v3 offset:12800
    ds_read_b32 v26, v3 offset:21504
    ds_read_b32 v27, v3 offset:30208
    ds_read_b32 v28, v3 offset:6144
    ds_read_b32 v29, v3 offset:14848
    ds_read_b32 v30, v3 offset:23552
    ds_read_b32 v31, v3 offset:32256
    ds_read_b32 v32, v3 offset:8192
    ds_read_b32 v33, v3 offset:16896
    ds_read_b32 v34, v3 offset:25600
    ds_read_b32 v35, v3 offset:34304
    s_waitcnt lgkmcnt(0)
    v_add_f32 v16, v16, v17
    v_add_f32 v18, v18, v19
    v_add_f32 v20, v20, v21
    v_add_f32 v22, v22, v23
    v_add_f32 v24, v24, v25
    v_add_f32 v26, v26, v27
    v_add_f32 v28, v28, v29
    v_add_f32 v30, v30, v31
    v_add_f32 v32, v32, v33
    v_add_f32 v34, v34, v35
    v_add_f32 v16, v16, v18
    v_add_f32 v20, v20, v22
    v_add_f32 v24, v24, v26
    v_add_f32 v28, v28, v30
    v_add_f32 v32, v32, v34
    s_movk_i32 s72, 4096
    buffer_atomic_add_f32 v16, v4, s[24:27], 0 offen
    buffer_atomic_add_f32 v20, v4, s[24:27], 0 offen offset:2048
    buffer_atomic_add_f32 v24, v4, s[24:27], s72 offen
    buffer_atomic_add_f32 v28, v4, s[24:27], s72 offen offset:2048
    s_cmp_ge_u32 s14, 2
    s_cbranch_scc1 k1_end
    s_lshl_b32 s71, s66, 9
    s_add_u32 s71, s71, 12648448
    v_add_u32 v4, s71, v3
    buffer_atomic_add_f32 v32, v4, s[24:27], 0 offen
    s_branch k1_end
k1_gu:
    s_lshl_b32 s71, s14, 2
    s_add_u32 s71, s71, 0
    s_cmp_lt_u32 s71, 22
    s_cbranch_scc0 k1_ga0
    s_cmp_ge_u32 s71, 11
    s_cselect_b32 s36, s32, s28
    s_cselect_b32 s37, s33, s29
    s_cselect_b32 s38, s34, s30
    s_cselect_b32 s39, s35, s31
    s_cselect_b32 s72, 11, 0
    s_lshl_b32 s52, s71, 10
    s_sub_u32 s71, s71, s72
    s_lshl_b32 s71, s71, 10
    s_mov_b32 s56, 88064
    v_add_u32 v4, s71, v3
    v_mul_u32_u24 v5, 47663, v4
    v_lshrrev_b32 v5, 24, v5
    v_mul_u32_u24 v6, 352, v5
    v_sub_u32 v6, v4, v6
    v_bfe_u32 v7, v5, 2, 2
    v_lshlrev_b32 v7, 3, v7
    v_lshrrev_b32 v8, 4, v5
    v_lshl_add_u32 v7, v8, 2, v7
    v_and_b32 v8, 3, v5
    v_add_u32 v7, v7, v8
    v_mul_u32_u24 v7, 2752, v7
    v_add_u32 v7, v7, v6
    s_mul_i32 s72, s66, 352
    v_add_u32 v20, s72, v7
    s_branch k1_gb0
k1_ga0:
    s_mov_b32 s36, s24
    s_mov_b32 s37, s25
    s_mov_b32 s38, s26
    s_mov_b32 s39, s27
    s_sub_u32 s71, s71, 22
    s_lshl_b32 s52, s71, 10
    s_add_u32 s52, s52, 22528
    s_movk_i32 s56, 1024
    s_lshl_b32 s72, s68, 3
    s_add_u32 s72, s72, s71
    s_lshl_b32 s72, s72, 14
    s_cmp_lt_u32 s71, 8
    s_cselect_b32 s72, s72, 0x40000000
    v_add_u32 v20, s72, v3
    s_cselect_b32 s52, s52, 30720
    s_cselect_b32 s56, s56, 0
k1_gb0:
    s_add_u32 m0, s52, 0
    s_mul_i32 s60, s56, 0
    buffer_load_dwordx4 v20, s[36:39], s60 offen lds
    s_lshl_b32 s71, s14, 2
    s_add_u32 s71, s71, 1
    s_cmp_lt_u32 s71, 22
    s_cbranch_scc0 k1_ga1
    s_cmp_ge_u32 s71, 11
    s_cselect_b32 s40, s32, s28
    s_cselect_b32 s41, s33, s29
    s_cselect_b32 s42, s34, s30
    s_cselect_b32 s43, s35, s31
    s_cselect_b32 s72, 11, 0
    s_lshl_b32 s53, s71, 10
    s_sub_u32 s71, s71, s72
    s_lshl_b32 s71, s71, 10
    s_mov_b32 s57, 88064
    v_add_u32 v4, s71, v3
    v_mul_u32_u24 v5, 47663, v4
    v_lshrrev_b32 v5, 24, v5
    v_mul_u32_u24 v6, 352, v5
    v_sub_u32 v6, v4, v6
    v_bfe_u32 v7, v5, 2, 2
    v_lshlrev_b32 v7, 3, v7
    v_lshrrev_b32 v8, 4, v5
    v_lshl_add_u32 v7, v8, 2, v7
    v_and_b32 v8, 3, v5
    v_add_u32 v7, v7, v8
    v_mul_u32_u24 v7, 2752, v7
    v_add_u32 v7, v7, v6
    s_mul_i32 s72, s66, 352
    v_add_u32 v21, s72, v7
    s_branch k1_gb1
k1_ga1:
    s_mov_b32 s40, s24
    s_mov_b32 s41, s25
    s_mov_b32 s42, s26
    s_mov_b32 s43, s27
    s_sub_u32 s71, s71, 22
    s_lshl_b32 s53, s71, 10
    s_add_u32 s53, s53, 22528
    s_movk_i32 s57, 1024
    s_lshl_b32 s72, s68, 3
    s_add_u32 s72, s72, s71
    s_lshl_b32 s72, s72, 14
    s_cmp_lt_u32 s71, 8
    s_cselect_b32 s72, s72, 0x40000000
    v_add_u32 v21, s72, v3
    s_cselect_b32 s53, s53, 30720
    s_cselect_b32 s57, s57, 0
k1_gb1:
    s_add_u32 m0, s53, 0
    s_mul_i32 s60, s57, 0
    buffer_load_dwordx4 v21, s[40:43], s60 offen lds
    s_lshl_b32 s71, s14, 2
    s_add_u32 s71, s71, 2
    s_cmp_lt_u32 s71, 22
    s_cbranch_scc0 k1_ga2
    s_cmp_ge_u32 s71, 11
    s_cselect_b32 s44, s32, s28
    s_cselect_b32 s45, s33, s29
    s_cselect_b32 s46, s34, s30
    s_cselect_b32 s47, s35, s31
    s_cselect_b32 s72, 11, 0
    s_lshl_b32 s54, s71, 10
    s_sub_u32 s71, s71, s72
    s_lshl_b32 s71, s71, 10
    s_mov_b32 s58, 88064
    v_add_u32 v4, s71, v3
    v_mul_u32_u24 v5, 47663, v4
    v_lshrrev_b32 v5, 24, v5
    v_mul_u32_u24 v6, 352, v5
    v_sub_u32 v6, v4, v6
    v_bfe_u32 v7, v5, 2, 2
    v_lshlrev_b32 v7, 3, v7
    v_lshrrev_b32 v8, 4, v5
    v_lshl_add_u32 v7, v8, 2, v7
    v_and_b32 v8, 3, v5
    v_add_u32 v7, v7, v8
    v_mul_u32_u24 v7, 2752, v7
    v_add_u32 v7, v7, v6
    s_mul_i32 s72, s66, 352
    v_add_u32 v22, s72, v7
    s_branch k1_gb2
k1_ga2:
    s_mov_b32 s44, s24
    s_mov_b32 s45, s25
    s_mov_b32 s46, s26
    s_mov_b32 s47, s27
    s_sub_u32 s71, s71, 22
    s_lshl_b32 s54, s71, 10
    s_add_u32 s54, s54, 22528
    s_movk_i32 s58, 1024
    s_lshl_b32 s72, s68, 3
    s_add_u32 s72, s72, s71
    s_lshl_b32 s72, s72, 14
    s_cmp_lt_u32 s71, 8
    s_cselect_b32 s72, s72, 0x40000000
    v_add_u32 v22, s72, v3
    s_cselect_b32 s54, s54, 30720
    s_cselect_b32 s58, s58, 0
k1_gb2:
    s_add_u32 m0, s54, 0
    s_mul_i32 s60, s58, 0
    buffer_load_dwordx4 v22, s[44:47], s60 offen lds
    s_lshl_b32 s71, s14, 2
    s_add_u32 s71, s71, 3
    s_cmp_lt_u32 s71, 22
    s_cbranch_scc0 k1_ga3
    s_cmp_ge_u32 s71, 11
    s_cselect_b32 s48, s32, s28
    s_cselect_b32 s49, s33, s29
    s_cselect_b32 s50, s34, s30
    s_cselect_b32 s51, s35, s31
    s_cselect_b32 s72, 11, 0
    s_lshl_b32 s55, s71, 10
    s_sub_u32 s71, s71, s72
    s_lshl_b32 s71, s71, 10
    s_mov_b32 s59, 88064
    v_add_u32 v4, s71, v3
    v_mul_u32_u24 v5, 47663, v4
    v_lshrrev_b32 v5, 24, v5
    v_mul_u32_u24 v6, 352, v5
    v_sub_u32 v6, v4, v6
    v_bfe_u32 v7, v5, 2, 2
    v_lshlrev_b32 v7, 3, v7
    v_lshrrev_b32 v8, 4, v5
    v_lshl_add_u32 v7, v8, 2, v7
    v_and_b32 v8, 3, v5
    v_add_u32 v7, v7, v8
    v_mul_u32_u24 v7, 2752, v7
    v_add_u32 v7, v7, v6
    s_mul_i32 s72, s66, 352
    v_add_u32 v23, s72, v7
    s_branch k1_gb3
k1_ga3:
    s_mov_b32 s48, s24
    s_mov_b32 s49, s25
    s_mov_b32 s50, s26
    s_mov_b32 s51, s27
    s_sub_u32 s71, s71, 22
    s_lshl_b32 s55, s71, 10
    s_add_u32 s55, s55, 22528
    s_movk_i32 s59, 1024
    s_lshl_b32 s72, s68, 3
    s_add_u32 s72, s72, s71
    s_lshl_b32 s72, s72, 14
    s_cmp_lt_u32 s71, 8
    s_cselect_b32 s72, s72, 0x40000000
    v_add_u32 v23, s72, v3
    s_cselect_b32 s55, s55, 30720
    s_cselect_b32 s59, s59, 0
k1_gb3:
    s_add_u32 m0, s55, 0
    s_mul_i32 s60, s59, 0
    buffer_load_dwordx4 v23, s[48:51], s60 offen lds
    v_lshrrev_b32 v4, 2, v2
    v_mul_u32_u24 v4, 352, v4
    v_and_b32 v5, 3, v2
    v_lshl_add_u32 v4, v5, 3, v4
    s_mul_i32 s71, s70, 192
    v_add_u32 v16, s71, v4
    v_add_u32 v17, 63488, v16
    v_add_u32 v18, 126976, v16
    s_cmp_eq_u32 s70, 1
    s_cbranch_scc1 k1_gu1
    s_add_u32 m0, s52, 31744
    s_mul_i32 s60, s56, 1
    buffer_load_dwordx4 v20, s[36:39], s60 offen lds
    s_add_u32 m0, s53, 31744
    s_mul_i32 s60, s57, 1
    buffer_load_dwordx4 v21, s[40:43], s60 offen lds
    s_add_u32 m0, s54, 31744
    s_mul_i32 s60, s58, 1
    buffer_load_dwordx4 v22, s[44:47], s60 offen lds
    s_add_u32 m0, s55, 31744
    s_mul_i32 s60, s59, 1
    buffer_load_dwordx4 v23, s[48:51], s60 offen lds
    s_add_u32 m0, s52, 63488
    s_mul_i32 s60, s56, 2
    buffer_load_dwordx4 v20, s[36:39], s60 offen lds
    s_add_u32 m0, s53, 63488
    s_mul_i32 s60, s57, 2
    buffer_load_dwordx4 v21, s[40:43], s60 offen lds
    s_add_u32 m0, s54, 63488
    s_mul_i32 s60, s58, 2
    buffer_load_dwordx4 v22, s[44:47], s60 offen lds
    s_add_u32 m0, s55, 63488
    s_mul_i32 s60, s59, 2
    buffer_load_dwordx4 v23, s[48:51], s60 offen lds
    s_add_u32 m0, s52, 95232
    s_mul_i32 s60, s56, 3
    buffer_load_dwordx4 v20, s[36:39], s60 offen lds
    s_add_u32 m0, s53, 95232
    s_mul_i32 s60, s57, 3
    buffer_load_dwordx4 v21, s[40:43], s60 offen lds
    s_add_u32 m0, s54, 95232
    s_mul_i32 s60, s58, 3
    buffer_load_dwordx4 v22, s[44:47], s60 offen lds
    s_add_u32 m0, s55, 95232
    s_mul_i32 s60, s59, 3
    buffer_load_dwordx4 v23, s[48:51], s60 offen lds
    s_waitcnt vmcnt(8)
    s_barrier
    ds_read_b128 v[48:51], v27 offset:0
    ds_read_b128 v[52:55], v27 offset:1024
    ds_read_b64_tr_b16 v[32:33], v16 offset:0
    ds_read_b64_tr_b16 v[34:35], v16 offset:5632
    ds_read_b64_tr_b16 v[36:37], v16 offset:11264
    ds_read_b64_tr_b16 v[38:39], v16 offset:16896
    ds_read_b64_tr_b16 v[40:41], v16 offset:32
    ds_read_b64_tr_b16 v[42:43], v16 offset:5664
    ds_read_b64_tr_b16 v[44:45], v16 offset:11296
    ds_read_b64_tr_b16 v[46:47], v16 offset:16928
    s_waitcnt lgkmcnt(6)
    v_mfma_f32_16x16x32_bf16 v[160:163], v[32:35], v[48:51], 0
    v_mfma_f32_16x16x32_bf16 v[164:167], v[32:35], v[52:55], 0
    s_add_u32 m0, s52, 126976
    s_mul_i32 s60, s56, 4
    buffer_load_dwordx4 v20, s[36:39], s60 offen lds
    ds_read_b64_tr_b16 v[32:33], v16 offset:64
    ds_read_b64_tr_b16 v[34:35], v16 offset:5696
    s_waitcnt lgkmcnt(6)
    v_mfma_f32_16x16x32_bf16 v[168:171], v[36:39], v[48:51], 0
    v_mfma_f32_16x16x32_bf16 v[172:175], v[36:39], v[52:55], 0
    ds_read_b64_tr_b16 v[36:37], v16 offset:11328
    ds_read_b64_tr_b16 v[38:39], v16 offset:16960
    s_waitcnt lgkmcnt(6)
    v_mfma_f32_16x16x32_bf16 v[176:179], v[40:43], v[48:51], 0
    v_mfma_f32_16x16x32_bf16 v[180:183], v[40:43], v[52:55], 0
    ds_read_b64_tr_b16 v[40:41], v16 offset:96
    ds_read_b64_tr_b16 v[42:43], v16 offset:5728
    s_waitcnt lgkmcnt(6)
    v_mfma_f32_16x16x32_bf16 v[184:187], v[44:47], v[48:51], 0
    v_mfma_f32_16x16x32_bf16 v[188:191], v[44:47], v[52:55], 0
    s_add_u32 m0, s53, 126976
    s_mul_i32 s60, s57, 4
    buffer_load_dwordx4 v21, s[40:43], s60 offen lds
    ds_read_b64_tr_b16 v[44:45], v16 offset:11360
    ds_read_b64_tr_b16 v[46:47], v16 offset:16992
    s_waitcnt lgkmcnt(6)
    v_mfma_f32_16x16x32_bf16 v[192:195], v[32:35], v[48:51], 0
    v_mfma_f32_16x16x32_bf16 v[196:199], v[32:35], v[52:55], 0
    ds_read_b64_tr_b16 v[32:33], v16 offset:128
    ds_read_b64_tr_b16 v[34:35], v16 offset:5760
    s_waitcnt lgkmcnt(6)
    v_mfma_f32_16x16x32_bf16 v[200:203], v[36:39], v[48:51], 0
    v_mfma_f32_16x16x32_bf16 v[204:207], v[36:39], v[52:55], 0
    ds_read_b64_tr_b16 v[36:37], v16 offset:11392
    ds_read_b64_tr_b16 v[38:39], v16 offset:17024
    s_waitcnt lgkmcnt(6)
    v_mfma_f32_16x16x32_bf16 v[208:211], v[40:43], v[48:51], 0
    v_mfma_f32_16x16x32_bf16 v[212:215], v[40:43], v[52:55], 0
    s_add_u32 m0, s54, 126976
    s_mul_i32 s60, s58, 4
    buffer_load_dwordx4 v22, s[44:47], s60 offen lds
    ds_read_b64_tr_b16 v[40:41], v16 offset:160
    ds_read_b64_tr_b16 v[42:43], v16 offset:5792
    s_waitcnt lgkmcnt(6)
    v_mfma_f32_16x16x32_bf16 v[216:219], v[44:47], v[48:51], 0
    v_mfma_f32_16x16x32_bf16 v[220:223], v[44:47], v[52:55], 0
    ds_read_b64_tr_b16 v[44:45], v16 offset:11424
    ds_read_b64_tr_b16 v[46:47], v16 offset:17056
    s_waitcnt lgkmcnt(6)
    v_mfma_f32_16x16x32_bf16 v[224:227], v[32:35], v[48:51], 0
    v_mfma_f32_16x16x32_bf16 v[228:231], v[32:35], v[52:55], 0
    ds_read_b128 v[56:59], v27 offset:31744
    ds_read_b128 v[60:63], v27 offset:32768
    ds_read_b64_tr_b16 v[32:33], v16 offset:31744
    ds_read_b64_tr_b16 v[34:35], v16 offset:37376
    s_waitcnt lgkmcnt(8)
    v_mfma_f32_16x16x32_bf16 v[232:235], v[36:39], v[48:51], 0
    v_mfma_f32_16x16x32_bf16 v[236:239], v[36:39], v[52:55], 0
    s_add_u32 m0, s55, 126976
    s_mul_i32 s60, s59, 4
    buffer_load_dwordx4 v23, s[48:51], s60 offen lds
    ds_read_b64_tr_b16 v[36:37], v16 offset:43008
    ds_read_b64_tr_b16 v[38:39], v16 offset:48640
    s_waitcnt lgkmcnt(8)
    v_mfma_f32_16x16x32_bf16 v[240:243], v[40:43], v[48:51], 0
    v_mfma_f32_16x16x32_bf16 v[244:247], v[40:43], v[52:55], 0
    ds_read_b64_tr_b16 v[40:41], v16 offset:31776
    ds_read_b64_tr_b16 v[42:43], v16 offset:37408
    s_waitcnt lgkmcnt(8)
    v_mfma_f32_16x16x32_bf16 v[248:251], v[44:47], v[48:51], 0
    v_mfma_f32_16x16x32_bf16 v[252:255], v[44:47], v[52:55], 0
    s_waitcnt vmcnt(8)
    s_barrier
    ds_read_b64_tr_b16 v[44:45], v16 offset:43040
    ds_read_b64_tr_b16 v[46:47], v16 offset:48672
    s_waitcnt lgkmcnt(6)
    v_mfma_f32_16x16x32_bf16 v[160:163], v[32:35], v[56:59], v[160:163]
    v_mfma_f32_16x16x32_bf16 v[164:167], v[32:35], v[60:63], v[164:167]
    s_add_u32 m0, s52, 0
    s_mul_i32 s60, s56, 5
    buffer_load_dwordx4 v20, s[36:39], s60 offen lds
    ds_read_b64_tr_b16 v[32:33], v16 offset:31808
    ds_read_b64_tr_b16 v[34:35], v16 offset:37440
    s_waitcnt lgkmcnt(6)
    v_mfma_f32_16x16x32_bf16 v[168:171], v[36:39], v[56:59], v[168:171]
    v_mfma_f32_16x16x32_bf16 v[172:175], v[36:39], v[60:63], v[172:175]
    ds_read_b64_tr_b16 v[36:37], v16 offset:43072
    ds_read_b64_tr_b16 v[38:39], v16 offset:48704
    s_waitcnt lgkmcnt(6)
    v_mfma_f32_16x16x32_bf16 v[176:179], v[40:43], v[56:59], v[176:179]
    v_mfma_f32_16x16x32_bf16 v[180:183], v[40:43], v[60:63], v[180:183]
    ds_read_b64_tr_b16 v[40:41], v16 offset:31840
    ds_read_b64_tr_b16 v[42:43], v16 offset:37472
    s_waitcnt lgkmcnt(6)
    v_mfma_f32_16x16x32_bf16 v[184:187], v[44:47], v[56:59], v[184:187]
    v_mfma_f32_16x16x32_bf16 v[188:191], v[44:47], v[60:63], v[188:191]
    s_add_u32 m0, s53, 0
    s_mul_i32 s60, s57, 5
    buffer_load_dwordx4 v21, s[40:43], s60 offen lds
    ds_read_b64_tr_b16 v[44:45], v16 offset:43104
    ds_read_b64_tr_b16 v[46:47], v16 offset:48736
    s_waitcnt lgkmcnt(6)
    v_mfma_f32_16x16x32_bf16 v[192:195], v[32:35], v[56:59], v[192:195]
    v_mfma_f32_16x16x32_bf16 v[196:199], v[32:35], v[60:63], v[196:199]
    ds_read_b64_tr_b16 v[32:33], v16 offset:31872
    ds_read_b64_tr_b16 v[34:35], v16 offset:37504
    s_waitcnt lgkmcnt(6)
    v_mfma_f32_16x16x32_bf16 v[200:203], v[36:39], v[56:59], v[200:203]
    v_mfma_f32_16x16x32_bf16 v[204:207], v[36:39], v[60:63], v[204:207]
    ds_read_b64_tr_b16 v[36:37], v16 offset:43136
    ds_read_b64_tr_b16 v[38:39], v16 offset:48768
    s_waitcnt lgkmcnt(6)
    v_mfma_f32_16x16x32_bf16 v[208:211], v[40:43], v[56:59], v[208:211]
    v_mfma_f32_16x16x32_bf16 v[212:215], v[40:43], v[60:63], v[212:215]
    s_add_u32 m0, s54, 0
    s_mul_i32 s60, s58, 5
    buffer_load_dwordx4 v22, s[44:47], s60 offen lds
    ds_read_b64_tr_b16 v[40:41], v16 offset:31904
    ds_read_b64_tr_b16 v[42:43], v16 offset:37536
    s_waitcnt lgkmcnt(6)
    v_mfma_f32_16x16x32_bf16 v[216:219], v[44:47], v[56:59], v[216:219]
    v_mfma_f32_16x16x32_bf16 v[220:223], v[44:47], v[60:63], v[220:223]
    ds_read_b64_tr_b16 v[44:45], v16 offset:43168
    ds_read_b64_tr_b16 v[46:47], v16 offset:48800
    s_waitcnt lgkmcnt(6)
    v_mfma_f32_16x16x32_bf16 v[224:227], v[32:35], v[56:59], v[224:227]
    v_mfma_f32_16x16x32_bf16 v[228:231], v[32:35], v[60:63], v[228:231]
    ds_read_b128 v[48:51], v28 offset:0
    ds_read_b128 v[52:55], v28 offset:1024
    ds_read_b64_tr_b16 v[32:33], v17 offset:0
    ds_read_b64_tr_b16 v[34:35], v17 offset:5632
    s_waitcnt lgkmcnt(8)
    v_mfma_f32_16x16x32_bf16 v[232:235], v[36:39], v[56:59], v[232:235]
    v_mfma_f32_16x16x32_bf16 v[236:239], v[36:39], v[60:63], v[236:239]
    s_add_u32 m0, s55, 0
    s_mul_i32 s60, s59, 5
    buffer_load_dwordx4 v23, s[48:51], s60 offen lds
    ds_read_b64_tr_b16 v[36:37], v17 offset:11264
    ds_read_b64_tr_b16 v[38:39], v17 offset:16896
    s_waitcnt lgkmcnt(8)
    v_mfma_f32_16x16x32_bf16 v[240:243], v[40:43], v[56:59], v[240:243]
    v_mfma_f32_16x16x32_bf16 v[244:247], v[40:43], v[60:63], v[244:247]
    ds_read_b64_tr_b16 v[40:41], v17 offset:32
    ds_read_b64_tr_b16 v[42:43], v17 offset:5664
    s_waitcnt lgkmcnt(8)
    v_mfma_f32_16x16x32_bf16 v[248:251], v[44:47], v[56:59], v[248:251]
    v_mfma_f32_16x16x32_bf16 v[252:255], v[44:47], v[60:63], v[252:255]
    s_waitcnt vmcnt(8)
    s_barrier
    ds_read_b64_tr_b16 v[44:45], v17 offset:11296
    ds_read_b64_tr_b16 v[46:47], v17 offset:16928
    s_waitcnt lgkmcnt(6)
    v_mfma_f32_16x16x32_bf16 v[160:163], v[32:35], v[48:51], v[160:163]
    v_mfma_f32_16x16x32_bf16 v[164:167], v[32:35], v[52:55], v[164:167]
    s_add_u32 m0, s52, 31744
    s_mul_i32 s60, s56, 6
    buffer_load_dwordx4 v20, s[36:39], s60 offen lds
    ds_read_b64_tr_b16 v[32:33], v17 offset:64
    ds_read_b64_tr_b16 v[34:35], v17 offset:5696
    s_waitcnt lgkmcnt(6)
    v_mfma_f32_16x16x32_bf16 v[168:171], v[36:39], v[48:51], v[168:171]
    v_mfma_f32_16x16x32_bf16 v[172:175], v[36:39], v[52:55], v[172:175]
    ds_read_b64_tr_b16 v[36:37], v17 offset:11328
    ds_read_b64_tr_b16 v[38:39], v17 offset:16960
    s_waitcnt lgkmcnt(6)
    v_mfma_f32_16x16x32_bf16 v[176:179], v[40:43], v[48:51], v[176:179]
    v_mfma_f32_16x16x32_bf16 v[180:183], v[40:43], v[52:55], v[180:183]
    ds_read_b64_tr_b16 v[40:41], v17 offset:96
    ds_read_b64_tr_b16 v[42:43], v17 offset:5728
    s_waitcnt lgkmcnt(6)
    v_mfma_f32_16x16x32_bf16 v[184:187], v[44:47], v[48:51], v[184:187]
    v_mfma_f32_16x16x32_bf16 v[188:191], v[44:47], v[52:55], v[188:191]
    s_add_u32 m0, s53, 31744
    s_mul_i32 s60, s57, 6
    buffer_load_dwordx4 v21, s[40:43], s60 offen lds
    ds_read_b64_tr_b16 v[44:45], v17 offset:11360
    ds_read_b64_tr_b16 v[46:47], v17 offset:16992
    s_waitcnt lgkmcnt(6)
    v_mfma_f32_16x16x32_bf16 v[192:195], v[32:35], v[48:51], v[192:195]
    v_mfma_f32_16x16x32_bf16 v[196:199], v[32:35], v[52:55], v[196:199]
    ds_read_b64_tr_b16 v[32:33], v17 offset:128
    ds_read_b64_tr_b16 v[34:35], v17 offset:5760
    s_waitcnt lgkmcnt(6)
    v_mfma_f32_16x16x32_bf16 v[200:203], v[36:39], v[48:51], v[200:203]
    v_mfma_f32_16x16x32_bf16 v[204:207], v[36:39], v[52:55], v[204:207]
    ds_read_b64_tr_b16 v[36:37], v17 offset:11392
    ds_read_b64_tr_b16 v[38:39], v17 offset:17024
    s_waitcnt lgkmcnt(6)
    v_mfma_f32_16x16x32_bf16 v[208:211], v[40:43], v[48:51], v[208:211]
    v_mfma_f32_16x16x32_bf16 v[212:215], v[40:43], v[52:55], v[212:215]
    s_add_u32 m0, s54, 31744
    s_mul_i32 s60, s58, 6
    buffer_load_dwordx4 v22, s[44:47], s60 offen lds
    ds_read_b64_tr_b16 v[40:41], v17 offset:160
    ds_read_b64_tr_b16 v[42:43], v17 offset:5792
    s_waitcnt lgkmcnt(6)
    v_mfma_f32_16x16x32_bf16 v[216:219], v[44:47], v[48:51], v[216:219]
    v_mfma_f32_16x16x32_bf16 v[220:223], v[44:47], v[52:55], v[220:223]
    ds_read_b64_tr_b16 v[44:45], v17 offset:11424
    ds_read_b64_tr_b16 v[46:47], v17 offset:17056
    s_waitcnt lgkmcnt(6)
    v_mfma_f32_16x16x32_bf16 v[224:227], v[32:35], v[48:51], v[224:227]
    v_mfma_f32_16x16x32_bf16 v[228:231], v[32:35], v[52:55], v[228:231]
    ds_read_b128 v[56:59], v28 offset:31744
    ds_read_b128 v[60:63], v28 offset:32768
    ds_read_b64_tr_b16 v[32:33], v17 offset:31744
    ds_read_b64_tr_b16 v[34:35], v17 offset:37376
    s_waitcnt lgkmcnt(8)
    v_mfma_f32_16x16x32_bf16 v[232:235], v[36:39], v[48:51], v[232:235]
    v_mfma_f32_16x16x32_bf16 v[236:239], v[36:39], v[52:55], v[236:239]
    s_add_u32 m0, s55, 31744
    s_mul_i32 s60, s59, 6
    buffer_load_dwordx4 v23, s[48:51], s60 offen lds
    ds_read_b64_tr_b16 v[36:37], v17 offset:43008
    ds_read_b64_tr_b16 v[38:39], v17 offset:48640
    s_waitcnt lgkmcnt(8)
    v_mfma_f32_16x16x32_bf16 v[240:243], v[40:43], v[48:51], v[240:243]
    v_mfma_f32_16x16x32_bf16 v[244:247], v[40:43], v[52:55], v[244:247]
    ds_read_b64_tr_b16 v[40:41], v17 offset:31776
    ds_read_b64_tr_b16 v[42:43], v17 offset:37408
    s_waitcnt lgkmcnt(8)
    v_mfma_f32_16x16x32_bf16 v[248:251], v[44:47], v[48:51], v[248:251]
    v_mfma_f32_16x16x32_bf16 v[252:255], v[44:47], v[52:55], v[252:255]
    s_waitcnt vmcnt(8)
    s_barrier
    ds_read_b64_tr_b16 v[44:45], v17 offset:43040
    ds_read_b64_tr_b16 v[46:47], v17 offset:48672
    s_waitcnt lgkmcnt(6)
    v_mfma_f32_16x16x32_bf16 v[160:163], v[32:35], v[56:59], v[160:163]
    v_mfma_f32_16x16x32_bf16 v[164:167], v[32:35], v[60:63], v[164:167]
    s_add_u32 m0, s52, 63488
    s_mul_i32 s60, s56, 7
    buffer_load_dwordx4 v20, s[36:39], s60 offen lds
    ds_read_b64_tr_b16 v[32:33], v17 offset:31808
    ds_read_b64_tr_b16 v[34:35], v17 offset:37440
    s_waitcnt lgkmcnt(6)
    v_mfma_f32_16x16x32_bf16 v[168:171], v[36:39], v[56:59], v[168:171]
    v_mfma_f32_16x16x32_bf16 v[172:175], v[36:39], v[60:63], v[172:175]
    ds_read_b64_tr_b16 v[36:37], v17 offset:43072
    ds_read_b64_tr_b16 v[38:39], v17 offset:48704
    s_waitcnt lgkmcnt(6)
    v_mfma_f32_16x16x32_bf16 v[176:179], v[40:43], v[56:59], v[176:179]
    v_mfma_f32_16x16x32_bf16 v[180:183], v[40:43], v[60:63], v[180:183]
    ds_read_b64_tr_b16 v[40:41], v17 offset:31840
    ds_read_b64_tr_b16 v[42:43], v17 offset:37472
    s_waitcnt lgkmcnt(6)
    v_mfma_f32_16x16x32_bf16 v[184:187], v[44:47], v[56:59], v[184:187]
    v_mfma_f32_16x16x32_bf16 v[188:191], v[44:47], v[60:63], v[188:191]
    s_add_u32 m0, s53, 63488
    s_mul_i32 s60, s57, 7
    buffer_load_dwordx4 v21, s[40:43], s60 offen lds
    ds_read_b64_tr_b16 v[44:45], v17 offset:43104
    ds_read_b64_tr_b16 v[46:47], v17 offset:48736
    s_waitcnt lgkmcnt(6)
    v_mfma_f32_16x16x32_bf16 v[192:195], v[32:35], v[56:59], v[192:195]
    v_mfma_f32_16x16x32_bf16 v[196:199], v[32:35], v[60:63], v[196:199]
    ds_read_b64_tr_b16 v[32:33], v17 offset:31872
    ds_read_b64_tr_b16 v[34:35], v17 offset:37504
    s_waitcnt lgkmcnt(6)
    v_mfma_f32_16x16x32_bf16 v[200:203], v[36:39], v[56:59], v[200:203]
    v_mfma_f32_16x16x32_bf16 v[204:207], v[36:39], v[60:63], v[204:207]
    ds_read_b64_tr_b16 v[36:37], v17 offset:43136
    ds_read_b64_tr_b16 v[38:39], v17 offset:48768
    s_waitcnt lgkmcnt(6)
    v_mfma_f32_16x16x32_bf16 v[208:211], v[40:43], v[56:59], v[208:211]
    v_mfma_f32_16x16x32_bf16 v[212:215], v[40:43], v[60:63], v[212:215]
    s_add_u32 m0, s54, 63488
    s_mul_i32 s60, s58, 7
    buffer_load_dwordx4 v22, s[44:47], s60 offen lds
    ds_read_b64_tr_b16 v[40:41], v17 offset:31904
    ds_read_b64_tr_b16 v[42:43], v17 offset:37536
    s_waitcnt lgkmcnt(6)
    v_mfma_f32_16x16x32_bf16 v[216:219], v[44:47], v[56:59], v[216:219]
    v_mfma_f32_16x16x32_bf16 v[220:223], v[44:47], v[60:63], v[220:223]
    ds_read_b64_tr_b16 v[44:45], v17 offset:43168
    ds_read_b64_tr_b16 v[46:47], v17 offset:48800
    s_waitcnt lgkmcnt(6)
    v_mfma_f32_16x16x32_bf16 v[224:227], v[32:35], v[56:59], v[224:227]
    v_mfma_f32_16x16x32_bf16 v[228:231], v[32:35], v[60:63], v[228:231]
    ds_read_b128 v[48:51], v29 offset:0
    ds_read_b128 v[52:55], v29 offset:1024
    ds_read_b64_tr_b16 v[32:33], v18 offset:0
    ds_read_b64_tr_b16 v[34:35], v18 offset:5632
    s_waitcnt lgkmcnt(8)
    v_mfma_f32_16x16x32_bf16 v[232:235], v[36:39], v[56:59], v[232:235]
    v_mfma_f32_16x16x32_bf16 v[236:239], v[36:39], v[60:63], v[236:239]
    s_add_u32 m0, s55, 63488
    s_mul_i32 s60, s59, 7
    buffer_load_dwordx4 v23, s[48:51], s60 offen lds
    ds_read_b64_tr_b16 v[36:37], v18 offset:11264
    ds_read_b64_tr_b16 v[38:39], v18 offset:16896
    s_waitcnt lgkmcnt(8)
    v_mfma_f32_16x16x32_bf16 v[240:243], v[40:43], v[56:59], v[240:243]
    v_mfma_f32_16x16x32_bf16 v[244:247], v[40:43], v[60:63], v[244:247]
    ds_read_b64_tr_b16 v[40:41], v18 offset:32
    ds_read_b64_tr_b16 v[42:43], v18 offset:5664
    s_waitcnt lgkmcnt(8)
    v_mfma_f32_16x16x32_bf16 v[248:251], v[44:47], v[56:59], v[248:251]
    v_mfma_f32_16x16x32_bf16 v[252:255], v[44:47], v[60:63], v[252:255]
    s_waitcnt vmcnt(8)
    s_barrier
    ds_read_b64_tr_b16 v[44:45], v18 offset:11296
    ds_read_b64_tr_b16 v[46:47], v18 offset:16928
    s_waitcnt lgkmcnt(6)
    v_mfma_f32_16x16x32_bf16 v[160:163], v[32:35], v[48:51], v[160:163]
    v_mfma_f32_16x16x32_bf16 v[164:167], v[32:35], v[52:55], v[164:167]
    s_add_u32 m0, s52, 95232
    s_mul_i32 s60, s56, 8
    buffer_load_dwordx4 v20, s[36:39], s60 offen lds
    ds_read_b64_tr_b16 v[32:33], v18 offset:64
    ds_read_b64_tr_b16 v[34:35], v18 offset:5696
    s_waitcnt lgkmcnt(6)
    v_mfma_f32_16x16x32_bf16 v[168:171], v[36:39], v[48:51], v[168:171]
    v_mfma_f32_16x16x32_bf16 v[172:175], v[36:39], v[52:55], v[172:175]
    ds_read_b64_tr_b16 v[36:37], v18 offset:11328
    ds_read_b64_tr_b16 v[38:39], v18 offset:16960
    s_waitcnt lgkmcnt(6)
    v_mfma_f32_16x16x32_bf16 v[176:179], v[40:43], v[48:51], v[176:179]
    v_mfma_f32_16x16x32_bf16 v[180:183], v[40:43], v[52:55], v[180:183]
    ds_read_b64_tr_b16 v[40:41], v18 offset:96
    ds_read_b64_tr_b16 v[42:43], v18 offset:5728
    s_waitcnt lgkmcnt(6)
    v_mfma_f32_16x16x32_bf16 v[184:187], v[44:47], v[48:51], v[184:187]
    v_mfma_f32_16x16x32_bf16 v[188:191], v[44:47], v[52:55], v[188:191]
    s_add_u32 m0, s53, 95232
    s_mul_i32 s60, s57, 8
    buffer_load_dwordx4 v21, s[40:43], s60 offen lds
    ds_read_b64_tr_b16 v[44:45], v18 offset:11360
    ds_read_b64_tr_b16 v[46:47], v18 offset:16992
    s_waitcnt lgkmcnt(6)
    v_mfma_f32_16x16x32_bf16 v[192:195], v[32:35], v[48:51], v[192:195]
    v_mfma_f32_16x16x32_bf16 v[196:199], v[32:35], v[52:55], v[196:199]
    ds_read_b64_tr_b16 v[32:33], v18 offset:128
    ds_read_b64_tr_b16 v[34:35], v18 offset:5760
    s_waitcnt lgkmcnt(6)
    v_mfma_f32_16x16x32_bf16 v[200:203], v[36:39], v[48:51], v[200:203]
    v_mfma_f32_16x16x32_bf16 v[204:207], v[36:39], v[52:55], v[204:207]
    ds_read_b64_tr_b16 v[36:37], v18 offset:11392
    ds_read_b64_tr_b16 v[38:39], v18 offset:17024
    s_waitcnt lgkmcnt(6)
    v_mfma_f32_16x16x32_bf16 v[208:211], v[40:43], v[48:51], v[208:211]
    v_mfma_f32_16x16x32_bf16 v[212:215], v[40:43], v[52:55], v[212:215]
    s_add_u32 m0, s54, 95232
    s_mul_i32 s60, s58, 8
    buffer_load_dwordx4 v22, s[44:47], s60 offen lds
    ds_read_b64_tr_b16 v[40:41], v18 offset:160
    ds_read_b64_tr_b16 v[42:43], v18 offset:5792
    s_waitcnt lgkmcnt(6)
    v_mfma_f32_16x16x32_bf16 v[216:219], v[44:47], v[48:51], v[216:219]
    v_mfma_f32_16x16x32_bf16 v[220:223], v[44:47], v[52:55], v[220:223]
    ds_read_b64_tr_b16 v[44:45], v18 offset:11424
    ds_read_b64_tr_b16 v[46:47], v18 offset:17056
    s_waitcnt lgkmcnt(6)
    v_mfma_f32_16x16x32_bf16 v[224:227], v[32:35], v[48:51], v[224:227]
    v_mfma_f32_16x16x32_bf16 v[228:231], v[32:35], v[52:55], v[228:231]
    ds_read_b128 v[56:59], v27 offset:0
    ds_read_b128 v[60:63], v27 offset:1024
    ds_read_b64_tr_b16 v[32:33], v16 offset:0
    ds_read_b64_tr_b16 v[34:35], v16 offset:5632
    s_waitcnt lgkmcnt(8)
    v_mfma_f32_16x16x32_bf16 v[232:235], v[36:39], v[48:51], v[232:235]
    v_mfma_f32_16x16x32_bf16 v[236:239], v[36:39], v[52:55], v[236:239]
    s_add_u32 m0, s55, 95232
    s_mul_i32 s60, s59, 8
    buffer_load_dwordx4 v23, s[48:51], s60 offen lds
    ds_read_b64_tr_b16 v[36:37], v16 offset:11264
    ds_read_b64_tr_b16 v[38:39], v16 offset:16896
    s_waitcnt lgkmcnt(8)
    v_mfma_f32_16x16x32_bf16 v[240:243], v[40:43], v[48:51], v[240:243]
    v_mfma_f32_16x16x32_bf16 v[244:247], v[40:43], v[52:55], v[244:247]
    ds_read_b64_tr_b16 v[40:41], v16 offset:32
    ds_read_b64_tr_b16 v[42:43], v16 offset:5664
    s_waitcnt lgkmcnt(8)
    v_mfma_f32_16x16x32_bf16 v[248:251], v[44:47], v[48:51], v[248:251]
    v_mfma_f32_16x16x32_bf16 v[252:255], v[44:47], v[52:55], v[252:255]
    s_waitcnt vmcnt(8)
    s_barrier
    ds_read_b64_tr_b16 v[44:45], v16 offset:11296
    ds_read_b64_tr_b16 v[46:47], v16 offset:16928
    s_waitcnt lgkmcnt(6)
    v_mfma_f32_16x16x32_bf16 v[160:163], v[32:35], v[56:59], v[160:163]
    v_mfma_f32_16x16x32_bf16 v[164:167], v[32:35], v[60:63], v[164:167]
    s_add_u32 m0, s52, 126976
    s_mul_i32 s60, s56, 9
    buffer_load_dwordx4 v20, s[36:39], s60 offen lds
    ds_read_b64_tr_b16 v[32:33], v16 offset:64
    ds_read_b64_tr_b16 v[34:35], v16 offset:5696
    s_waitcnt lgkmcnt(6)
    v_mfma_f32_16x16x32_bf16 v[168:171], v[36:39], v[56:59], v[168:171]
    v_mfma_f32_16x16x32_bf16 v[172:175], v[36:39], v[60:63], v[172:175]
    ds_read_b64_tr_b16 v[36:37], v16 offset:11328
    ds_read_b64_tr_b16 v[38:39], v16 offset:16960
    s_waitcnt lgkmcnt(6)
    v_mfma_f32_16x16x32_bf16 v[176:179], v[40:43], v[56:59], v[176:179]
    v_mfma_f32_16x16x32_bf16 v[180:183], v[40:43], v[60:63], v[180:183]
    ds_read_b64_tr_b16 v[40:41], v16 offset:96
    ds_read_b64_tr_b16 v[42:43], v16 offset:5728
    s_waitcnt lgkmcnt(6)
    v_mfma_f32_16x16x32_bf16 v[184:187], v[44:47], v[56:59], v[184:187]
    v_mfma_f32_16x16x32_bf16 v[188:191], v[44:47], v[60:63], v[188:191]
    s_add_u32 m0, s53, 126976
    s_mul_i32 s60, s57, 9
    buffer_load_dwordx4 v21, s[40:43], s60 offen lds
    ds_read_b64_tr_b16 v[44:45], v16 offset:11360
    ds_read_b64_tr_b16 v[46:47], v16 offset:16992
    s_waitcnt lgkmcnt(6)
    v_mfma_f32_16x16x32_bf16 v[192:195], v[32:35], v[56:59], v[192:195]
    v_mfma_f32_16x16x32_bf16 v[196:199], v[32:35], v[60:63], v[196:199]
    ds_read_b64_tr_b16 v[32:33], v16 offset:128
    ds_read_b64_tr_b16 v[34:35], v16 offset:5760
    s_waitcnt lgkmcnt(6)
    v_mfma_f32_16x16x32_bf16 v[200:203], v[36:39], v[56:59], v[200:203]
    v_mfma_f32_16x16x32_bf16 v[204:207], v[36:39], v[60:63], v[204:207]
    ds_read_b64_tr_b16 v[36:37], v16 offset:11392
    ds_read_b64_tr_b16 v[38:39], v16 offset:17024
    s_waitcnt lgkmcnt(6)
    v_mfma_f32_16x16x32_bf16 v[208:211], v[40:43], v[56:59], v[208:211]
    v_mfma_f32_16x16x32_bf16 v[212:215], v[40:43], v[60:63], v[212:215]
    s_add_u32 m0, s54, 126976
    s_mul_i32 s60, s58, 9
    buffer_load_dwordx4 v22, s[44:47], s60 offen lds
    ds_read_b64_tr_b16 v[40:41], v16 offset:160
    ds_read_b64_tr_b16 v[42:43], v16 offset:5792
    s_waitcnt lgkmcnt(6)
    v_mfma_f32_16x16x32_bf16 v[216:219], v[44:47], v[56:59], v[216:219]
    v_mfma_f32_16x16x32_bf16 v[220:223], v[44:47], v[60:63], v[220:223]
    ds_read_b64_tr_b16 v[44:45], v16 offset:11424
    ds_read_b64_tr_b16 v[46:47], v16 offset:17056
    s_waitcnt lgkmcnt(6)
    v_mfma_f32_16x16x32_bf16 v[224:227], v[32:35], v[56:59], v[224:227]
    v_mfma_f32_16x16x32_bf16 v[228:231], v[32:35], v[60:63], v[228:231]
    ds_read_b128 v[48:51], v27 offset:31744
    ds_read_b128 v[52:55], v27 offset:32768
    ds_read_b64_tr_b16 v[32:33], v16 offset:31744
    ds_read_b64_tr_b16 v[34:35], v16 offset:37376
    s_waitcnt lgkmcnt(8)
    v_mfma_f32_16x16x32_bf16 v[232:235], v[36:39], v[56:59], v[232:235]
    v_mfma_f32_16x16x32_bf16 v[236:239], v[36:39], v[60:63], v[236:239]
    s_add_u32 m0, s55, 126976
    s_mul_i32 s60, s59, 9
    buffer_load_dwordx4 v23, s[48:51], s60 offen lds
    ds_read_b64_tr_b16 v[36:37], v16 offset:43008
    ds_read_b64_tr_b16 v[38:39], v16 offset:48640
    s_waitcnt lgkmcnt(8)
    v_mfma_f32_16x16x32_bf16 v[240:243], v[40:43], v[56:59], v[240:243]
    v_mfma_f32_16x16x32_bf16 v[244:247], v[40:43], v[60:63], v[244:247]
    ds_read_b64_tr_b16 v[40:41], v16 offset:31776
    ds_read_b64_tr_b16 v[42:43], v16 offset:37408
    s_waitcnt lgkmcnt(8)
    v_mfma_f32_16x16x32_bf16 v[248:251], v[44:47], v[56:59], v[248:251]
    v_mfma_f32_16x16x32_bf16 v[252:255], v[44:47], v[60:63], v[252:255]
    s_waitcnt vmcnt(8)
    s_barrier
    ds_read_b64_tr_b16 v[44:45], v16 offset:43040
    ds_read_b64_tr_b16 v[46:47], v16 offset:48672
    s_waitcnt lgkmcnt(6)
    v_mfma_f32_16x16x32_bf16 v[160:163], v[32:35], v[48:51], v[160:163]
    v_mfma_f32_16x16x32_bf16 v[164:167], v[32:35], v[52:55], v[164:167]
    s_add_u32 m0, s52, 0
    s_mul_i32 s60, s56, 10
    buffer_load_dwordx4 v20, s[36:39], s60 offen lds
    ds_read_b64_tr_b16 v[32:33], v16 offset:31808
    ds_read_b64_tr_b16 v[34:35], v16 offset:37440
    s_waitcnt lgkmcnt(6)
    v_mfma_f32_16x16x32_bf16 v[168:171], v[36:39], v[48:51], v[168:171]
    v_mfma_f32_16x16x32_bf16 v[172:175], v[36:39], v[52:55], v[172:175]
    ds_read_b64_tr_b16 v[36:37], v16 offset:43072
    ds_read_b64_tr_b16 v[38:39], v16 offset:48704
    s_waitcnt lgkmcnt(6)
    v_mfma_f32_16x16x32_bf16 v[176:179], v[40:43], v[48:51], v[176:179]
    v_mfma_f32_16x16x32_bf16 v[180:183], v[40:43], v[52:55], v[180:183]
    ds_read_b64_tr_b16 v[40:41], v16 offset:31840
    ds_read_b64_tr_b16 v[42:43], v16 offset:37472
    s_waitcnt lgkmcnt(6)
    v_mfma_f32_16x16x32_bf16 v[184:187], v[44:47], v[48:51], v[184:187]
    v_mfma_f32_16x16x32_bf16 v[188:191], v[44:47], v[52:55], v[188:191]
    s_add_u32 m0, s53, 0
    s_mul_i32 s60, s57, 10
    buffer_load_dwordx4 v21, s[40:43], s60 offen lds
    ds_read_b64_tr_b16 v[44:45], v16 offset:43104
    ds_read_b64_tr_b16 v[46:47], v16 offset:48736
    s_waitcnt lgkmcnt(6)
    v_mfma_f32_16x16x32_bf16 v[192:195], v[32:35], v[48:51], v[192:195]
    v_mfma_f32_16x16x32_bf16 v[196:199], v[32:35], v[52:55], v[196:199]
    ds_read_b64_tr_b16 v[32:33], v16 offset:31872
    ds_read_b64_tr_b16 v[34:35], v16 offset:37504
    s_waitcnt lgkmcnt(6)
    v_mfma_f32_16x16x32_bf16 v[200:203], v[36:39], v[48:51], v[200:203]
    v_mfma_f32_16x16x32_bf16 v[204:207], v[36:39], v[52:55], v[204:207]
    ds_read_b64_tr_b16 v[36:37], v16 offset:43136
    ds_read_b64_tr_b16 v[38:39], v16 offset:48768
    s_waitcnt lgkmcnt(6)
    v_mfma_f32_16x16x32_bf16 v[208:211], v[40:43], v[48:51], v[208:211]
    v_mfma_f32_16x16x32_bf16 v[212:215], v[40:43], v[52:55], v[212:215]
    s_add_u32 m0, s54, 0
    s_mul_i32 s60, s58, 10
    buffer_load_dwordx4 v22, s[44:47], s60 offen lds
    ds_read_b64_tr_b16 v[40:41], v16 offset:31904
    ds_read_b64_tr_b16 v[42:43], v16 offset:37536
    s_waitcnt lgkmcnt(6)
    v_mfma_f32_16x16x32_bf16 v[216:219], v[44:47], v[48:51], v[216:219]
    v_mfma_f32_16x16x32_bf16 v[220:223], v[44:47], v[52:55], v[220:223]
    ds_read_b64_tr_b16 v[44:45], v16 offset:43168
    ds_read_b64_tr_b16 v[46:47], v16 offset:48800
    s_waitcnt lgkmcnt(6)
    v_mfma_f32_16x16x32_bf16 v[224:227], v[32:35], v[48:51], v[224:227]
    v_mfma_f32_16x16x32_bf16 v[228:231], v[32:35], v[52:55], v[228:231]
    ds_read_b128 v[56:59], v28 offset:0
    ds_read_b128 v[60:63], v28 offset:1024
    ds_read_b64_tr_b16 v[32:33], v17 offset:0
    ds_read_b64_tr_b16 v[34:35], v17 offset:5632
    s_waitcnt lgkmcnt(8)
    v_mfma_f32_16x16x32_bf16 v[232:235], v[36:39], v[48:51], v[232:235]
    v_mfma_f32_16x16x32_bf16 v[236:239], v[36:39], v[52:55], v[236:239]
    s_add_u32 m0, s55, 0
    s_mul_i32 s60, s59, 10
    buffer_load_dwordx4 v23, s[48:51], s60 offen lds
    ds_read_b64_tr_b16 v[36:37], v17 offset:11264
    ds_read_b64_tr_b16 v[38:39], v17 offset:16896
    s_waitcnt lgkmcnt(8)
    v_mfma_f32_16x16x32_bf16 v[240:243], v[40:43], v[48:51], v[240:243]
    v_mfma_f32_16x16x32_bf16 v[244:247], v[40:43], v[52:55], v[244:247]
    ds_read_b64_tr_b16 v[40:41], v17 offset:32
    ds_read_b64_tr_b16 v[42:43], v17 offset:5664
    s_waitcnt lgkmcnt(8)
    v_mfma_f32_16x16x32_bf16 v[248:251], v[44:47], v[48:51], v[248:251]
    v_mfma_f32_16x16x32_bf16 v[252:255], v[44:47], v[52:55], v[252:255]
    s_waitcnt vmcnt(8)
    s_barrier
    ds_read_b64_tr_b16 v[44:45], v17 offset:11296
    ds_read_b64_tr_b16 v[46:47], v17 offset:16928
    s_waitcnt lgkmcnt(6)
    v_mfma_f32_16x16x32_bf16 v[160:163], v[32:35], v[56:59], v[160:163]
    v_mfma_f32_16x16x32_bf16 v[164:167], v[32:35], v[60:63], v[164:167]
    s_add_u32 m0, s52, 31744
    s_mul_i32 s60, s56, 11
    buffer_load_dwordx4 v20, s[36:39], s60 offen lds
    ds_read_b64_tr_b16 v[32:33], v17 offset:64
    ds_read_b64_tr_b16 v[34:35], v17 offset:5696
    s_waitcnt lgkmcnt(6)
    v_mfma_f32_16x16x32_bf16 v[168:171], v[36:39], v[56:59], v[168:171]
    v_mfma_f32_16x16x32_bf16 v[172:175], v[36:39], v[60:63], v[172:175]
    ds_read_b64_tr_b16 v[36:37], v17 offset:11328
    ds_read_b64_tr_b16 v[38:39], v17 offset:16960
    s_waitcnt lgkmcnt(6)
    v_mfma_f32_16x16x32_bf16 v[176:179], v[40:43], v[56:59], v[176:179]
    v_mfma_f32_16x16x32_bf16 v[180:183], v[40:43], v[60:63], v[180:183]
    ds_read_b64_tr_b16 v[40:41], v17 offset:96
    ds_read_b64_tr_b16 v[42:43], v17 offset:5728
    s_waitcnt lgkmcnt(6)
    v_mfma_f32_16x16x32_bf16 v[184:187], v[44:47], v[56:59], v[184:187]
    v_mfma_f32_16x16x32_bf16 v[188:191], v[44:47], v[60:63], v[188:191]
    s_add_u32 m0, s53, 31744
    s_mul_i32 s60, s57, 11
    buffer_load_dwordx4 v21, s[40:43], s60 offen lds
    ds_read_b64_tr_b16 v[44:45], v17 offset:11360
    ds_read_b64_tr_b16 v[46:47], v17 offset:16992
    s_waitcnt lgkmcnt(6)
    v_mfma_f32_16x16x32_bf16 v[192:195], v[32:35], v[56:59], v[192:195]
    v_mfma_f32_16x16x32_bf16 v[196:199], v[32:35], v[60:63], v[196:199]
    ds_read_b64_tr_b16 v[32:33], v17 offset:128
    ds_read_b64_tr_b16 v[34:35], v17 offset:5760
    s_waitcnt lgkmcnt(6)
    v_mfma_f32_16x16x32_bf16 v[200:203], v[36:39], v[56:59], v[200:203]
    v_mfma_f32_16x16x32_bf16 v[204:207], v[36:39], v[60:63], v[204:207]
    ds_read_b64_tr_b16 v[36:37], v17 offset:11392
    ds_read_b64_tr_b16 v[38:39], v17 offset:17024
    s_waitcnt lgkmcnt(6)
    v_mfma_f32_16x16x32_bf16 v[208:211], v[40:43], v[56:59], v[208:211]
    v_mfma_f32_16x16x32_bf16 v[212:215], v[40:43], v[60:63], v[212:215]
    s_add_u32 m0, s54, 31744
    s_mul_i32 s60, s58, 11
    buffer_load_dwordx4 v22, s[44:47], s60 offen lds
    ds_read_b64_tr_b16 v[40:41], v17 offset:160
    ds_read_b64_tr_b16 v[42:43], v17 offset:5792
    s_waitcnt lgkmcnt(6)
    v_mfma_f32_16x16x32_bf16 v[216:219], v[44:47], v[56:59], v[216:219]
    v_mfma_f32_16x16x32_bf16 v[220:223], v[44:47], v[60:63], v[220:223]
    ds_read_b64_tr_b16 v[44:45], v17 offset:11424
    ds_read_b64_tr_b16 v[46:47], v17 offset:17056
    s_waitcnt lgkmcnt(6)
    v_mfma_f32_16x16x32_bf16 v[224:227], v[32:35], v[56:59], v[224:227]
    v_mfma_f32_16x16x32_bf16 v[228:231], v[32:35], v[60:63], v[228:231]
    ds_read_b128 v[48:51], v28 offset:31744
    ds_read_b128 v[52:55], v28 offset:32768
    ds_read_b64_tr_b16 v[32:33], v17 offset:31744
    ds_read_b64_tr_b16 v[34:35], v17 offset:37376
    s_waitcnt lgkmcnt(8)
    v_mfma_f32_16x16x32_bf16 v[232:235], v[36:39], v[56:59], v[232:235]
    v_mfma_f32_16x16x32_bf16 v[236:239], v[36:39], v[60:63], v[236:239]
    s_add_u32 m0, s55, 31744
    s_mul_i32 s60, s59, 11
    buffer_load_dwordx4 v23, s[48:51], s60 offen lds
    ds_read_b64_tr_b16 v[36:37], v17 offset:43008
    ds_read_b64_tr_b16 v[38:39], v17 offset:48640
    s_waitcnt lgkmcnt(8)
    v_mfma_f32_16x16x32_bf16 v[240:243], v[40:43], v[56:59], v[240:243]
    v_mfma_f32_16x16x32_bf16 v[244:247], v[40:43], v[60:63], v[244:247]
    ds_read_b64_tr_b16 v[40:41], v17 offset:31776
    ds_read_b64_tr_b16 v[42:43], v17 offset:37408
    s_waitcnt lgkmcnt(8)
    v_mfma_f32_16x16x32_bf16 v[248:251], v[44:47], v[56:59], v[248:251]
    v_mfma_f32_16x16x32_bf16 v[252:255], v[44:47], v[60:63], v[252:255]
    s_waitcnt vmcnt(8)
    s_barrier
    ds_read_b64_tr_b16 v[44:45], v17 offset:43040
    ds_read_b64_tr_b16 v[46:47], v17 offset:48672
    s_waitcnt lgkmcnt(6)
    v_mfma_f32_16x16x32_bf16 v[160:163], v[32:35], v[48:51], v[160:163]
    v_mfma_f32_16x16x32_bf16 v[164:167], v[32:35], v[52:55], v[164:167]
    s_add_u32 m0, s52, 63488
    s_mul_i32 s60, s56, 12
    buffer_load_dwordx4 v20, s[36:39], s60 offen lds
    ds_read_b64_tr_b16 v[32:33], v17 offset:31808
    ds_read_b64_tr_b16 v[34:35], v17 offset:37440
    s_waitcnt lgkmcnt(6)
    v_mfma_f32_16x16x32_bf16 v[168:171], v[36:39], v[48:51], v[168:171]
    v_mfma_f32_16x16x32_bf16 v[172:175], v[36:39], v[52:55], v[172:175]
    ds_read_b64_tr_b16 v[36:37], v17 offset:43072
    ds_read_b64_tr_b16 v[38:39], v17 offset:48704
    s_waitcnt lgkmcnt(6)
    v_mfma_f32_16x16x32_bf16 v[176:179], v[40:43], v[48:51], v[176:179]
    v_mfma_f32_16x16x32_bf16 v[180:183], v[40:43], v[52:55], v[180:183]
    ds_read_b64_tr_b16 v[40:41], v17 offset:31840
    ds_read_b64_tr_b16 v[42:43], v17 offset:37472
    s_waitcnt lgkmcnt(6)
    v_mfma_f32_16x16x32_bf16 v[184:187], v[44:47], v[48:51], v[184:187]
    v_mfma_f32_16x16x32_bf16 v[188:191], v[44:47], v[52:55], v[188:191]
    s_add_u32 m0, s53, 63488
    s_mul_i32 s60, s57, 12
    buffer_load_dwordx4 v21, s[40:43], s60 offen lds
    ds_read_b64_tr_b16 v[44:45], v17 offset:43104
    ds_read_b64_tr_b16 v[46:47], v17 offset:48736
    s_waitcnt lgkmcnt(6)
    v_mfma_f32_16x16x32_bf16 v[192:195], v[32:35], v[48:51], v[192:195]
    v_mfma_f32_16x16x32_bf16 v[196:199], v[32:35], v[52:55], v[196:199]
    ds_read_b64_tr_b16 v[32:33], v17 offset:31872
    ds_read_b64_tr_b16 v[34:35], v17 offset:37504
    s_waitcnt lgkmcnt(6)
    v_mfma_f32_16x16x32_bf16 v[200:203], v[36:39], v[48:51], v[200:203]
    v_mfma_f32_16x16x32_bf16 v[204:207], v[36:39], v[52:55], v[204:207]
    ds_read_b64_tr_b16 v[36:37], v17 offset:43136
    ds_read_b64_tr_b16 v[38:39], v17 offset:48768
    s_waitcnt lgkmcnt(6)
    v_mfma_f32_16x16x32_bf16 v[208:211], v[40:43], v[48:51], v[208:211]
    v_mfma_f32_16x16x32_bf16 v[212:215], v[40:43], v[52:55], v[212:215]
    s_add_u32 m0, s54, 63488
    s_mul_i32 s60, s58, 12
    buffer_load_dwordx4 v22, s[44:47], s60 offen lds
    ds_read_b64_tr_b16 v[40:41], v17 offset:31904
    ds_read_b64_tr_b16 v[42:43], v17 offset:37536
    s_waitcnt lgkmcnt(6)
    v_mfma_f32_16x16x32_bf16 v[216:219], v[44:47], v[48:51], v[216:219]
    v_mfma_f32_16x16x32_bf16 v[220:223], v[44:47], v[52:55], v[220:223]
    ds_read_b64_tr_b16 v[44:45], v17 offset:43168
    ds_read_b64_tr_b16 v[46:47], v17 offset:48800
    s_waitcnt lgkmcnt(6)
    v_mfma_f32_16x16x32_bf16 v[224:227], v[32:35], v[48:51], v[224:227]
    v_mfma_f32_16x16x32_bf16 v[228:231], v[32:35], v[52:55], v[228:231]
    ds_read_b128 v[56:59], v29 offset:0
    ds_read_b128 v[60:63], v29 offset:1024
    ds_read_b64_tr_b16 v[32:33], v18 offset:0
    ds_read_b64_tr_b16 v[34:35], v18 offset:5632
    s_waitcnt lgkmcnt(8)
    v_mfma_f32_16x16x32_bf16 v[232:235], v[36:39], v[48:51], v[232:235]
    v_mfma_f32_16x16x32_bf16 v[236:239], v[36:39], v[52:55], v[236:239]
    s_add_u32 m0, s55, 63488
    s_mul_i32 s60, s59, 12
    buffer_load_dwordx4 v23, s[48:51], s60 offen lds
    ds_read_b64_tr_b16 v[36:37], v18 offset:11264
    ds_read_b64_tr_b16 v[38:39], v18 offset:16896
    s_waitcnt lgkmcnt(8)
    v_mfma_f32_16x16x32_bf16 v[240:243], v[40:43], v[48:51], v[240:243]
    v_mfma_f32_16x16x32_bf16 v[244:247], v[40:43], v[52:55], v[244:247]
    ds_read_b64_tr_b16 v[40:41], v18 offset:32
    ds_read_b64_tr_b16 v[42:43], v18 offset:5664
    s_waitcnt lgkmcnt(8)
    v_mfma_f32_16x16x32_bf16 v[248:251], v[44:47], v[48:51], v[248:251]
    v_mfma_f32_16x16x32_bf16 v[252:255], v[44:47], v[52:55], v[252:255]
    s_waitcnt vmcnt(8)
    s_barrier
    ds_read_b64_tr_b16 v[44:45], v18 offset:11296
    ds_read_b64_tr_b16 v[46:47], v18 offset:16928
    s_waitcnt lgkmcnt(6)
    v_mfma_f32_16x16x32_bf16 v[160:163], v[32:35], v[56:59], v[160:163]
    v_mfma_f32_16x16x32_bf16 v[164:167], v[32:35], v[60:63], v[164:167]
    s_add_u32 m0, s52, 95232
    s_mul_i32 s60, s56, 13
    buffer_load_dwordx4 v20, s[36:39], s60 offen lds
    ds_read_b64_tr_b16 v[32:33], v18 offset:64
    ds_read_b64_tr_b16 v[34:35], v18 offset:5696
    s_waitcnt lgkmcnt(6)
    v_mfma_f32_16x16x32_bf16 v[168:171], v[36:39], v[56:59], v[168:171]
    v_mfma_f32_16x16x32_bf16 v[172:175], v[36:39], v[60:63], v[172:175]
    ds_read_b64_tr_b16 v[36:37], v18 offset:11328
    ds_read_b64_tr_b16 v[38:39], v18 offset:16960
    s_waitcnt lgkmcnt(6)
    v_mfma_f32_16x16x32_bf16 v[176:179], v[40:43], v[56:59], v[176:179]
    v_mfma_f32_16x16x32_bf16 v[180:183], v[40:43], v[60:63], v[180:183]
    ds_read_b64_tr_b16 v[40:41], v18 offset:96
    ds_read_b64_tr_b16 v[42:43], v18 offset:5728
    s_waitcnt lgkmcnt(6)
    v_mfma_f32_16x16x32_bf16 v[184:187], v[44:47], v[56:59], v[184:187]
    v_mfma_f32_16x16x32_bf16 v[188:191], v[44:47], v[60:63], v[188:191]
    s_add_u32 m0, s53, 95232
    s_mul_i32 s60, s57, 13
    buffer_load_dwordx4 v21, s[40:43], s60 offen lds
    ds_read_b64_tr_b16 v[44:45], v18 offset:11360
    ds_read_b64_tr_b16 v[46:47], v18 offset:16992
    s_waitcnt lgkmcnt(6)
    v_mfma_f32_16x16x32_bf16 v[192:195], v[32:35], v[56:59], v[192:195]
    v_mfma_f32_16x16x32_bf16 v[196:199], v[32:35], v[60:63], v[196:199]
    ds_read_b64_tr_b16 v[32:33], v18 offset:128
    ds_read_b64_tr_b16 v[34:35], v18 offset:5760
    s_waitcnt lgkmcnt(6)
    v_mfma_f32_16x16x32_bf16 v[200:203], v[36:39], v[56:59], v[200:203]
    v_mfma_f32_16x16x32_bf16 v[204:207], v[36:39], v[60:63], v[204:207]
    ds_read_b64_tr_b16 v[36:37], v18 offset:11392
    ds_read_b64_tr_b16 v[38:39], v18 offset:17024
    s_waitcnt lgkmcnt(6)
    v_mfma_f32_16x16x32_bf16 v[208:211], v[40:43], v[56:59], v[208:211]
    v_mfma_f32_16x16x32_bf16 v[212:215], v[40:43], v[60:63], v[212:215]
    s_add_u32 m0, s54, 95232
    s_mul_i32 s60, s58, 13
    buffer_load_dwordx4 v22, s[44:47], s60 offen lds
    ds_read_b64_tr_b16 v[40:41], v18 offset:160
    ds_read_b64_tr_b16 v[42:43], v18 offset:5792
    s_waitcnt lgkmcnt(6)
    v_mfma_f32_16x16x32_bf16 v[216:219], v[44:47], v[56:59], v[216:219]
    v_mfma_f32_16x16x32_bf16 v[220:223], v[44:47], v[60:63], v[220:223]
    ds_read_b64_tr_b16 v[44:45], v18 offset:11424
    ds_read_b64_tr_b16 v[46:47], v18 offset:17056
    s_waitcnt lgkmcnt(6)
    v_mfma_f32_16x16x32_bf16 v[224:227], v[32:35], v[56:59], v[224:227]
    v_mfma_f32_16x16x32_bf16 v[228:231], v[32:35], v[60:63], v[228:231]
    ds_read_b128 v[48:51], v27 offset:0
    ds_read_b128 v[52:55], v27 offset:1024
    ds_read_b64_tr_b16 v[32:33], v16 offset:0
    ds_read_b64_tr_b16 v[34:35], v16 offset:5632
    s_waitcnt lgkmcnt(8)
    v_mfma_f32_16x16x32_bf16 v[232:235], v[36:39], v[56:59], v[232:235]
    v_mfma_f32_16x16x32_bf16 v[236:239], v[36:39], v[60:63], v[236:239]
    s_add_u32 m0, s55, 95232
    s_mul_i32 s60, s59, 13
    buffer_load_dwordx4 v23, s[48:51], s60 offen lds
    ds_read_b64_tr_b16 v[36:37], v16 offset:11264
    ds_read_b64_tr_b16 v[38:39], v16 offset:16896
    s_waitcnt lgkmcnt(8)
    v_mfma_f32_16x16x32_bf16 v[240:243], v[40:43], v[56:59], v[240:243]
    v_mfma_f32_16x16x32_bf16 v[244:247], v[40:43], v[60:63], v[244:247]
    ds_read_b64_tr_b16 v[40:41], v16 offset:32
    ds_read_b64_tr_b16 v[42:43], v16 offset:5664
    s_waitcnt lgkmcnt(8)
    v_mfma_f32_16x16x32_bf16 v[248:251], v[44:47], v[56:59], v[248:251]
    v_mfma_f32_16x16x32_bf16 v[252:255], v[44:47], v[60:63], v[252:255]
    s_waitcnt vmcnt(8)
    s_barrier
    ds_read_b64_tr_b16 v[44:45], v16 offset:11296
    ds_read_b64_tr_b16 v[46:47], v16 offset:16928
    s_waitcnt lgkmcnt(6)
    v_mfma_f32_16x16x32_bf16 v[160:163], v[32:35], v[48:51], v[160:163]
    v_mfma_f32_16x16x32_bf16 v[164:167], v[32:35], v[52:55], v[164:167]
    s_add_u32 m0, s52, 126976
    s_mul_i32 s60, s56, 14
    buffer_load_dwordx4 v20, s[36:39], s60 offen lds
    ds_read_b64_tr_b16 v[32:33], v16 offset:64
    ds_read_b64_tr_b16 v[34:35], v16 offset:5696
    s_waitcnt lgkmcnt(6)
    v_mfma_f32_16x16x32_bf16 v[168:171], v[36:39], v[48:51], v[168:171]
    v_mfma_f32_16x16x32_bf16 v[172:175], v[36:39], v[52:55], v[172:175]
    ds_read_b64_tr_b16 v[36:37], v16 offset:11328
    ds_read_b64_tr_b16 v[38:39], v16 offset:16960
    s_waitcnt lgkmcnt(6)
    v_mfma_f32_16x16x32_bf16 v[176:179], v[40:43], v[48:51], v[176:179]
    v_mfma_f32_16x16x32_bf16 v[180:183], v[40:43], v[52:55], v[180:183]
    ds_read_b64_tr_b16 v[40:41], v16 offset:96
    ds_read_b64_tr_b16 v[42:43], v16 offset:5728
    s_waitcnt lgkmcnt(6)
    v_mfma_f32_16x16x32_bf16 v[184:187], v[44:47], v[48:51], v[184:187]
    v_mfma_f32_16x16x32_bf16 v[188:191], v[44:47], v[52:55], v[188:191]
    s_add_u32 m0, s53, 126976
    s_mul_i32 s60, s57, 14
    buffer_load_dwordx4 v21, s[40:43], s60 offen lds
    ds_read_b64_tr_b16 v[44:45], v16 offset:11360
    ds_read_b64_tr_b16 v[46:47], v16 offset:16992
    s_waitcnt lgkmcnt(6)
    v_mfma_f32_16x16x32_bf16 v[192:195], v[32:35], v[48:51], v[192:195]
    v_mfma_f32_16x16x32_bf16 v[196:199], v[32:35], v[52:55], v[196:199]
    ds_read_b64_tr_b16 v[32:33], v16 offset:128
    ds_read_b64_tr_b16 v[34:35], v16 offset:5760
    s_waitcnt lgkmcnt(6)
    v_mfma_f32_16x16x32_bf16 v[200:203], v[36:39], v[48:51], v[200:203]
    v_mfma_f32_16x16x32_bf16 v[204:207], v[36:39], v[52:55], v[204:207]
    ds_read_b64_tr_b16 v[36:37], v16 offset:11392
    ds_read_b64_tr_b16 v[38:39], v16 offset:17024
    s_waitcnt lgkmcnt(6)
    v_mfma_f32_16x16x32_bf16 v[208:211], v[40:43], v[48:51], v[208:211]
    v_mfma_f32_16x16x32_bf16 v[212:215], v[40:43], v[52:55], v[212:215]
    s_add_u32 m0, s54, 126976
    s_mul_i32 s60, s58, 14
    buffer_load_dwordx4 v22, s[44:47], s60 offen lds
    ds_read_b64_tr_b16 v[40:41], v16 offset:160
    ds_read_b64_tr_b16 v[42:43], v16 offset:5792
    s_waitcnt lgkmcnt(6)
    v_mfma_f32_16x16x32_bf16 v[216:219], v[44:47], v[48:51], v[216:219]
    v_mfma_f32_16x16x32_bf16 v[220:223], v[44:47], v[52:55], v[220:223]
    ds_read_b64_tr_b16 v[44:45], v16 offset:11424
    ds_read_b64_tr_b16 v[46:47], v16 offset:17056
    s_waitcnt lgkmcnt(6)
    v_mfma_f32_16x16x32_bf16 v[224:227], v[32:35], v[48:51], v[224:227]
    v_mfma_f32_16x16x32_bf16 v[228:231], v[32:35], v[52:55], v[228:231]
    ds_read_b128 v[56:59], v27 offset:31744
    ds_read_b128 v[60:63], v27 offset:32768
    ds_read_b64_tr_b16 v[32:33], v16 offset:31744
    ds_read_b64_tr_b16 v[34:35], v16 offset:37376
    s_waitcnt lgkmcnt(8)
    v_mfma_f32_16x16x32_bf16 v[232:235], v[36:39], v[48:51], v[232:235]
    v_mfma_f32_16x16x32_bf16 v[236:239], v[36:39], v[52:55], v[236:239]
    s_add_u32 m0, s55, 126976
    s_mul_i32 s60, s59, 14
    buffer_load_dwordx4 v23, s[48:51], s60 offen lds
    ds_read_b64_tr_b16 v[36:37], v16 offset:43008
    ds_read_b64_tr_b16 v[38:39], v16 offset:48640
    s_waitcnt lgkmcnt(8)
    v_mfma_f32_16x16x32_bf16 v[240:243], v[40:43], v[48:51], v[240:243]
    v_mfma_f32_16x16x32_bf16 v[244:247], v[40:43], v[52:55], v[244:247]
    ds_read_b64_tr_b16 v[40:41], v16 offset:31776
    ds_read_b64_tr_b16 v[42:43], v16 offset:37408
    s_waitcnt lgkmcnt(8)
    v_mfma_f32_16x16x32_bf16 v[248:251], v[44:47], v[48:51], v[248:251]
    v_mfma_f32_16x16x32_bf16 v[252:255], v[44:47], v[52:55], v[252:255]
    s_waitcnt vmcnt(8)
    s_barrier
    ds_read_b64_tr_b16 v[44:45], v16 offset:43040
    ds_read_b64_tr_b16 v[46:47], v16 offset:48672
    s_waitcnt lgkmcnt(6)
    v_mfma_f32_16x16x32_bf16 v[160:163], v[32:35], v[56:59], v[160:163]
    v_mfma_f32_16x16x32_bf16 v[164:167], v[32:35], v[60:63], v[164:167]
    s_add_u32 m0, s52, 0
    s_mul_i32 s60, s56, 15
    buffer_load_dwordx4 v20, s[36:39], s60 offen lds
    ds_read_b64_tr_b16 v[32:33], v16 offset:31808
    ds_read_b64_tr_b16 v[34:35], v16 offset:37440
    s_waitcnt lgkmcnt(6)
    v_mfma_f32_16x16x32_bf16 v[168:171], v[36:39], v[56:59], v[168:171]
    v_mfma_f32_16x16x32_bf16 v[172:175], v[36:39], v[60:63], v[172:175]
    ds_read_b64_tr_b16 v[36:37], v16 offset:43072
    ds_read_b64_tr_b16 v[38:39], v16 offset:48704
    s_waitcnt lgkmcnt(6)
    v_mfma_f32_16x16x32_bf16 v[176:179], v[40:43], v[56:59], v[176:179]
    v_mfma_f32_16x16x32_bf16 v[180:183], v[40:43], v[60:63], v[180:183]
    ds_read_b64_tr_b16 v[40:41], v16 offset:31840
    ds_read_b64_tr_b16 v[42:43], v16 offset:37472
    s_waitcnt lgkmcnt(6)
    v_mfma_f32_16x16x32_bf16 v[184:187], v[44:47], v[56:59], v[184:187]
    v_mfma_f32_16x16x32_bf16 v[188:191], v[44:47], v[60:63], v[188:191]
    s_add_u32 m0, s53, 0
    s_mul_i32 s60, s57, 15
    buffer_load_dwordx4 v21, s[40:43], s60 offen lds
    ds_read_b64_tr_b16 v[44:45], v16 offset:43104
    ds_read_b64_tr_b16 v[46:47], v16 offset:48736
    s_waitcnt lgkmcnt(6)
    v_mfma_f32_16x16x32_bf16 v[192:195], v[32:35], v[56:59], v[192:195]
    v_mfma_f32_16x16x32_bf16 v[196:199], v[32:35], v[60:63], v[196:199]
    ds_read_b64_tr_b16 v[32:33], v16 offset:31872
    ds_read_b64_tr_b16 v[34:35], v16 offset:37504
    s_waitcnt lgkmcnt(6)
    v_mfma_f32_16x16x32_bf16 v[200:203], v[36:39], v[56:59], v[200:203]
    v_mfma_f32_16x16x32_bf16 v[204:207], v[36:39], v[60:63], v[204:207]
    ds_read_b64_tr_b16 v[36:37], v16 offset:43136
    ds_read_b64_tr_b16 v[38:39], v16 offset:48768
    s_waitcnt lgkmcnt(6)
    v_mfma_f32_16x16x32_bf16 v[208:211], v[40:43], v[56:59], v[208:211]
    v_mfma_f32_16x16x32_bf16 v[212:215], v[40:43], v[60:63], v[212:215]
    s_add_u32 m0, s54, 0
    s_mul_i32 s60, s58, 15
    buffer_load_dwordx4 v22, s[44:47], s60 offen lds
    ds_read_b64_tr_b16 v[40:41], v16 offset:31904
    ds_read_b64_tr_b16 v[42:43], v16 offset:37536
    s_waitcnt lgkmcnt(6)
    v_mfma_f32_16x16x32_bf16 v[216:219], v[44:47], v[56:59], v[216:219]
    v_mfma_f32_16x16x32_bf16 v[220:223], v[44:47], v[60:63], v[220:223]
    ds_read_b64_tr_b16 v[44:45], v16 offset:43168
    ds_read_b64_tr_b16 v[46:47], v16 offset:48800
    s_waitcnt lgkmcnt(6)
    v_mfma_f32_16x16x32_bf16 v[224:227], v[32:35], v[56:59], v[224:227]
    v_mfma_f32_16x16x32_bf16 v[228:231], v[32:35], v[60:63], v[228:231]
    ds_read_b128 v[48:51], v28 offset:0
    ds_read_b128 v[52:55], v28 offset:1024
    ds_read_b64_tr_b16 v[32:33], v17 offset:0
    ds_read_b64_tr_b16 v[34:35], v17 offset:5632
    s_waitcnt lgkmcnt(8)
    v_mfma_f32_16x16x32_bf16 v[232:235], v[36:39], v[56:59], v[232:235]
    v_mfma_f32_16x16x32_bf16 v[236:239], v[36:39], v[60:63], v[236:239]
    s_add_u32 m0, s55, 0
    s_mul_i32 s60, s59, 15
    buffer_load_dwordx4 v23, s[48:51], s60 offen lds
    ds_read_b64_tr_b16 v[36:37], v17 offset:11264
    ds_read_b64_tr_b16 v[38:39], v17 offset:16896
    s_waitcnt lgkmcnt(8)
    v_mfma_f32_16x16x32_bf16 v[240:243], v[40:43], v[56:59], v[240:243]
    v_mfma_f32_16x16x32_bf16 v[244:247], v[40:43], v[60:63], v[244:247]
    ds_read_b64_tr_b16 v[40:41], v17 offset:32
    ds_read_b64_tr_b16 v[42:43], v17 offset:5664
    s_waitcnt lgkmcnt(8)
    v_mfma_f32_16x16x32_bf16 v[248:251], v[44:47], v[56:59], v[248:251]
    v_mfma_f32_16x16x32_bf16 v[252:255], v[44:47], v[60:63], v[252:255]
    s_waitcnt vmcnt(8)
    s_barrier
    ds_read_b64_tr_b16 v[44:45], v17 offset:11296
    ds_read_b64_tr_b16 v[46:47], v17 offset:16928
    s_waitcnt lgkmcnt(6)
    v_mfma_f32_16x16x32_bf16 v[160:163], v[32:35], v[48:51], v[160:163]
    v_mfma_f32_16x16x32_bf16 v[164:167], v[32:35], v[52:55], v[164:167]
    ds_read_b64_tr_b16 v[32:33], v17 offset:64
    ds_read_b64_tr_b16 v[34:35], v17 offset:5696
    s_waitcnt lgkmcnt(6)
    v_mfma_f32_16x16x32_bf16 v[168:171], v[36:39], v[48:51], v[168:171]
    v_mfma_f32_16x16x32_bf16 v[172:175], v[36:39], v[52:55], v[172:175]
    ds_read_b64_tr_b16 v[36:37], v17 offset:11328
    ds_read_b64_tr_b16 v[38:39], v17 offset:16960
    s_waitcnt lgkmcnt(6)
    v_mfma_f32_16x16x32_bf16 v[176:179], v[40:43], v[48:51], v[176:179]
    v_mfma_f32_16x16x32_bf16 v[180:183], v[40:43], v[52:55], v[180:183]
    ds_read_b64_tr_b16 v[40:41], v17 offset:96
    ds_read_b64_tr_b16 v[42:43], v17 offset:5728
    s_waitcnt lgkmcnt(6)
    v_mfma_f32_16x16x32_bf16 v[184:187], v[44:47], v[48:51], v[184:187]
    v_mfma_f32_16x16x32_bf16 v[188:191], v[44:47], v[52:55], v[188:191]
    ds_read_b64_tr_b16 v[44:45], v17 offset:11360
    ds_read_b64_tr_b16 v[46:47], v17 offset:16992
    s_waitcnt lgkmcnt(6)
    v_mfma_f32_16x16x32_bf16 v[192:195], v[32:35], v[48:51], v[192:195]
    v_mfma_f32_16x16x32_bf16 v[196:199], v[32:35], v[52:55], v[196:199]
    ds_read_b64_tr_b16 v[32:33], v17 offset:128
    ds_read_b64_tr_b16 v[34:35], v17 offset:5760
    s_waitcnt lgkmcnt(6)
    v_mfma_f32_16x16x32_bf16 v[200:203], v[36:39], v[48:51], v[200:203]
    v_mfma_f32_16x16x32_bf16 v[204:207], v[36:39], v[52:55], v[204:207]
    ds_read_b64_tr_b16 v[36:37], v17 offset:11392
    ds_read_b64_tr_b16 v[38:39], v17 offset:17024
    s_waitcnt lgkmcnt(6)
    v_mfma_f32_16x16x32_bf16 v[208:211], v[40:43], v[48:51], v[208:211]
    v_mfma_f32_16x16x32_bf16 v[212:215], v[40:43], v[52:55], v[212:215]
    ds_read_b64_tr_b16 v[40:41], v17 offset:160
    ds_read_b64_tr_b16 v[42:43], v17 offset:5792
    s_waitcnt lgkmcnt(6)
    v_mfma_f32_16x16x32_bf16 v[216:219], v[44:47], v[48:51], v[216:219]
    v_mfma_f32_16x16x32_bf16 v[220:223], v[44:47], v[52:55], v[220:223]
    ds_read_b64_tr_b16 v[44:45], v17 offset:11424
    ds_read_b64_tr_b16 v[46:47], v17 offset:17056
    s_waitcnt lgkmcnt(6)
    v_mfma_f32_16x16x32_bf16 v[224:227], v[32:35], v[48:51], v[224:227]
    v_mfma_f32_16x16x32_bf16 v[228:231], v[32:35], v[52:55], v[228:231]
    ds_read_b128 v[56:59], v28 offset:31744
    ds_read_b128 v[60:63], v28 offset:32768
    ds_read_b64_tr_b16 v[32:33], v17 offset:31744
    ds_read_b64_tr_b16 v[34:35], v17 offset:37376
    s_waitcnt lgkmcnt(8)
    v_mfma_f32_16x16x32_bf16 v[232:235], v[36:39], v[48:51], v[232:235]
    v_mfma_f32_16x16x32_bf16 v[236:239], v[36:39], v[52:55], v[236:239]
    ds_read_b64_tr_b16 v[36:37], v17 offset:43008
    ds_read_b64_tr_b16 v[38:39], v17 offset:48640
    s_waitcnt lgkmcnt(8)
    v_mfma_f32_16x16x32_bf16 v[240:243], v[40:43], v[48:51], v[240:243]
    v_mfma_f32_16x16x32_bf16 v[244:247], v[40:43], v[52:55], v[244:247]
    ds_read_b64_tr_b16 v[40:41], v17 offset:31776
    ds_read_b64_tr_b16 v[42:43], v17 offset:37408
    s_waitcnt lgkmcnt(8)
    v_mfma_f32_16x16x32_bf16 v[248:251], v[44:47], v[48:51], v[248:251]
    v_mfma_f32_16x16x32_bf16 v[252:255], v[44:47], v[52:55], v[252:255]
    s_waitcnt vmcnt(4)
    s_barrier
    ds_read_b64_tr_b16 v[44:45], v17 offset:43040
    ds_read_b64_tr_b16 v[46:47], v17 offset:48672
    s_waitcnt lgkmcnt(6)
    v_mfma_f32_16x16x32_bf16 v[160:163], v[32:35], v[56:59], v[160:163]
    v_mfma_f32_16x16x32_bf16 v[164:167], v[32:35], v[60:63], v[164:167]
    ds_read_b64_tr_b16 v[32:33], v17 offset:31808
    ds_read_b64_tr_b16 v[34:35], v17 offset:37440
    s_waitcnt lgkmcnt(6)
    v_mfma_f32_16x16x32_bf16 v[168:171], v[36:39], v[56:59], v[168:171]
    v_mfma_f32_16x16x32_bf16 v[172:175], v[36:39], v[60:63], v[172:175]
    ds_read_b64_tr_b16 v[36:37], v17 offset:43072
    ds_read_b64_tr_b16 v[38:39], v17 offset:48704
    s_waitcnt lgkmcnt(6)
    v_mfma_f32_16x16x32_bf16 v[176:179], v[40:43], v[56:59], v[176:179]
    v_mfma_f32_16x16x32_bf16 v[180:183], v[40:43], v[60:63], v[180:183]
    ds_read_b64_tr_b16 v[40:41], v17 offset:31840
    ds_read_b64_tr_b16 v[42:43], v17 offset:37472
    s_waitcnt lgkmcnt(6)
    v_mfma_f32_16x16x32_bf16 v[184:187], v[44:47], v[56:59], v[184:187]
    v_mfma_f32_16x16x32_bf16 v[188:191], v[44:47], v[60:63], v[188:191]
    ds_read_b64_tr_b16 v[44:45], v17 offset:43104
    ds_read_b64_tr_b16 v[46:47], v17 offset:48736
    s_waitcnt lgkmcnt(6)
    v_mfma_f32_16x16x32_bf16 v[192:195], v[32:35], v[56:59], v[192:195]
    v_mfma_f32_16x16x32_bf16 v[196:199], v[32:35], v[60:63], v[196:199]
    ds_read_b64_tr_b16 v[32:33], v17 offset:31872
    ds_read_b64_tr_b16 v[34:35], v17 offset:37504
    s_waitcnt lgkmcnt(6)
    v_mfma_f32_16x16x32_bf16 v[200:203], v[36:39], v[56:59], v[200:203]
    v_mfma_f32_16x16x32_bf16 v[204:207], v[36:39], v[60:63], v[204:207]
    ds_read_b64_tr_b16 v[36:37], v17 offset:43136
    ds_read_b64_tr_b16 v[38:39], v17 offset:48768
    s_waitcnt lgkmcnt(6)
    v_mfma_f32_16x16x32_bf16 v[208:211], v[40:43], v[56:59], v[208:211]
    v_mfma_f32_16x16x32_bf16 v[212:215], v[40:43], v[60:63], v[212:215]
    ds_read_b64_tr_b16 v[40:41], v17 offset:31904
    ds_read_b64_tr_b16 v[42:43], v17 offset:37536
    s_waitcnt lgkmcnt(6)
    v_mfma_f32_16x16x32_bf16 v[216:219], v[44:47], v[56:59], v[216:219]
    v_mfma_f32_16x16x32_bf16 v[220:223], v[44:47], v[60:63], v[220:223]
    ds_read_b64_tr_b16 v[44:45], v17 offset:43168
    ds_read_b64_tr_b16 v[46:47], v17 offset:48800
    s_waitcnt lgkmcnt(6)
    v_mfma_f32_16x16x32_bf16 v[224:227], v[32:35], v[56:59], v[224:227]
    v_mfma_f32_16x16x32_bf16 v[228:231], v[32:35], v[60:63], v[228:231]
    ds_read_b128 v[48:51], v29 offset:0
    ds_read_b128 v[52:55], v29 offset:1024
    ds_read_b64_tr_b16 v[32:33], v18 offset:0
    ds_read_b64_tr_b16 v[34:35], v18 offset:5632
    s_waitcnt lgkmcnt(8)
    v_mfma_f32_16x16x32_bf16 v[232:235], v[36:39], v[56:59], v[232:235]
    v_mfma_f32_16x16x32_bf16 v[236:239], v[36:39], v[60:63], v[236:239]
    ds_read_b64_tr_b16 v[36:37], v18 offset:11264
    ds_read_b64_tr_b16 v[38:39], v18 offset:16896
    s_waitcnt lgkmcnt(8)
    v_mfma_f32_16x16x32_bf16 v[240:243], v[40:43], v[56:59], v[240:243]
    v_mfma_f32_16x16x32_bf16 v[244:247], v[40:43], v[60:63], v[244:247]
    ds_read_b64_tr_b16 v[40:41], v18 offset:32
    ds_read_b64_tr_b16 v[42:43], v18 offset:5664
    s_waitcnt lgkmcnt(8)
    v_mfma_f32_16x16x32_bf16 v[248:251], v[44:47], v[56:59], v[248:251]
    v_mfma_f32_16x16x32_bf16 v[252:255], v[44:47], v[60:63], v[252:255]
    s_waitcnt vmcnt(0)
    s_barrier
    ds_read_b64_tr_b16 v[44:45], v18 offset:11296
    ds_read_b64_tr_b16 v[46:47], v18 offset:16928
    s_waitcnt lgkmcnt(6)
    v_mfma_f32_16x16x32_bf16 v[160:163], v[32:35], v[48:51], v[160:163]
    v_mfma_f32_16x16x32_bf16 v[164:167], v[32:35], v[52:55], v[164:167]
    ds_read_b64_tr_b16 v[32:33], v18 offset:64
    ds_read_b64_tr_b16 v[34:35], v18 offset:5696
    s_waitcnt lgkmcnt(6)
    v_mfma_f32_16x16x32_bf16 v[168:171], v[36:39], v[48:51], v[168:171]
    v_mfma_f32_16x16x32_bf16 v[172:175], v[36:39], v[52:55], v[172:175]
    ds_read_b64_tr_b16 v[36:37], v18 offset:11328
    ds_read_b64_tr_b16 v[38:39], v18 offset:16960
    s_waitcnt lgkmcnt(6)
    v_mfma_f32_16x16x32_bf16 v[176:179], v[40:43], v[48:51], v[176:179]
    v_mfma_f32_16x16x32_bf16 v[180:183], v[40:43], v[52:55], v[180:183]
    ds_read_b64_tr_b16 v[40:41], v18 offset:96
    ds_read_b64_tr_b16 v[42:43], v18 offset:5728
    s_waitcnt lgkmcnt(6)
    v_mfma_f32_16x16x32_bf16 v[184:187], v[44:47], v[48:51], v[184:187]
    v_mfma_f32_16x16x32_bf16 v[188:191], v[44:47], v[52:55], v[188:191]
    ds_read_b64_tr_b16 v[44:45], v18 offset:11360
    ds_read_b64_tr_b16 v[46:47], v18 offset:16992
    s_waitcnt lgkmcnt(6)
    v_mfma_f32_16x16x32_bf16 v[192:195], v[32:35], v[48:51], v[192:195]
    v_mfma_f32_16x16x32_bf16 v[196:199], v[32:35], v[52:55], v[196:199]
    ds_read_b64_tr_b16 v[32:33], v18 offset:128
    ds_read_b64_tr_b16 v[34:35], v18 offset:5760
    s_waitcnt lgkmcnt(6)
    v_mfma_f32_16x16x32_bf16 v[200:203], v[36:39], v[48:51], v[200:203]
    v_mfma_f32_16x16x32_bf16 v[204:207], v[36:39], v[52:55], v[204:207]
    ds_read_b64_tr_b16 v[36:37], v18 offset:11392
    ds_read_b64_tr_b16 v[38:39], v18 offset:17024
    s_waitcnt lgkmcnt(6)
    v_mfma_f32_16x16x32_bf16 v[208:211], v[40:43], v[48:51], v[208:211]
    v_mfma_f32_16x16x32_bf16 v[212:215], v[40:43], v[52:55], v[212:215]
    ds_read_b64_tr_b16 v[40:41], v18 offset:160
    ds_read_b64_tr_b16 v[42:43], v18 offset:5792
    s_waitcnt lgkmcnt(6)
    v_mfma_f32_16x16x32_bf16 v[216:219], v[44:47], v[48:51], v[216:219]
    v_mfma_f32_16x16x32_bf16 v[220:223], v[44:47], v[52:55], v[220:223]
    ds_read_b64_tr_b16 v[44:45], v18 offset:11424
    ds_read_b64_tr_b16 v[46:47], v18 offset:17056
    s_waitcnt lgkmcnt(6)
    v_mfma_f32_16x16x32_bf16 v[224:227], v[32:35], v[48:51], v[224:227]
    v_mfma_f32_16x16x32_bf16 v[228:231], v[32:35], v[52:55], v[228:231]
    ds_read_b128 v[56:59], v27 offset:0
    ds_read_b128 v[60:63], v27 offset:1024
    ds_read_b64_tr_b16 v[32:33], v16 offset:0
    ds_read_b64_tr_b16 v[34:35], v16 offset:5632
    s_waitcnt lgkmcnt(8)
    v_mfma_f32_16x16x32_bf16 v[232:235], v[36:39], v[48:51], v[232:235]
    v_mfma_f32_16x16x32_bf16 v[236:239], v[36:39], v[52:55], v[236:239]
    ds_read_b64_tr_b16 v[36:37], v16 offset:11264
    ds_read_b64_tr_b16 v[38:39], v16 offset:16896
    s_waitcnt lgkmcnt(8)
    v_mfma_f32_16x16x32_bf16 v[240:243], v[40:43], v[48:51], v[240:243]
    v_mfma_f32_16x16x32_bf16 v[244:247], v[40:43], v[52:55], v[244:247]
    ds_read_b64_tr_b16 v[40:41], v16 offset:32
    ds_read_b64_tr_b16 v[42:43], v16 offset:5664
    s_waitcnt lgkmcnt(8)
    v_mfma_f32_16x16x32_bf16 v[248:251], v[44:47], v[48:51], v[248:251]
    v_mfma_f32_16x16x32_bf16 v[252:255], v[44:47], v[52:55], v[252:255]
    s_waitcnt vmcnt(0)
    s_barrier
    ds_read_b64_tr_b16 v[44:45], v16 offset:11296
    ds_read_b64_tr_b16 v[46:47], v16 offset:16928
    s_waitcnt lgkmcnt(6)
    v_mfma_f32_16x16x32_bf16 v[160:163], v[32:35], v[56:59], v[160:163]
    v_mfma_f32_16x16x32_bf16 v[164:167], v[32:35], v[60:63], v[164:167]
    ds_read_b64_tr_b16 v[32:33], v16 offset:64
    ds_read_b64_tr_b16 v[34:35], v16 offset:5696
    s_waitcnt lgkmcnt(6)
    v_mfma_f32_16x16x32_bf16 v[168:171], v[36:39], v[56:59], v[168:171]
    v_mfma_f32_16x16x32_bf16 v[172:175], v[36:39], v[60:63], v[172:175]
    ds_read_b64_tr_b16 v[36:37], v16 offset:11328
    ds_read_b64_tr_b16 v[38:39], v16 offset:16960
    s_waitcnt lgkmcnt(6)
    v_mfma_f32_16x16x32_bf16 v[176:179], v[40:43], v[56:59], v[176:179]
    v_mfma_f32_16x16x32_bf16 v[180:183], v[40:43], v[60:63], v[180:183]
    ds_read_b64_tr_b16 v[40:41], v16 offset:96
    ds_read_b64_tr_b16 v[42:43], v16 offset:5728
    s_waitcnt lgkmcnt(6)
    v_mfma_f32_16x16x32_bf16 v[184:187], v[44:47], v[56:59], v[184:187]
    v_mfma_f32_16x16x32_bf16 v[188:191], v[44:47], v[60:63], v[188:191]
    ds_read_b64_tr_b16 v[44:45], v16 offset:11360
    ds_read_b64_tr_b16 v[46:47], v16 offset:16992
    s_waitcnt lgkmcnt(6)
    v_mfma_f32_16x16x32_bf16 v[192:195], v[32:35], v[56:59], v[192:195]
    v_mfma_f32_16x16x32_bf16 v[196:199], v[32:35], v[60:63], v[196:199]
    ds_read_b64_tr_b16 v[32:33], v16 offset:128
    ds_read_b64_tr_b16 v[34:35], v16 offset:5760
    s_waitcnt lgkmcnt(6)
    v_mfma_f32_16x16x32_bf16 v[200:203], v[36:39], v[56:59], v[200:203]
    v_mfma_f32_16x16x32_bf16 v[204:207], v[36:39], v[60:63], v[204:207]
    ds_read_b64_tr_b16 v[36:37], v16 offset:11392
    ds_read_b64_tr_b16 v[38:39], v16 offset:17024
    s_waitcnt lgkmcnt(6)
    v_mfma_f32_16x16x32_bf16 v[208:211], v[40:43], v[56:59], v[208:211]
    v_mfma_f32_16x16x32_bf16 v[212:215], v[40:43], v[60:63], v[212:215]
    ds_read_b64_tr_b16 v[40:41], v16 offset:160
    ds_read_b64_tr_b16 v[42:43], v16 offset:5792
    s_waitcnt lgkmcnt(6)
    v_mfma_f32_16x16x32_bf16 v[216:219], v[44:47], v[56:59], v[216:219]
    v_mfma_f32_16x16x32_bf16 v[220:223], v[44:47], v[60:63], v[220:223]
    ds_read_b64_tr_b16 v[44:45], v16 offset:11424
    ds_read_b64_tr_b16 v[46:47], v16 offset:17056
    s_waitcnt lgkmcnt(6)
    v_mfma_f32_16x16x32_bf16 v[224:227], v[32:35], v[56:59], v[224:227]
    v_mfma_f32_16x16x32_bf16 v[228:231], v[32:35], v[60:63], v[228:231]
    s_waitcnt lgkmcnt(4)
    v_mfma_f32_16x16x32_bf16 v[232:235], v[36:39], v[56:59], v[232:235]
    v_mfma_f32_16x16x32_bf16 v[236:239], v[36:39], v[60:63], v[236:239]
    s_waitcnt lgkmcnt(2)
    v_mfma_f32_16x16x32_bf16 v[240:243], v[40:43], v[56:59], v[240:243]
    v_mfma_f32_16x16x32_bf16 v[244:247], v[40:43], v[60:63], v[244:247]
    s_waitcnt lgkmcnt(0)
    v_mfma_f32_16x16x32_bf16 v[248:251], v[44:47], v[56:59], v[248:251]
    v_mfma_f32_16x16x32_bf16 v[252:255], v[44:47], v[60:63], v[252:255]
    s_branch k1_gu_epi
k1_gu1:
    s_add_u32 m0, s52, 31744
    s_mul_i32 s60, s56, 1
    buffer_load_dwordx4 v20, s[36:39], s60 offen lds
    s_add_u32 m0, s53, 31744
    s_mul_i32 s60, s57, 1
    buffer_load_dwordx4 v21, s[40:43], s60 offen lds
    s_add_u32 m0, s54, 31744
    s_mul_i32 s60, s58, 1
    buffer_load_dwordx4 v22, s[44:47], s60 offen lds
    s_add_u32 m0, s55, 31744
    s_mul_i32 s60, s59, 1
    buffer_load_dwordx4 v23, s[48:51], s60 offen lds
    s_add_u32 m0, s52, 63488
    s_mul_i32 s60, s56, 2
    buffer_load_dwordx4 v20, s[36:39], s60 offen lds
    s_add_u32 m0, s53, 63488
    s_mul_i32 s60, s57, 2
    buffer_load_dwordx4 v21, s[40:43], s60 offen lds
    s_add_u32 m0, s54, 63488
    s_mul_i32 s60, s58, 2
    buffer_load_dwordx4 v22, s[44:47], s60 offen lds
    s_add_u32 m0, s55, 63488
    s_mul_i32 s60, s59, 2
    buffer_load_dwordx4 v23, s[48:51], s60 offen lds
    s_add_u32 m0, s52, 95232
    s_mul_i32 s60, s56, 3
    buffer_load_dwordx4 v20, s[36:39], s60 offen lds
    s_add_u32 m0, s53, 95232
    s_mul_i32 s60, s57, 3
    buffer_load_dwordx4 v21, s[40:43], s60 offen lds
    s_add_u32 m0, s54, 95232
    s_mul_i32 s60, s58, 3
    buffer_load_dwordx4 v22, s[44:47], s60 offen lds
    s_add_u32 m0, s55, 95232
    s_mul_i32 s60, s59, 3
    buffer_load_dwordx4 v23, s[48:51], s60 offen lds
    s_waitcnt vmcnt(8)
    s_barrier
    ds_read_b128 v[48:51], v27 offset:0
    ds_read_b128 v[52:55], v27 offset:1024
    ds_read_b64_tr_b16 v[32:33], v16 offset:0
    ds_read_b64_tr_b16 v[34:35], v16 offset:5632
    ds_read_b64_tr_b16 v[36:37], v16 offset:11264
    ds_read_b64_tr_b16 v[38:39], v16 offset:16896
    ds_read_b64_tr_b16 v[40:41], v16 offset:32
    ds_read_b64_tr_b16 v[42:43], v16 offset:5664
    ds_read_b64_tr_b16 v[44:45], v16 offset:11296
    ds_read_b64_tr_b16 v[46:47], v16 offset:16928
    s_waitcnt lgkmcnt(6)
    v_mfma_f32_16x16x32_bf16 v[160:163], v[32:35], v[48:51], 0
    v_mfma_f32_16x16x32_bf16 v[164:167], v[32:35], v[52:55], 0
    ds_read_b64_tr_b16 v[32:33], v16 offset:64
    ds_read_b64_tr_b16 v[34:35], v16 offset:5696
    s_waitcnt lgkmcnt(6)
    v_mfma_f32_16x16x32_bf16 v[168:171], v[36:39], v[48:51], 0
    v_mfma_f32_16x16x32_bf16 v[172:175], v[36:39], v[52:55], 0
    s_add_u32 m0, s52, 126976
    s_mul_i32 s60, s56, 4
    buffer_load_dwordx4 v20, s[36:39], s60 offen lds
    ds_read_b64_tr_b16 v[36:37], v16 offset:11328
    ds_read_b64_tr_b16 v[38:39], v16 offset:16960
    s_waitcnt lgkmcnt(6)
    v_mfma_f32_16x16x32_bf16 v[176:179], v[40:43], v[48:51], 0
    v_mfma_f32_16x16x32_bf16 v[180:183], v[40:43], v[52:55], 0
    ds_read_b64_tr_b16 v[40:41], v16 offset:96
    ds_read_b64_tr_b16 v[42:43], v16 offset:5728
    s_waitcnt lgkmcnt(6)
    v_mfma_f32_16x16x32_bf16 v[184:187], v[44:47], v[48:51], 0
    v_mfma_f32_16x16x32_bf16 v[188:191], v[44:47], v[52:55], 0
    ds_read_b64_tr_b16 v[44:45], v16 offset:11360
    ds_read_b64_tr_b16 v[46:47], v16 offset:16992
    s_waitcnt lgkmcnt(6)
    v_mfma_f32_16x16x32_bf16 v[192:195], v[32:35], v[48:51], 0
    v_mfma_f32_16x16x32_bf16 v[196:199], v[32:35], v[52:55], 0
    s_add_u32 m0, s53, 126976
    s_mul_i32 s60, s57, 4
    buffer_load_dwordx4 v21, s[40:43], s60 offen lds
    ds_read_b64_tr_b16 v[32:33], v16 offset:128
    ds_read_b64_tr_b16 v[34:35], v16 offset:5760
    s_waitcnt lgkmcnt(6)
    v_mfma_f32_16x16x32_bf16 v[200:203], v[36:39], v[48:51], 0
    v_mfma_f32_16x16x32_bf16 v[204:207], v[36:39], v[52:55], 0
    ds_read_b64_tr_b16 v[36:37], v16 offset:11392
    ds_read_b64_tr_b16 v[38:39], v16 offset:17024
    s_waitcnt lgkmcnt(6)
    v_mfma_f32_16x16x32_bf16 v[208:211], v[40:43], v[48:51], 0
    v_mfma_f32_16x16x32_bf16 v[212:215], v[40:43], v[52:55], 0
    s_add_u32 m0, s54, 126976
    s_mul_i32 s60, s58, 4
    buffer_load_dwordx4 v22, s[44:47], s60 offen lds
    ds_read_b128 v[56:59], v27 offset:31744
    ds_read_b128 v[60:63], v27 offset:32768
    ds_read_b64_tr_b16 v[40:41], v16 offset:31744
    ds_read_b64_tr_b16 v[42:43], v16 offset:37376
    s_waitcnt lgkmcnt(8)
    v_mfma_f32_16x16x32_bf16 v[216:219], v[44:47], v[48:51], 0
    v_mfma_f32_16x16x32_bf16 v[220:223], v[44:47], v[52:55], 0
    ds_read_b64_tr_b16 v[44:45], v16 offset:43008
    ds_read_b64_tr_b16 v[46:47], v16 offset:48640
    s_waitcnt lgkmcnt(8)
    v_mfma_f32_16x16x32_bf16 v[224:227], v[32:35], v[48:51], 0
    v_mfma_f32_16x16x32_bf16 v[228:231], v[32:35], v[52:55], 0
    s_add_u32 m0, s55, 126976
    s_mul_i32 s60, s59, 4
    buffer_load_dwordx4 v23, s[48:51], s60 offen lds
    ds_read_b64_tr_b16 v[32:33], v16 offset:31776
    ds_read_b64_tr_b16 v[34:35], v16 offset:37408
    s_waitcnt lgkmcnt(8)
    v_mfma_f32_16x16x32_bf16 v[232:235], v[36:39], v[48:51], 0
    v_mfma_f32_16x16x32_bf16 v[236:239], v[36:39], v[52:55], 0
    s_waitcnt vmcnt(8)
    s_barrier
    ds_read_b64_tr_b16 v[36:37], v16 offset:43040
    ds_read_b64_tr_b16 v[38:39], v16 offset:48672
    s_waitcnt lgkmcnt(6)
    v_mfma_f32_16x16x32_bf16 v[160:163], v[40:43], v[56:59], v[160:163]
    v_mfma_f32_16x16x32_bf16 v[164:167], v[40:43], v[60:63], v[164:167]
    ds_read_b64_tr_b16 v[40:41], v16 offset:31808
    ds_read_b64_tr_b16 v[42:43], v16 offset:37440
    s_waitcnt lgkmcnt(6)
    v_mfma_f32_16x16x32_bf16 v[168:171], v[44:47], v[56:59], v[168:171]
    v_mfma_f32_16x16x32_bf16 v[172:175], v[44:47], v[60:63], v[172:175]
    s_add_u32 m0, s52, 0
    s_mul_i32 s60, s56, 5
    buffer_load_dwordx4 v20, s[36:39], s60 offen lds
    ds_read_b64_tr_b16 v[44:45], v16 offset:43072
    ds_read_b64_tr_b16 v[46:47], v16 offset:48704
    s_waitcnt lgkmcnt(6)
    v_mfma_f32_16x16x32_bf16 v[176:179], v[32:35], v[56:59], v[176:179]
    v_mfma_f32_16x16x32_bf16 v[180:183], v[32:35], v[60:63], v[180:183]
    ds_read_b64_tr_b16 v[32:33], v16 offset:31840
    ds_read_b64_tr_b16 v[34:35], v16 offset:37472
    s_waitcnt lgkmcnt(6)
    v_mfma_f32_16x16x32_bf16 v[184:187], v[36:39], v[56:59], v[184:187]
    v_mfma_f32_16x16x32_bf16 v[188:191], v[36:39], v[60:63], v[188:191]
    ds_read_b64_tr_b16 v[36:37], v16 offset:43104
    ds_read_b64_tr_b16 v[38:39], v16 offset:48736
    s_waitcnt lgkmcnt(6)
    v_mfma_f32_16x16x32_bf16 v[192:195], v[40:43], v[56:59], v[192:195]
    v_mfma_f32_16x16x32_bf16 v[196:199], v[40:43], v[60:63], v[196:199]
    s_add_u32 m0, s53, 0
    s_mul_i32 s60, s57, 5
    buffer_load_dwordx4 v21, s[40:43], s60 offen lds
    ds_read_b64_tr_b16 v[40:41], v16 offset:31872
    ds_read_b64_tr_b16 v[42:43], v16 offset:37504
    s_waitcnt lgkmcnt(6)
    v_mfma_f32_16x16x32_bf16 v[200:203], v[44:47], v[56:59], v[200:203]
    v_mfma_f32_16x16x32_bf16 v[204:207], v[44:47], v[60:63], v[204:207]
    ds_read_b64_tr_b16 v[44:45], v16 offset:43136
    ds_read_b64_tr_b16 v[46:47], v16 offset:48768
    s_waitcnt lgkmcnt(6)
    v_mfma_f32_16x16x32_bf16 v[208:211], v[32:35], v[56:59], v[208:211]
    v_mfma_f32_16x16x32_bf16 v[212:215], v[32:35], v[60:63], v[212:215]
    s_add_u32 m0, s54, 0
    s_mul_i32 s60, s58, 5
    buffer_load_dwordx4 v22, s[44:47], s60 offen lds
    ds_read_b128 v[48:51], v28 offset:0
    ds_read_b128 v[52:55], v28 offset:1024
    ds_read_b64_tr_b16 v[32:33], v17 offset:0
    ds_read_b64_tr_b16 v[34:35], v17 offset:5632
    s_waitcnt lgkmcnt(8)
    v_mfma_f32_16x16x32_bf16 v[216:219], v[36:39], v[56:59], v[216:219]
    v_mfma_f32_16x16x32_bf16 v[220:223], v[36:39], v[60:63], v[220:223]
    ds_read_b64_tr_b16 v[36:37], v17 offset:11264
    ds_read_b64_tr_b16 v[38:39], v17 offset:16896
    s_waitcnt lgkmcnt(8)
    v_mfma_f32_16x16x32_bf16 v[224:227], v[40:43], v[56:59], v[224:227]
    v_mfma_f32_16x16x32_bf16 v[228:231], v[40:43], v[60:63], v[228:231]
    s_add_u32 m0, s55, 0
    s_mul_i32 s60, s59, 5
    buffer_load_dwordx4 v23, s[48:51], s60 offen lds
    ds_read_b64_tr_b16 v[40:41], v17 offset:32
    ds_read_b64_tr_b16 v[42:43], v17 offset:5664
    s_waitcnt lgkmcnt(8)
    v_mfma_f32_16x16x32_bf16 v[232:235], v[44:47], v[56:59], v[232:235]
    v_mfma_f32_16x16x32_bf16 v[236:239], v[44:47], v[60:63], v[236:239]
    s_waitcnt vmcnt(8)
    s_barrier
    ds_read_b64_tr_b16 v[44:45], v17 offset:11296
    ds_read_b64_tr_b16 v[46:47], v17 offset:16928
    s_waitcnt lgkmcnt(6)
    v_mfma_f32_16x16x32_bf16 v[160:163], v[32:35], v[48:51], v[160:163]
    v_mfma_f32_16x16x32_bf16 v[164:167], v[32:35], v[52:55], v[164:167]
    ds_read_b64_tr_b16 v[32:33], v17 offset:64
    ds_read_b64_tr_b16 v[34:35], v17 offset:5696
    s_waitcnt lgkmcnt(6)
    v_mfma_f32_16x16x32_bf16 v[168:171], v[36:39], v[48:51], v[168:171]
    v_mfma_f32_16x16x32_bf16 v[172:175], v[36:39], v[52:55], v[172:175]
    s_add_u32 m0, s52, 31744
    s_mul_i32 s60, s56, 6
    buffer_load_dwordx4 v20, s[36:39], s60 offen lds
    ds_read_b64_tr_b16 v[36:37], v17 offset:11328
    ds_read_b64_tr_b16 v[38:39], v17 offset:16960
    s_waitcnt lgkmcnt(6)
    v_mfma_f32_16x16x32_bf16 v[176:179], v[40:43], v[48:51], v[176:179]
    v_mfma_f32_16x16x32_bf16 v[180:183], v[40:43], v[52:55], v[180:183]
    ds_read_b64_tr_b16 v[40:41], v17 offset:96
    ds_read_b64_tr_b16 v[42:43], v17 offset:5728
    s_waitcnt lgkmcnt(6)
    v_mfma_f32_16x16x32_bf16 v[184:187], v[44:47], v[48:51], v[184:187]
    v_mfma_f32_16x16x32_bf16 v[188:191], v[44:47], v[52:55], v[188:191]
    ds_read_b64_tr_b16 v[44:45], v17 offset:11360
    ds_read_b64_tr_b16 v[46:47], v17 offset:16992
    s_waitcnt lgkmcnt(6)
    v_mfma_f32_16x16x32_bf16 v[192:195], v[32:35], v[48:51], v[192:195]
    v_mfma_f32_16x16x32_bf16 v[196:199], v[32:35], v[52:55], v[196:199]
    s_add_u32 m0, s53, 31744
    s_mul_i32 s60, s57, 6
    buffer_load_dwordx4 v21, s[40:43], s60 offen lds
    ds_read_b64_tr_b16 v[32:33], v17 offset:128
    ds_read_b64_tr_b16 v[34:35], v17 offset:5760
    s_waitcnt lgkmcnt(6)
    v_mfma_f32_16x16x32_bf16 v[200:203], v[36:39], v[48:51], v[200:203]
    v_mfma_f32_16x16x32_bf16 v[204:207], v[36:39], v[52:55], v[204:207]
    ds_read_b64_tr_b16 v[36:37], v17 offset:11392
    ds_read_b64_tr_b16 v[38:39], v17 offset:17024
    s_waitcnt lgkmcnt(6)
    v_mfma_f32_16x16x32_bf16 v[208:211], v[40:43], v[48:51], v[208:211]
    v_mfma_f32_16x16x32_bf16 v[212:215], v[40:43], v[52:55], v[212:215]
    s_add_u32 m0, s54, 31744
    s_mul_i32 s60, s58, 6
    buffer_load_dwordx4 v22, s[44:47], s60 offen lds
    ds_read_b128 v[56:59], v28 offset:31744
    ds_read_b128 v[60:63], v28 offset:32768
    ds_read_b64_tr_b16 v[40:41], v17 offset:31744
    ds_read_b64_tr_b16 v[42:43], v17 offset:37376
    s_waitcnt lgkmcnt(8)
    v_mfma_f32_16x16x32_bf16 v[216:219], v[44:47], v[48:51], v[216:219]
    v_mfma_f32_16x16x32_bf16 v[220:223], v[44:47], v[52:55], v[220:223]
    ds_read_b64_tr_b16 v[44:45], v17 offset:43008
    ds_read_b64_tr_b16 v[46:47], v17 offset:48640
    s_waitcnt lgkmcnt(8)
    v_mfma_f32_16x16x32_bf16 v[224:227], v[32:35], v[48:51], v[224:227]
    v_mfma_f32_16x16x32_bf16 v[228:231], v[32:35], v[52:55], v[228:231]
    s_add_u32 m0, s55, 31744
    s_mul_i32 s60, s59, 6
    buffer_load_dwordx4 v23, s[48:51], s60 offen lds
    ds_read_b64_tr_b16 v[32:33], v17 offset:31776
    ds_read_b64_tr_b16 v[34:35], v17 offset:37408
    s_waitcnt lgkmcnt(8)
    v_mfma_f32_16x16x32_bf16 v[232:235], v[36:39], v[48:51], v[232:235]
    v_mfma_f32_16x16x32_bf16 v[236:239], v[36:39], v[52:55], v[236:239]
    s_waitcnt vmcnt(8)
    s_barrier
    ds_read_b64_tr_b16 v[36:37], v17 offset:43040
    ds_read_b64_tr_b16 v[38:39], v17 offset:48672
    s_waitcnt lgkmcnt(6)
    v_mfma_f32_16x16x32_bf16 v[160:163], v[40:43], v[56:59], v[160:163]
    v_mfma_f32_16x16x32_bf16 v[164:167], v[40:43], v[60:63], v[164:167]
    ds_read_b64_tr_b16 v[40:41], v17 offset:31808
    ds_read_b64_tr_b16 v[42:43], v17 offset:37440
    s_waitcnt lgkmcnt(6)
    v_mfma_f32_16x16x32_bf16 v[168:171], v[44:47], v[56:59], v[168:171]
    v_mfma_f32_16x16x32_bf16 v[172:175], v[44:47], v[60:63], v[172:175]
    s_add_u32 m0, s52, 63488
    s_mul_i32 s60, s56, 7
    buffer_load_dwordx4 v20, s[36:39], s60 offen lds
    ds_read_b64_tr_b16 v[44:45], v17 offset:43072
    ds_read_b64_tr_b16 v[46:47], v17 offset:48704
    s_waitcnt lgkmcnt(6)
    v_mfma_f32_16x16x32_bf16 v[176:179], v[32:35], v[56:59], v[176:179]
    v_mfma_f32_16x16x32_bf16 v[180:183], v[32:35], v[60:63], v[180:183]
    ds_read_b64_tr_b16 v[32:33], v17 offset:31840
    ds_read_b64_tr_b16 v[34:35], v17 offset:37472
    s_waitcnt lgkmcnt(6)
    v_mfma_f32_16x16x32_bf16 v[184:187], v[36:39], v[56:59], v[184:187]
    v_mfma_f32_16x16x32_bf16 v[188:191], v[36:39], v[60:63], v[188:191]
    ds_read_b64_tr_b16 v[36:37], v17 offset:43104
    ds_read_b64_tr_b16 v[38:39], v17 offset:48736
    s_waitcnt lgkmcnt(6)
    v_mfma_f32_16x16x32_bf16 v[192:195], v[40:43], v[56:59], v[192:195]
    v_mfma_f32_16x16x32_bf16 v[196:199], v[40:43], v[60:63], v[196:199]
    s_add_u32 m0, s53, 63488
    s_mul_i32 s60, s57, 7
    buffer_load_dwordx4 v21, s[40:43], s60 offen lds
    ds_read_b64_tr_b16 v[40:41], v17 offset:31872
    ds_read_b64_tr_b16 v[42:43], v17 offset:37504
    s_waitcnt lgkmcnt(6)
    v_mfma_f32_16x16x32_bf16 v[200:203], v[44:47], v[56:59], v[200:203]
    v_mfma_f32_16x16x32_bf16 v[204:207], v[44:47], v[60:63], v[204:207]
    ds_read_b64_tr_b16 v[44:45], v17 offset:43136
    ds_read_b64_tr_b16 v[46:47], v17 offset:48768
    s_waitcnt lgkmcnt(6)
    v_mfma_f32_16x16x32_bf16 v[208:211], v[32:35], v[56:59], v[208:211]
    v_mfma_f32_16x16x32_bf16 v[212:215], v[32:35], v[60:63], v[212:215]
    s_add_u32 m0, s54, 63488
    s_mul_i32 s60, s58, 7
    buffer_load_dwordx4 v22, s[44:47], s60 offen lds
    ds_read_b128 v[48:51], v29 offset:0
    ds_read_b128 v[52:55], v29 offset:1024
    ds_read_b64_tr_b16 v[32:33], v18 offset:0
    ds_read_b64_tr_b16 v[34:35], v18 offset:5632
    s_waitcnt lgkmcnt(8)
    v_mfma_f32_16x16x32_bf16 v[216:219], v[36:39], v[56:59], v[216:219]
    v_mfma_f32_16x16x32_bf16 v[220:223], v[36:39], v[60:63], v[220:223]
    ds_read_b64_tr_b16 v[36:37], v18 offset:11264
    ds_read_b64_tr_b16 v[38:39], v18 offset:16896
    s_waitcnt lgkmcnt(8)
    v_mfma_f32_16x16x32_bf16 v[224:227], v[40:43], v[56:59], v[224:227]
    v_mfma_f32_16x16x32_bf16 v[228:231], v[40:43], v[60:63], v[228:231]
    s_add_u32 m0, s55, 63488
    s_mul_i32 s60, s59, 7
    buffer_load_dwordx4 v23, s[48:51], s60 offen lds
    ds_read_b64_tr_b16 v[40:41], v18 offset:32
    ds_read_b64_tr_b16 v[42:43], v18 offset:5664
    s_waitcnt lgkmcnt(8)
    v_mfma_f32_16x16x32_bf16 v[232:235], v[44:47], v[56:59], v[232:235]
    v_mfma_f32_16x16x32_bf16 v[236:239], v[44:47], v[60:63], v[236:239]
    s_waitcnt vmcnt(8)
    s_barrier
    ds_read_b64_tr_b16 v[44:45], v18 offset:11296
    ds_read_b64_tr_b16 v[46:47], v18 offset:16928
    s_waitcnt lgkmcnt(6)
    v_mfma_f32_16x16x32_bf16 v[160:163], v[32:35], v[48:51], v[160:163]
    v_mfma_f32_16x16x32_bf16 v[164:167], v[32:35], v[52:55], v[164:167]
    ds_read_b64_tr_b16 v[32:33], v18 offset:64
    ds_read_b64_tr_b16 v[34:35], v18 offset:5696
    s_waitcnt lgkmcnt(6)
    v_mfma_f32_16x16x32_bf16 v[168:171], v[36:39], v[48:51], v[168:171]
    v_mfma_f32_16x16x32_bf16 v[172:175], v[36:39], v[52:55], v[172:175]
    s_add_u32 m0, s52, 95232
    s_mul_i32 s60, s56, 8
    buffer_load_dwordx4 v20, s[36:39], s60 offen lds
    ds_read_b64_tr_b16 v[36:37], v18 offset:11328
    ds_read_b64_tr_b16 v[38:39], v18 offset:16960
    s_waitcnt lgkmcnt(6)
    v_mfma_f32_16x16x32_bf16 v[176:179], v[40:43], v[48:51], v[176:179]
    v_mfma_f32_16x16x32_bf16 v[180:183], v[40:43], v[52:55], v[180:183]
    ds_read_b64_tr_b16 v[40:41], v18 offset:96
    ds_read_b64_tr_b16 v[42:43], v18 offset:5728
    s_waitcnt lgkmcnt(6)
    v_mfma_f32_16x16x32_bf16 v[184:187], v[44:47], v[48:51], v[184:187]
    v_mfma_f32_16x16x32_bf16 v[188:191], v[44:47], v[52:55], v[188:191]
    ds_read_b64_tr_b16 v[44:45], v18 offset:11360
    ds_read_b64_tr_b16 v[46:47], v18 offset:16992
    s_waitcnt lgkmcnt(6)
    v_mfma_f32_16x16x32_bf16 v[192:195], v[32:35], v[48:51], v[192:195]
    v_mfma_f32_16x16x32_bf16 v[196:199], v[32:35], v[52:55], v[196:199]
    s_add_u32 m0, s53, 95232
    s_mul_i32 s60, s57, 8
    buffer_load_dwordx4 v21, s[40:43], s60 offen lds
    ds_read_b64_tr_b16 v[32:33], v18 offset:128
    ds_read_b64_tr_b16 v[34:35], v18 offset:5760
    s_waitcnt lgkmcnt(6)
    v_mfma_f32_16x16x32_bf16 v[200:203], v[36:39], v[48:51], v[200:203]
    v_mfma_f32_16x16x32_bf16 v[204:207], v[36:39], v[52:55], v[204:207]
    ds_read_b64_tr_b16 v[36:37], v18 offset:11392
    ds_read_b64_tr_b16 v[38:39], v18 offset:17024
    s_waitcnt lgkmcnt(6)
    v_mfma_f32_16x16x32_bf16 v[208:211], v[40:43], v[48:51], v[208:211]
    v_mfma_f32_16x16x32_bf16 v[212:215], v[40:43], v[52:55], v[212:215]
    s_add_u32 m0, s54, 95232
    s_mul_i32 s60, s58, 8
    buffer_load_dwordx4 v22, s[44:47], s60 offen lds
    ds_read_b128 v[56:59], v27 offset:0
    ds_read_b128 v[60:63], v27 offset:1024
    ds_read_b64_tr_b16 v[40:41], v16 offset:0
    ds_read_b64_tr_b16 v[42:43], v16 offset:5632
    s_waitcnt lgkmcnt(8)
    v_mfma_f32_16x16x32_bf16 v[216:219], v[44:47], v[48:51], v[216:219]
    v_mfma_f32_16x16x32_bf16 v[220:223], v[44:47], v[52:55], v[220:223]
    ds_read_b64_tr_b16 v[44:45], v16 offset:11264
    ds_read_b64_tr_b16 v[46:47], v16 offset:16896
    s_waitcnt lgkmcnt(8)
    v_mfma_f32_16x16x32_bf16 v[224:227], v[32:35], v[48:51], v[224:227]
    v_mfma_f32_16x16x32_bf16 v[228:231], v[32:35], v[52:55], v[228:231]
    s_add_u32 m0, s55, 95232
    s_mul_i32 s60, s59, 8
    buffer_load_dwordx4 v23, s[48:51], s60 offen lds
    ds_read_b64_tr_b16 v[32:33], v16 offset:32
    ds_read_b64_tr_b16 v[34:35], v16 offset:5664
    s_waitcnt lgkmcnt(8)
    v_mfma_f32_16x16x32_bf16 v[232:235], v[36:39], v[48:51], v[232:235]
    v_mfma_f32_16x16x32_bf16 v[236:239], v[36:39], v[52:55], v[236:239]
    s_waitcnt vmcnt(8)
    s_barrier
    ds_read_b64_tr_b16 v[36:37], v16 offset:11296
    ds_read_b64_tr_b16 v[38:39], v16 offset:16928
    s_waitcnt lgkmcnt(6)
    v_mfma_f32_16x16x32_bf16 v[160:163], v[40:43], v[56:59], v[160:163]
    v_mfma_f32_16x16x32_bf16 v[164:167], v[40:43], v[60:63], v[164:167]
    ds_read_b64_tr_b16 v[40:41], v16 offset:64
    ds_read_b64_tr_b16 v[42:43], v16 offset:5696
    s_waitcnt lgkmcnt(6)
    v_mfma_f32_16x16x32_bf16 v[168:171], v[44:47], v[56:59], v[168:171]
    v_mfma_f32_16x16x32_bf16 v[172:175], v[44:47], v[60:63], v[172:175]
    s_add_u32 m0, s52, 126976
    s_mul_i32 s60, s56, 9
    buffer_load_dwordx4 v20, s[36:39], s60 offen lds
    ds_read_b64_tr_b16 v[44:45], v16 offset:11328
    ds_read_b64_tr_b16 v[46:47], v16 offset:16960
    s_waitcnt lgkmcnt(6)
    v_mfma_f32_16x16x32_bf16 v[176:179], v[32:35], v[56:59], v[176:179]
    v_mfma_f32_16x16x32_bf16 v[180:183], v[32:35], v[60:63], v[180:183]
    ds_read_b64_tr_b16 v[32:33], v16 offset:96
    ds_read_b64_tr_b16 v[34:35], v16 offset:5728
    s_waitcnt lgkmcnt(6)
    v_mfma_f32_16x16x32_bf16 v[184:187], v[36:39], v[56:59], v[184:187]
    v_mfma_f32_16x16x32_bf16 v[188:191], v[36:39], v[60:63], v[188:191]
    ds_read_b64_tr_b16 v[36:37], v16 offset:11360
    ds_read_b64_tr_b16 v[38:39], v16 offset:16992
    s_waitcnt lgkmcnt(6)
    v_mfma_f32_16x16x32_bf16 v[192:195], v[40:43], v[56:59], v[192:195]
    v_mfma_f32_16x16x32_bf16 v[196:199], v[40:43], v[60:63], v[196:199]
    s_add_u32 m0, s53, 126976
    s_mul_i32 s60, s57, 9
    buffer_load_dwordx4 v21, s[40:43], s60 offen lds
    ds_read_b64_tr_b16 v[40:41], v16 offset:128
    ds_read_b64_tr_b16 v[42:43], v16 offset:5760
    s_waitcnt lgkmcnt(6)
    v_mfma_f32_16x16x32_bf16 v[200:203], v[44:47], v[56:59], v[200:203]
    v_mfma_f32_16x16x32_bf16 v[204:207], v[44:47], v[60:63], v[204:207]
    ds_read_b64_tr_b16 v[44:45], v16 offset:11392
    ds_read_b64_tr_b16 v[46:47], v16 offset:17024
    s_waitcnt lgkmcnt(6)
    v_mfma_f32_16x16x32_bf16 v[208:211], v[32:35], v[56:59], v[208:211]
    v_mfma_f32_16x16x32_bf16 v[212:215], v[32:35], v[60:63], v[212:215]
    s_add_u32 m0, s54, 126976
    s_mul_i32 s60, s58, 9
    buffer_load_dwordx4 v22, s[44:47], s60 offen lds
    ds_read_b128 v[48:51], v27 offset:31744
    ds_read_b128 v[52:55], v27 offset:32768
    ds_read_b64_tr_b16 v[32:33], v16 offset:31744
    ds_read_b64_tr_b16 v[34:35], v16 offset:37376
    s_waitcnt lgkmcnt(8)
    v_mfma_f32_16x16x32_bf16 v[216:219], v[36:39], v[56:59], v[216:219]
    v_mfma_f32_16x16x32_bf16 v[220:223], v[36:39], v[60:63], v[220:223]
    ds_read_b64_tr_b16 v[36:37], v16 offset:43008
    ds_read_b64_tr_b16 v[38:39], v16 offset:48640
    s_waitcnt lgkmcnt(8)
    v_mfma_f32_16x16x32_bf16 v[224:227], v[40:43], v[56:59], v[224:227]
    v_mfma_f32_16x16x32_bf16 v[228:231], v[40:43], v[60:63], v[228:231]
    s_add_u32 m0, s55, 126976
    s_mul_i32 s60, s59, 9
    buffer_load_dwordx4 v23, s[48:51], s60 offen lds
    ds_read_b64_tr_b16 v[40:41], v16 offset:31776
    ds_read_b64_tr_b16 v[42:43], v16 offset:37408
    s_waitcnt lgkmcnt(8)
    v_mfma_f32_16x16x32_bf16 v[232:235], v[44:47], v[56:59], v[232:235]
    v_mfma_f32_16x16x32_bf16 v[236:239], v[44:47], v[60:63], v[236:239]
    s_waitcnt vmcnt(8)
    s_barrier
    ds_read_b64_tr_b16 v[44:45], v16 offset:43040
    ds_read_b64_tr_b16 v[46:47], v16 offset:48672
    s_waitcnt lgkmcnt(6)
    v_mfma_f32_16x16x32_bf16 v[160:163], v[32:35], v[48:51], v[160:163]
    v_mfma_f32_16x16x32_bf16 v[164:167], v[32:35], v[52:55], v[164:167]
    ds_read_b64_tr_b16 v[32:33], v16 offset:31808
    ds_read_b64_tr_b16 v[34:35], v16 offset:37440
    s_waitcnt lgkmcnt(6)
    v_mfma_f32_16x16x32_bf16 v[168:171], v[36:39], v[48:51], v[168:171]
    v_mfma_f32_16x16x32_bf16 v[172:175], v[36:39], v[52:55], v[172:175]
    s_add_u32 m0, s52, 0
    s_mul_i32 s60, s56, 10
    buffer_load_dwordx4 v20, s[36:39], s60 offen lds
    ds_read_b64_tr_b16 v[36:37], v16 offset:43072
    ds_read_b64_tr_b16 v[38:39], v16 offset:48704
    s_waitcnt lgkmcnt(6)
    v_mfma_f32_16x16x32_bf16 v[176:179], v[40:43], v[48:51], v[176:179]
    v_mfma_f32_16x16x32_bf16 v[180:183], v[40:43], v[52:55], v[180:183]
    ds_read_b64_tr_b16 v[40:41], v16 offset:31840
    ds_read_b64_tr_b16 v[42:43], v16 offset:37472
    s_waitcnt lgkmcnt(6)
    v_mfma_f32_16x16x32_bf16 v[184:187], v[44:47], v[48:51], v[184:187]
    v_mfma_f32_16x16x32_bf16 v[188:191], v[44:47], v[52:55], v[188:191]
    ds_read_b64_tr_b16 v[44:45], v16 offset:43104
    ds_read_b64_tr_b16 v[46:47], v16 offset:48736
    s_waitcnt lgkmcnt(6)
    v_mfma_f32_16x16x32_bf16 v[192:195], v[32:35], v[48:51], v[192:195]
    v_mfma_f32_16x16x32_bf16 v[196:199], v[32:35], v[52:55], v[196:199]
    s_add_u32 m0, s53, 0
    s_mul_i32 s60, s57, 10
    buffer_load_dwordx4 v21, s[40:43], s60 offen lds
    ds_read_b64_tr_b16 v[32:33], v16 offset:31872
    ds_read_b64_tr_b16 v[34:35], v16 offset:37504
    s_waitcnt lgkmcnt(6)
    v_mfma_f32_16x16x32_bf16 v[200:203], v[36:39], v[48:51], v[200:203]
    v_mfma_f32_16x16x32_bf16 v[204:207], v[36:39], v[52:55], v[204:207]
    ds_read_b64_tr_b16 v[36:37], v16 offset:43136
    ds_read_b64_tr_b16 v[38:39], v16 offset:48768
    s_waitcnt lgkmcnt(6)
    v_mfma_f32_16x16x32_bf16 v[208:211], v[40:43], v[48:51], v[208:211]
    v_mfma_f32_16x16x32_bf16 v[212:215], v[40:43], v[52:55], v[212:215]
    s_add_u32 m0, s54, 0
    s_mul_i32 s60, s58, 10
    buffer_load_dwordx4 v22, s[44:47], s60 offen lds
    ds_read_b128 v[56:59], v28 offset:0
    ds_read_b128 v[60:63], v28 offset:1024
    ds_read_b64_tr_b16 v[40:41], v17 offset:0
    ds_read_b64_tr_b16 v[42:43], v17 offset:5632
    s_waitcnt lgkmcnt(8)
    v_mfma_f32_16x16x32_bf16 v[216:219], v[44:47], v[48:51], v[216:219]
    v_mfma_f32_16x16x32_bf16 v[220:223], v[44:47], v[52:55], v[220:223]
    ds_read_b64_tr_b16 v[44:45], v17 offset:11264
    ds_read_b64_tr_b16 v[46:47], v17 offset:16896
    s_waitcnt lgkmcnt(8)
    v_mfma_f32_16x16x32_bf16 v[224:227], v[32:35], v[48:51], v[224:227]
    v_mfma_f32_16x16x32_bf16 v[228:231], v[32:35], v[52:55], v[228:231]
    s_add_u32 m0, s55, 0
    s_mul_i32 s60, s59, 10
    buffer_load_dwordx4 v23, s[48:51], s60 offen lds
    ds_read_b64_tr_b16 v[32:33], v17 offset:32
    ds_read_b64_tr_b16 v[34:35], v17 offset:5664
    s_waitcnt lgkmcnt(8)
    v_mfma_f32_16x16x32_bf16 v[232:235], v[36:39], v[48:51], v[232:235]
    v_mfma_f32_16x16x32_bf16 v[236:239], v[36:39], v[52:55], v[236:239]
    s_waitcnt vmcnt(8)
    s_barrier
    ds_read_b64_tr_b16 v[36:37], v17 offset:11296
    ds_read_b64_tr_b16 v[38:39], v17 offset:16928
    s_waitcnt lgkmcnt(6)
    v_mfma_f32_16x16x32_bf16 v[160:163], v[40:43], v[56:59], v[160:163]
    v_mfma_f32_16x16x32_bf16 v[164:167], v[40:43], v[60:63], v[164:167]
    ds_read_b64_tr_b16 v[40:41], v17 offset:64
    ds_read_b64_tr_b16 v[42:43], v17 offset:5696
    s_waitcnt lgkmcnt(6)
    v_mfma_f32_16x16x32_bf16 v[168:171], v[44:47], v[56:59], v[168:171]
    v_mfma_f32_16x16x32_bf16 v[172:175], v[44:47], v[60:63], v[172:175]
    s_add_u32 m0, s52, 31744
    s_mul_i32 s60, s56, 11
    buffer_load_dwordx4 v20, s[36:39], s60 offen lds
    ds_read_b64_tr_b16 v[44:45], v17 offset:11328
    ds_read_b64_tr_b16 v[46:47], v17 offset:16960
    s_waitcnt lgkmcnt(6)
    v_mfma_f32_16x16x32_bf16 v[176:179], v[32:35], v[56:59], v[176:179]
    v_mfma_f32_16x16x32_bf16 v[180:183], v[32:35], v[60:63], v[180:183]
    ds_read_b64_tr_b16 v[32:33], v17 offset:96
    ds_read_b64_tr_b16 v[34:35], v17 offset:5728
    s_waitcnt lgkmcnt(6)
    v_mfma_f32_16x16x32_bf16 v[184:187], v[36:39], v[56:59], v[184:187]
    v_mfma_f32_16x16x32_bf16 v[188:191], v[36:39], v[60:63], v[188:191]
    ds_read_b64_tr_b16 v[36:37], v17 offset:11360
    ds_read_b64_tr_b16 v[38:39], v17 offset:16992
    s_waitcnt lgkmcnt(6)
    v_mfma_f32_16x16x32_bf16 v[192:195], v[40:43], v[56:59], v[192:195]
    v_mfma_f32_16x16x32_bf16 v[196:199], v[40:43], v[60:63], v[196:199]
    s_add_u32 m0, s53, 31744
    s_mul_i32 s60, s57, 11
    buffer_load_dwordx4 v21, s[40:43], s60 offen lds
    ds_read_b64_tr_b16 v[40:41], v17 offset:128
    ds_read_b64_tr_b16 v[42:43], v17 offset:5760
    s_waitcnt lgkmcnt(6)
    v_mfma_f32_16x16x32_bf16 v[200:203], v[44:47], v[56:59], v[200:203]
    v_mfma_f32_16x16x32_bf16 v[204:207], v[44:47], v[60:63], v[204:207]
    ds_read_b64_tr_b16 v[44:45], v17 offset:11392
    ds_read_b64_tr_b16 v[46:47], v17 offset:17024
    s_waitcnt lgkmcnt(6)
    v_mfma_f32_16x16x32_bf16 v[208:211], v[32:35], v[56:59], v[208:211]
    v_mfma_f32_16x16x32_bf16 v[212:215], v[32:35], v[60:63], v[212:215]
    s_add_u32 m0, s54, 31744
    s_mul_i32 s60, s58, 11
    buffer_load_dwordx4 v22, s[44:47], s60 offen lds
    ds_read_b128 v[48:51], v28 offset:31744
    ds_read_b128 v[52:55], v28 offset:32768
    ds_read_b64_tr_b16 v[32:33], v17 offset:31744
    ds_read_b64_tr_b16 v[34:35], v17 offset:37376
    s_waitcnt lgkmcnt(8)
    v_mfma_f32_16x16x32_bf16 v[216:219], v[36:39], v[56:59], v[216:219]
    v_mfma_f32_16x16x32_bf16 v[220:223], v[36:39], v[60:63], v[220:223]
    ds_read_b64_tr_b16 v[36:37], v17 offset:43008
    ds_read_b64_tr_b16 v[38:39], v17 offset:48640
    s_waitcnt lgkmcnt(8)
    v_mfma_f32_16x16x32_bf16 v[224:227], v[40:43], v[56:59], v[224:227]
    v_mfma_f32_16x16x32_bf16 v[228:231], v[40:43], v[60:63], v[228:231]
    s_add_u32 m0, s55, 31744
    s_mul_i32 s60, s59, 11
    buffer_load_dwordx4 v23, s[48:51], s60 offen lds
    ds_read_b64_tr_b16 v[40:41], v17 offset:31776
    ds_read_b64_tr_b16 v[42:43], v17 offset:37408
    s_waitcnt lgkmcnt(8)
    v_mfma_f32_16x16x32_bf16 v[232:235], v[44:47], v[56:59], v[232:235]
    v_mfma_f32_16x16x32_bf16 v[236:239], v[44:47], v[60:63], v[236:239]
    s_waitcnt vmcnt(8)
    s_barrier
    ds_read_b64_tr_b16 v[44:45], v17 offset:43040
    ds_read_b64_tr_b16 v[46:47], v17 offset:48672
    s_waitcnt lgkmcnt(6)
    v_mfma_f32_16x16x32_bf16 v[160:163], v[32:35], v[48:51], v[160:163]
    v_mfma_f32_16x16x32_bf16 v[164:167], v[32:35], v[52:55], v[164:167]
    ds_read_b64_tr_b16 v[32:33], v17 offset:31808
    ds_read_b64_tr_b16 v[34:35], v17 offset:37440
    s_waitcnt lgkmcnt(6)
    v_mfma_f32_16x16x32_bf16 v[168:171], v[36:39], v[48:51], v[168:171]
    v_mfma_f32_16x16x32_bf16 v[172:175], v[36:39], v[52:55], v[172:175]
    s_add_u32 m0, s52, 63488
    s_mul_i32 s60, s56, 12
    buffer_load_dwordx4 v20, s[36:39], s60 offen lds
    ds_read_b64_tr_b16 v[36:37], v17 offset:43072
    ds_read_b64_tr_b16 v[38:39], v17 offset:48704
    s_waitcnt lgkmcnt(6)
    v_mfma_f32_16x16x32_bf16 v[176:179], v[40:43], v[48:51], v[176:179]
    v_mfma_f32_16x16x32_bf16 v[180:183], v[40:43], v[52:55], v[180:183]
    ds_read_b64_tr_b16 v[40:41], v17 offset:31840
    ds_read_b64_tr_b16 v[42:43], v17 offset:37472
    s_waitcnt lgkmcnt(6)
    v_mfma_f32_16x16x32_bf16 v[184:187], v[44:47], v[48:51], v[184:187]
    v_mfma_f32_16x16x32_bf16 v[188:191], v[44:47], v[52:55], v[188:191]
    ds_read_b64_tr_b16 v[44:45], v17 offset:43104
    ds_read_b64_tr_b16 v[46:47], v17 offset:48736
    s_waitcnt lgkmcnt(6)
    v_mfma_f32_16x16x32_bf16 v[192:195], v[32:35], v[48:51], v[192:195]
    v_mfma_f32_16x16x32_bf16 v[196:199], v[32:35], v[52:55], v[196:199]
    s_add_u32 m0, s53, 63488
    s_mul_i32 s60, s57, 12
    buffer_load_dwordx4 v21, s[40:43], s60 offen lds
    ds_read_b64_tr_b16 v[32:33], v17 offset:31872
    ds_read_b64_tr_b16 v[34:35], v17 offset:37504
    s_waitcnt lgkmcnt(6)
    v_mfma_f32_16x16x32_bf16 v[200:203], v[36:39], v[48:51], v[200:203]
    v_mfma_f32_16x16x32_bf16 v[204:207], v[36:39], v[52:55], v[204:207]
    ds_read_b64_tr_b16 v[36:37], v17 offset:43136
    ds_read_b64_tr_b16 v[38:39], v17 offset:48768
    s_waitcnt lgkmcnt(6)
    v_mfma_f32_16x16x32_bf16 v[208:211], v[40:43], v[48:51], v[208:211]
    v_mfma_f32_16x16x32_bf16 v[212:215], v[40:43], v[52:55], v[212:215]
    s_add_u32 m0, s54, 63488
    s_mul_i32 s60, s58, 12
    buffer_load_dwordx4 v22, s[44:47], s60 offen lds
    ds_read_b128 v[56:59], v29 offset:0
    ds_read_b128 v[60:63], v29 offset:1024
    ds_read_b64_tr_b16 v[40:41], v18 offset:0
    ds_read_b64_tr_b16 v[42:43], v18 offset:5632
    s_waitcnt lgkmcnt(8)
    v_mfma_f32_16x16x32_bf16 v[216:219], v[44:47], v[48:51], v[216:219]
    v_mfma_f32_16x16x32_bf16 v[220:223], v[44:47], v[52:55], v[220:223]
    ds_read_b64_tr_b16 v[44:45], v18 offset:11264
    ds_read_b64_tr_b16 v[46:47], v18 offset:16896
    s_waitcnt lgkmcnt(8)
    v_mfma_f32_16x16x32_bf16 v[224:227], v[32:35], v[48:51], v[224:227]
    v_mfma_f32_16x16x32_bf16 v[228:231], v[32:35], v[52:55], v[228:231]
    s_add_u32 m0, s55, 63488
    s_mul_i32 s60, s59, 12
    buffer_load_dwordx4 v23, s[48:51], s60 offen lds
    ds_read_b64_tr_b16 v[32:33], v18 offset:32
    ds_read_b64_tr_b16 v[34:35], v18 offset:5664
    s_waitcnt lgkmcnt(8)
    v_mfma_f32_16x16x32_bf16 v[232:235], v[36:39], v[48:51], v[232:235]
    v_mfma_f32_16x16x32_bf16 v[236:239], v[36:39], v[52:55], v[236:239]
    s_waitcnt vmcnt(8)
    s_barrier
    ds_read_b64_tr_b16 v[36:37], v18 offset:11296
    ds_read_b64_tr_b16 v[38:39], v18 offset:16928
    s_waitcnt lgkmcnt(6)
    v_mfma_f32_16x16x32_bf16 v[160:163], v[40:43], v[56:59], v[160:163]
    v_mfma_f32_16x16x32_bf16 v[164:167], v[40:43], v[60:63], v[164:167]
    ds_read_b64_tr_b16 v[40:41], v18 offset:64
    ds_read_b64_tr_b16 v[42:43], v18 offset:5696
    s_waitcnt lgkmcnt(6)
    v_mfma_f32_16x16x32_bf16 v[168:171], v[44:47], v[56:59], v[168:171]
    v_mfma_f32_16x16x32_bf16 v[172:175], v[44:47], v[60:63], v[172:175]
    s_add_u32 m0, s52, 95232
    s_mul_i32 s60, s56, 13
    buffer_load_dwordx4 v20, s[36:39], s60 offen lds
    ds_read_b64_tr_b16 v[44:45], v18 offset:11328
    ds_read_b64_tr_b16 v[46:47], v18 offset:16960
    s_waitcnt lgkmcnt(6)
    v_mfma_f32_16x16x32_bf16 v[176:179], v[32:35], v[56:59], v[176:179]
    v_mfma_f32_16x16x32_bf16 v[180:183], v[32:35], v[60:63], v[180:183]
    ds_read_b64_tr_b16 v[32:33], v18 offset:96
    ds_read_b64_tr_b16 v[34:35], v18 offset:5728
    s_waitcnt lgkmcnt(6)
    v_mfma_f32_16x16x32_bf16 v[184:187], v[36:39], v[56:59], v[184:187]
    v_mfma_f32_16x16x32_bf16 v[188:191], v[36:39], v[60:63], v[188:191]
    ds_read_b64_tr_b16 v[36:37], v18 offset:11360
    ds_read_b64_tr_b16 v[38:39], v18 offset:16992
    s_waitcnt lgkmcnt(6)
    v_mfma_f32_16x16x32_bf16 v[192:195], v[40:43], v[56:59], v[192:195]
    v_mfma_f32_16x16x32_bf16 v[196:199], v[40:43], v[60:63], v[196:199]
    s_add_u32 m0, s53, 95232
    s_mul_i32 s60, s57, 13
    buffer_load_dwordx4 v21, s[40:43], s60 offen lds
    ds_read_b64_tr_b16 v[40:41], v18 offset:128
    ds_read_b64_tr_b16 v[42:43], v18 offset:5760
    s_waitcnt lgkmcnt(6)
    v_mfma_f32_16x16x32_bf16 v[200:203], v[44:47], v[56:59], v[200:203]
    v_mfma_f32_16x16x32_bf16 v[204:207], v[44:47], v[60:63], v[204:207]
    ds_read_b64_tr_b16 v[44:45], v18 offset:11392
    ds_read_b64_tr_b16 v[46:47], v18 offset:17024
    s_waitcnt lgkmcnt(6)
    v_mfma_f32_16x16x32_bf16 v[208:211], v[32:35], v[56:59], v[208:211]
    v_mfma_f32_16x16x32_bf16 v[212:215], v[32:35], v[60:63], v[212:215]
    s_add_u32 m0, s54, 95232
    s_mul_i32 s60, s58, 13
    buffer_load_dwordx4 v22, s[44:47], s60 offen lds
    ds_read_b128 v[48:51], v27 offset:0
    ds_read_b128 v[52:55], v27 offset:1024
    ds_read_b64_tr_b16 v[32:33], v16 offset:0
    ds_read_b64_tr_b16 v[34:35], v16 offset:5632
    s_waitcnt lgkmcnt(8)
    v_mfma_f32_16x16x32_bf16 v[216:219], v[36:39], v[56:59], v[216:219]
    v_mfma_f32_16x16x32_bf16 v[220:223], v[36:39], v[60:63], v[220:223]
    ds_read_b64_tr_b16 v[36:37], v16 offset:11264
    ds_read_b64_tr_b16 v[38:39], v16 offset:16896
    s_waitcnt lgkmcnt(8)
    v_mfma_f32_16x16x32_bf16 v[224:227], v[40:43], v[56:59], v[224:227]
    v_mfma_f32_16x16x32_bf16 v[228:231], v[40:43], v[60:63], v[228:231]
    s_add_u32 m0, s55, 95232
    s_mul_i32 s60, s59, 13
    buffer_load_dwordx4 v23, s[48:51], s60 offen lds
    ds_read_b64_tr_b16 v[40:41], v16 offset:32
    ds_read_b64_tr_b16 v[42:43], v16 offset:5664
    s_waitcnt lgkmcnt(8)
    v_mfma_f32_16x16x32_bf16 v[232:235], v[44:47], v[56:59], v[232:235]
    v_mfma_f32_16x16x32_bf16 v[236:239], v[44:47], v[60:63], v[236:239]
    s_waitcnt vmcnt(8)
    s_barrier
    ds_read_b64_tr_b16 v[44:45], v16 offset:11296
    ds_read_b64_tr_b16 v[46:47], v16 offset:16928
    s_waitcnt lgkmcnt(6)
    v_mfma_f32_16x16x32_bf16 v[160:163], v[32:35], v[48:51], v[160:163]
    v_mfma_f32_16x16x32_bf16 v[164:167], v[32:35], v[52:55], v[164:167]
    ds_read_b64_tr_b16 v[32:33], v16 offset:64
    ds_read_b64_tr_b16 v[34:35], v16 offset:5696
    s_waitcnt lgkmcnt(6)
    v_mfma_f32_16x16x32_bf16 v[168:171], v[36:39], v[48:51], v[168:171]
    v_mfma_f32_16x16x32_bf16 v[172:175], v[36:39], v[52:55], v[172:175]
    s_add_u32 m0, s52, 126976
    s_mul_i32 s60, s56, 14
    buffer_load_dwordx4 v20, s[36:39], s60 offen lds
    ds_read_b64_tr_b16 v[36:37], v16 offset:11328
    ds_read_b64_tr_b16 v[38:39], v16 offset:16960
    s_waitcnt lgkmcnt(6)
    v_mfma_f32_16x16x32_bf16 v[176:179], v[40:43], v[48:51], v[176:179]
    v_mfma_f32_16x16x32_bf16 v[180:183], v[40:43], v[52:55], v[180:183]
    ds_read_b64_tr_b16 v[40:41], v16 offset:96
    ds_read_b64_tr_b16 v[42:43], v16 offset:5728
    s_waitcnt lgkmcnt(6)
    v_mfma_f32_16x16x32_bf16 v[184:187], v[44:47], v[48:51], v[184:187]
    v_mfma_f32_16x16x32_bf16 v[188:191], v[44:47], v[52:55], v[188:191]
    ds_read_b64_tr_b16 v[44:45], v16 offset:11360
    ds_read_b64_tr_b16 v[46:47], v16 offset:16992
    s_waitcnt lgkmcnt(6)
    v_mfma_f32_16x16x32_bf16 v[192:195], v[32:35], v[48:51], v[192:195]
    v_mfma_f32_16x16x32_bf16 v[196:199], v[32:35], v[52:55], v[196:199]
    s_add_u32 m0, s53, 126976
    s_mul_i32 s60, s57, 14
    buffer_load_dwordx4 v21, s[40:43], s60 offen lds
    ds_read_b64_tr_b16 v[32:33], v16 offset:128
    ds_read_b64_tr_b16 v[34:35], v16 offset:5760
    s_waitcnt lgkmcnt(6)
    v_mfma_f32_16x16x32_bf16 v[200:203], v[36:39], v[48:51], v[200:203]
    v_mfma_f32_16x16x32_bf16 v[204:207], v[36:39], v[52:55], v[204:207]
    ds_read_b64_tr_b16 v[36:37], v16 offset:11392
    ds_read_b64_tr_b16 v[38:39], v16 offset:17024
    s_waitcnt lgkmcnt(6)
    v_mfma_f32_16x16x32_bf16 v[208:211], v[40:43], v[48:51], v[208:211]
    v_mfma_f32_16x16x32_bf16 v[212:215], v[40:43], v[52:55], v[212:215]
    s_add_u32 m0, s54, 126976
    s_mul_i32 s60, s58, 14
    buffer_load_dwordx4 v22, s[44:47], s60 offen lds
    ds_read_b128 v[56:59], v27 offset:31744
    ds_read_b128 v[60:63], v27 offset:32768
    ds_read_b64_tr_b16 v[40:41], v16 offset:31744
    ds_read_b64_tr_b16 v[42:43], v16 offset:37376
    s_waitcnt lgkmcnt(8)
    v_mfma_f32_16x16x32_bf16 v[216:219], v[44:47], v[48:51], v[216:219]
    v_mfma_f32_16x16x32_bf16 v[220:223], v[44:47], v[52:55], v[220:223]
    ds_read_b64_tr_b16 v[44:45], v16 offset:43008
    ds_read_b64_tr_b16 v[46:47], v16 offset:48640
    s_waitcnt lgkmcnt(8)
    v_mfma_f32_16x16x32_bf16 v[224:227], v[32:35], v[48:51], v[224:227]
    v_mfma_f32_16x16x32_bf16 v[228:231], v[32:35], v[52:55], v[228:231]
    s_add_u32 m0, s55, 126976
    s_mul_i32 s60, s59, 14
    buffer_load_dwordx4 v23, s[48:51], s60 offen lds
    ds_read_b64_tr_b16 v[32:33], v16 offset:31776
    ds_read_b64_tr_b16 v[34:35], v16 offset:37408
    s_waitcnt lgkmcnt(8)
    v_mfma_f32_16x16x32_bf16 v[232:235], v[36:39], v[48:51], v[232:235]
    v_mfma_f32_16x16x32_bf16 v[236:239], v[36:39], v[52:55], v[236:239]
    s_waitcnt vmcnt(8)
    s_barrier
    ds_read_b64_tr_b16 v[36:37], v16 offset:43040
    ds_read_b64_tr_b16 v[38:39], v16 offset:48672
    s_waitcnt lgkmcnt(6)
    v_mfma_f32_16x16x32_bf16 v[160:163], v[40:43], v[56:59], v[160:163]
    v_mfma_f32_16x16x32_bf16 v[164:167], v[40:43], v[60:63], v[164:167]
    ds_read_b64_tr_b16 v[40:41], v16 offset:31808
    ds_read_b64_tr_b16 v[42:43], v16 offset:37440
    s_waitcnt lgkmcnt(6)
    v_mfma_f32_16x16x32_bf16 v[168:171], v[44:47], v[56:59], v[168:171]
    v_mfma_f32_16x16x32_bf16 v[172:175], v[44:47], v[60:63], v[172:175]
    s_add_u32 m0, s52, 0
    s_mul_i32 s60, s56, 15
    buffer_load_dwordx4 v20, s[36:39], s60 offen lds
    ds_read_b64_tr_b16 v[44:45], v16 offset:43072
    ds_read_b64_tr_b16 v[46:47], v16 offset:48704
    s_waitcnt lgkmcnt(6)
    v_mfma_f32_16x16x32_bf16 v[176:179], v[32:35], v[56:59], v[176:179]
    v_mfma_f32_16x16x32_bf16 v[180:183], v[32:35], v[60:63], v[180:183]
    ds_read_b64_tr_b16 v[32:33], v16 offset:31840
    ds_read_b64_tr_b16 v[34:35], v16 offset:37472
    s_waitcnt lgkmcnt(6)
    v_mfma_f32_16x16x32_bf16 v[184:187], v[36:39], v[56:59], v[184:187]
    v_mfma_f32_16x16x32_bf16 v[188:191], v[36:39], v[60:63], v[188:191]
    ds_read_b64_tr_b16 v[36:37], v16 offset:43104
    ds_read_b64_tr_b16 v[38:39], v16 offset:48736
    s_waitcnt lgkmcnt(6)
    v_mfma_f32_16x16x32_bf16 v[192:195], v[40:43], v[56:59], v[192:195]
    v_mfma_f32_16x16x32_bf16 v[196:199], v[40:43], v[60:63], v[196:199]
    s_add_u32 m0, s53, 0
    s_mul_i32 s60, s57, 15
    buffer_load_dwordx4 v21, s[40:43], s60 offen lds
    ds_read_b64_tr_b16 v[40:41], v16 offset:31872
    ds_read_b64_tr_b16 v[42:43], v16 offset:37504
    s_waitcnt lgkmcnt(6)
    v_mfma_f32_16x16x32_bf16 v[200:203], v[44:47], v[56:59], v[200:203]
    v_mfma_f32_16x16x32_bf16 v[204:207], v[44:47], v[60:63], v[204:207]
    ds_read_b64_tr_b16 v[44:45], v16 offset:43136
    ds_read_b64_tr_b16 v[46:47], v16 offset:48768
    s_waitcnt lgkmcnt(6)
    v_mfma_f32_16x16x32_bf16 v[208:211], v[32:35], v[56:59], v[208:211]
    v_mfma_f32_16x16x32_bf16 v[212:215], v[32:35], v[60:63], v[212:215]
    s_add_u32 m0, s54, 0
    s_mul_i32 s60, s58, 15
    buffer_load_dwordx4 v22, s[44:47], s60 offen lds
    ds_read_b128 v[48:51], v28 offset:0
    ds_read_b128 v[52:55], v28 offset:1024
    ds_read_b64_tr_b16 v[32:33], v17 offset:0
    ds_read_b64_tr_b16 v[34:35], v17 offset:5632
    s_waitcnt lgkmcnt(8)
    v_mfma_f32_16x16x32_bf16 v[216:219], v[36:39], v[56:59], v[216:219]
    v_mfma_f32_16x16x32_bf16 v[220:223], v[36:39], v[60:63], v[220:223]
    ds_read_b64_tr_b16 v[36:37], v17 offset:11264
    ds_read_b64_tr_b16 v[38:39], v17 offset:16896
    s_waitcnt lgkmcnt(8)
    v_mfma_f32_16x16x32_bf16 v[224:227], v[40:43], v[56:59], v[224:227]
    v_mfma_f32_16x16x32_bf16 v[228:231], v[40:43], v[60:63], v[228:231]
    s_add_u32 m0, s55, 0
    s_mul_i32 s60, s59, 15
    buffer_load_dwordx4 v23, s[48:51], s60 offen lds
    ds_read_b64_tr_b16 v[40:41], v17 offset:32
    ds_read_b64_tr_b16 v[42:43], v17 offset:5664
    s_waitcnt lgkmcnt(8)
    v_mfma_f32_16x16x32_bf16 v[232:235], v[44:47], v[56:59], v[232:235]
    v_mfma_f32_16x16x32_bf16 v[236:239], v[44:47], v[60:63], v[236:239]
    s_waitcnt vmcnt(8)
    s_barrier
    ds_read_b64_tr_b16 v[44:45], v17 offset:11296
    ds_read_b64_tr_b16 v[46:47], v17 offset:16928
    s_waitcnt lgkmcnt(6)
    v_mfma_f32_16x16x32_bf16 v[160:163], v[32:35], v[48:51], v[160:163]
    v_mfma_f32_16x16x32_bf16 v[164:167], v[32:35], v[52:55], v[164:167]
    ds_read_b64_tr_b16 v[32:33], v17 offset:64
    ds_read_b64_tr_b16 v[34:35], v17 offset:5696
    s_waitcnt lgkmcnt(6)
    v_mfma_f32_16x16x32_bf16 v[168:171], v[36:39], v[48:51], v[168:171]
    v_mfma_f32_16x16x32_bf16 v[172:175], v[36:39], v[52:55], v[172:175]
    ds_read_b64_tr_b16 v[36:37], v17 offset:11328
    ds_read_b64_tr_b16 v[38:39], v17 offset:16960
    s_waitcnt lgkmcnt(6)
    v_mfma_f32_16x16x32_bf16 v[176:179], v[40:43], v[48:51], v[176:179]
    v_mfma_f32_16x16x32_bf16 v[180:183], v[40:43], v[52:55], v[180:183]
    ds_read_b64_tr_b16 v[40:41], v17 offset:96
    ds_read_b64_tr_b16 v[42:43], v17 offset:5728
    s_waitcnt lgkmcnt(6)
    v_mfma_f32_16x16x32_bf16 v[184:187], v[44:47], v[48:51], v[184:187]
    v_mfma_f32_16x16x32_bf16 v[188:191], v[44:47], v[52:55], v[188:191]
    ds_read_b64_tr_b16 v[44:45], v17 offset:11360
    ds_read_b64_tr_b16 v[46:47], v17 offset:16992
    s_waitcnt lgkmcnt(6)
    v_mfma_f32_16x16x32_bf16 v[192:195], v[32:35], v[48:51], v[192:195]
    v_mfma_f32_16x16x32_bf16 v[196:199], v[32:35], v[52:55], v[196:199]
    ds_read_b64_tr_b16 v[32:33], v17 offset:128
    ds_read_b64_tr_b16 v[34:35], v17 offset:5760
    s_waitcnt lgkmcnt(6)
    v_mfma_f32_16x16x32_bf16 v[200:203], v[36:39], v[48:51], v[200:203]
    v_mfma_f32_16x16x32_bf16 v[204:207], v[36:39], v[52:55], v[204:207]
    ds_read_b64_tr_b16 v[36:37], v17 offset:11392
    ds_read_b64_tr_b16 v[38:39], v17 offset:17024
    s_waitcnt lgkmcnt(6)
    v_mfma_f32_16x16x32_bf16 v[208:211], v[40:43], v[48:51], v[208:211]
    v_mfma_f32_16x16x32_bf16 v[212:215], v[40:43], v[52:55], v[212:215]
    ds_read_b128 v[56:59], v28 offset:31744
    ds_read_b128 v[60:63], v28 offset:32768
    ds_read_b64_tr_b16 v[40:41], v17 offset:31744
    ds_read_b64_tr_b16 v[42:43], v17 offset:37376
    s_waitcnt lgkmcnt(8)
    v_mfma_f32_16x16x32_bf16 v[216:219], v[44:47], v[48:51], v[216:219]
    v_mfma_f32_16x16x32_bf16 v[220:223], v[44:47], v[52:55], v[220:223]
    ds_read_b64_tr_b16 v[44:45], v17 offset:43008
    ds_read_b64_tr_b16 v[46:47], v17 offset:48640
    s_waitcnt lgkmcnt(8)
    v_mfma_f32_16x16x32_bf16 v[224:227], v[32:35], v[48:51], v[224:227]
    v_mfma_f32_16x16x32_bf16 v[228:231], v[32:35], v[52:55], v[228:231]
    ds_read_b64_tr_b16 v[32:33], v17 offset:31776
    ds_read_b64_tr_b16 v[34:35], v17 offset:37408
    s_waitcnt lgkmcnt(8)
    v_mfma_f32_16x16x32_bf16 v[232:235], v[36:39], v[48:51], v[232:235]
    v_mfma_f32_16x16x32_bf16 v[236:239], v[36:39], v[52:55], v[236:239]
    s_waitcnt vmcnt(4)
    s_barrier
    ds_read_b64_tr_b16 v[36:37], v17 offset:43040
    ds_read_b64_tr_b16 v[38:39], v17 offset:48672
    s_waitcnt lgkmcnt(6)
    v_mfma_f32_16x16x32_bf16 v[160:163], v[40:43], v[56:59], v[160:163]
    v_mfma_f32_16x16x32_bf16 v[164:167], v[40:43], v[60:63], v[164:167]
    ds_read_b64_tr_b16 v[40:41], v17 offset:31808
    ds_read_b64_tr_b16 v[42:43], v17 offset:37440
    s_waitcnt lgkmcnt(6)
    v_mfma_f32_16x16x32_bf16 v[168:171], v[44:47], v[56:59], v[168:171]
    v_mfma_f32_16x16x32_bf16 v[172:175], v[44:47], v[60:63], v[172:175]
    ds_read_b64_tr_b16 v[44:45], v17 offset:43072
    ds_read_b64_tr_b16 v[46:47], v17 offset:48704
    s_waitcnt lgkmcnt(6)
    v_mfma_f32_16x16x32_bf16 v[176:179], v[32:35], v[56:59], v[176:179]
    v_mfma_f32_16x16x32_bf16 v[180:183], v[32:35], v[60:63], v[180:183]
    ds_read_b64_tr_b16 v[32:33], v17 offset:31840
    ds_read_b64_tr_b16 v[34:35], v17 offset:37472
    s_waitcnt lgkmcnt(6)
    v_mfma_f32_16x16x32_bf16 v[184:187], v[36:39], v[56:59], v[184:187]
    v_mfma_f32_16x16x32_bf16 v[188:191], v[36:39], v[60:63], v[188:191]
    ds_read_b64_tr_b16 v[36:37], v17 offset:43104
    ds_read_b64_tr_b16 v[38:39], v17 offset:48736
    s_waitcnt lgkmcnt(6)
    v_mfma_f32_16x16x32_bf16 v[192:195], v[40:43], v[56:59], v[192:195]
    v_mfma_f32_16x16x32_bf16 v[196:199], v[40:43], v[60:63], v[196:199]
    ds_read_b64_tr_b16 v[40:41], v17 offset:31872
    ds_read_b64_tr_b16 v[42:43], v17 offset:37504
    s_waitcnt lgkmcnt(6)
    v_mfma_f32_16x16x32_bf16 v[200:203], v[44:47], v[56:59], v[200:203]
    v_mfma_f32_16x16x32_bf16 v[204:207], v[44:47], v[60:63], v[204:207]
    ds_read_b64_tr_b16 v[44:45], v17 offset:43136
    ds_read_b64_tr_b16 v[46:47], v17 offset:48768
    s_waitcnt lgkmcnt(6)
    v_mfma_f32_16x16x32_bf16 v[208:211], v[32:35], v[56:59], v[208:211]
    v_mfma_f32_16x16x32_bf16 v[212:215], v[32:35], v[60:63], v[212:215]
    ds_read_b128 v[48:51], v29 offset:0
    ds_read_b128 v[52:55], v29 offset:1024
    ds_read_b64_tr_b16 v[32:33], v18 offset:0
    ds_read_b64_tr_b16 v[34:35], v18 offset:5632
    s_waitcnt lgkmcnt(8)
    v_mfma_f32_16x16x32_bf16 v[216:219], v[36:39], v[56:59], v[216:219]
    v_mfma_f32_16x16x32_bf16 v[220:223], v[36:39], v[60:63], v[220:223]
    ds_read_b64_tr_b16 v[36:37], v18 offset:11264
    ds_read_b64_tr_b16 v[38:39], v18 offset:16896
    s_waitcnt lgkmcnt(8)
    v_mfma_f32_16x16x32_bf16 v[224:227], v[40:43], v[56:59], v[224:227]
    v_mfma_f32_16x16x32_bf16 v[228:231], v[40:43], v[60:63], v[228:231]
    ds_read_b64_tr_b16 v[40:41], v18 offset:32
    ds_read_b64_tr_b16 v[42:43], v18 offset:5664
    s_waitcnt lgkmcnt(8)
    v_mfma_f32_16x16x32_bf16 v[232:235], v[44:47], v[56:59], v[232:235]
    v_mfma_f32_16x16x32_bf16 v[236:239], v[44:47], v[60:63], v[236:239]
    s_waitcnt vmcnt(0)
    s_barrier
    ds_read_b64_tr_b16 v[44:45], v18 offset:11296
    ds_read_b64_tr_b16 v[46:47], v18 offset:16928
    s_waitcnt lgkmcnt(6)
    v_mfma_f32_16x16x32_bf16 v[160:163], v[32:35], v[48:51], v[160:163]
    v_mfma_f32_16x16x32_bf16 v[164:167], v[32:35], v[52:55], v[164:167]
    ds_read_b64_tr_b16 v[32:33], v18 offset:64
    ds_read_b64_tr_b16 v[34:35], v18 offset:5696
    s_waitcnt lgkmcnt(6)
    v_mfma_f32_16x16x32_bf16 v[168:171], v[36:39], v[48:51], v[168:171]
    v_mfma_f32_16x16x32_bf16 v[172:175], v[36:39], v[52:55], v[172:175]
    ds_read_b64_tr_b16 v[36:37], v18 offset:11328
    ds_read_b64_tr_b16 v[38:39], v18 offset:16960
    s_waitcnt lgkmcnt(6)
    v_mfma_f32_16x16x32_bf16 v[176:179], v[40:43], v[48:51], v[176:179]
    v_mfma_f32_16x16x32_bf16 v[180:183], v[40:43], v[52:55], v[180:183]
    ds_read_b64_tr_b16 v[40:41], v18 offset:96
    ds_read_b64_tr_b16 v[42:43], v18 offset:5728
    s_waitcnt lgkmcnt(6)
    v_mfma_f32_16x16x32_bf16 v[184:187], v[44:47], v[48:51], v[184:187]
    v_mfma_f32_16x16x32_bf16 v[188:191], v[44:47], v[52:55], v[188:191]
    ds_read_b64_tr_b16 v[44:45], v18 offset:11360
    ds_read_b64_tr_b16 v[46:47], v18 offset:16992
    s_waitcnt lgkmcnt(6)
    v_mfma_f32_16x16x32_bf16 v[192:195], v[32:35], v[48:51], v[192:195]
    v_mfma_f32_16x16x32_bf16 v[196:199], v[32:35], v[52:55], v[196:199]
    ds_read_b64_tr_b16 v[32:33], v18 offset:128
    ds_read_b64_tr_b16 v[34:35], v18 offset:5760
    s_waitcnt lgkmcnt(6)
    v_mfma_f32_16x16x32_bf16 v[200:203], v[36:39], v[48:51], v[200:203]
    v_mfma_f32_16x16x32_bf16 v[204:207], v[36:39], v[52:55], v[204:207]
    ds_read_b64_tr_b16 v[36:37], v18 offset:11392
    ds_read_b64_tr_b16 v[38:39], v18 offset:17024
    s_waitcnt lgkmcnt(6)
    v_mfma_f32_16x16x32_bf16 v[208:211], v[40:43], v[48:51], v[208:211]
    v_mfma_f32_16x16x32_bf16 v[212:215], v[40:43], v[52:55], v[212:215]
    ds_read_b128 v[56:59], v27 offset:0
    ds_read_b128 v[60:63], v27 offset:1024
    ds_read_b64_tr_b16 v[40:41], v16 offset:0
    ds_read_b64_tr_b16 v[42:43], v16 offset:5632
    s_waitcnt lgkmcnt(8)
    v_mfma_f32_16x16x32_bf16 v[216:219], v[44:47], v[48:51], v[216:219]
    v_mfma_f32_16x16x32_bf16 v[220:223], v[44:47], v[52:55], v[220:223]
    ds_read_b64_tr_b16 v[44:45], v16 offset:11264
    ds_read_b64_tr_b16 v[46:47], v16 offset:16896
    s_waitcnt lgkmcnt(8)
    v_mfma_f32_16x16x32_bf16 v[224:227], v[32:35], v[48:51], v[224:227]
    v_mfma_f32_16x16x32_bf16 v[228:231], v[32:35], v[52:55], v[228:231]
    ds_read_b64_tr_b16 v[32:33], v16 offset:32
    ds_read_b64_tr_b16 v[34:35], v16 offset:5664
    s_waitcnt lgkmcnt(8)
    v_mfma_f32_16x16x32_bf16 v[232:235], v[36:39], v[48:51], v[232:235]
    v_mfma_f32_16x16x32_bf16 v[236:239], v[36:39], v[52:55], v[236:239]
    s_waitcnt vmcnt(0)
    s_barrier
    ds_read_b64_tr_b16 v[36:37], v16 offset:11296
    ds_read_b64_tr_b16 v[38:39], v16 offset:16928
    s_waitcnt lgkmcnt(6)
    v_mfma_f32_16x16x32_bf16 v[160:163], v[40:43], v[56:59], v[160:163]
    v_mfma_f32_16x16x32_bf16 v[164:167], v[40:43], v[60:63], v[164:167]
    ds_read_b64_tr_b16 v[40:41], v16 offset:64
    ds_read_b64_tr_b16 v[42:43], v16 offset:5696
    s_waitcnt lgkmcnt(6)
    v_mfma_f32_16x16x32_bf16 v[168:171], v[44:47], v[56:59], v[168:171]
    v_mfma_f32_16x16x32_bf16 v[172:175], v[44:47], v[60:63], v[172:175]
    ds_read_b64_tr_b16 v[44:45], v16 offset:11328
    ds_read_b64_tr_b16 v[46:47], v16 offset:16960
    s_waitcnt lgkmcnt(6)
    v_mfma_f32_16x16x32_bf16 v[176:179], v[32:35], v[56:59], v[176:179]
    v_mfma_f32_16x16x32_bf16 v[180:183], v[32:35], v[60:63], v[180:183]
    ds_read_b64_tr_b16 v[32:33], v16 offset:96
    ds_read_b64_tr_b16 v[34:35], v16 offset:5728
    s_waitcnt lgkmcnt(6)
    v_mfma_f32_16x16x32_bf16 v[184:187], v[36:39], v[56:59], v[184:187]
    v_mfma_f32_16x16x32_bf16 v[188:191], v[36:39], v[60:63], v[188:191]
    ds_read_b64_tr_b16 v[36:37], v16 offset:11360
    ds_read_b64_tr_b16 v[38:39], v16 offset:16992
    s_waitcnt lgkmcnt(6)
    v_mfma_f32_16x16x32_bf16 v[192:195], v[40:43], v[56:59], v[192:195]
    v_mfma_f32_16x16x32_bf16 v[196:199], v[40:43], v[60:63], v[196:199]
    ds_read_b64_tr_b16 v[40:41], v16 offset:128
    ds_read_b64_tr_b16 v[42:43], v16 offset:5760
    s_waitcnt lgkmcnt(6)
    v_mfma_f32_16x16x32_bf16 v[200:203], v[44:47], v[56:59], v[200:203]
    v_mfma_f32_16x16x32_bf16 v[204:207], v[44:47], v[60:63], v[204:207]
    ds_read_b64_tr_b16 v[44:45], v16 offset:11392
    ds_read_b64_tr_b16 v[46:47], v16 offset:17024
    s_waitcnt lgkmcnt(6)
    v_mfma_f32_16x16x32_bf16 v[208:211], v[32:35], v[56:59], v[208:211]
    v_mfma_f32_16x16x32_bf16 v[212:215], v[32:35], v[60:63], v[212:215]
    s_waitcnt lgkmcnt(4)
    v_mfma_f32_16x16x32_bf16 v[216:219], v[36:39], v[56:59], v[216:219]
    v_mfma_f32_16x16x32_bf16 v[220:223], v[36:39], v[60:63], v[220:223]
    s_waitcnt lgkmcnt(2)
    v_mfma_f32_16x16x32_bf16 v[224:227], v[40:43], v[56:59], v[224:227]
    v_mfma_f32_16x16x32_bf16 v[228:231], v[40:43], v[60:63], v[228:231]
    s_waitcnt lgkmcnt(0)
    v_mfma_f32_16x16x32_bf16 v[232:235], v[44:47], v[56:59], v[232:235]
    v_mfma_f32_16x16x32_bf16 v[236:239], v[44:47], v[60:63], v[236:239]
k1_gu_epi:
    s_nop 7
    v_and_b32 v4, 15, v2
    v_lshlrev_b32 v4, 4, v4
    v_lshrrev_b32 v5, 5, v2
    v_lshl_add_u32 v4, v5, 8, v4
    v_bfe_u32 v5, v2, 4, 1
    v_mul_u32_u24 v5, 44032, v5
    v_add_u32 v4, v4, v5
    s_mul_i32 s71, s66, 11
    s_mul_i32 s72, s70, 6
    s_add_u32 s71, s71, s72
    s_lshr_b32 s72, s73, 4
    s_mul_i32 s72, s72, 44032
    s_lshl_b32 s74, s71, 9
    s_add_u32 s72, s72, s74
    s_add_u32 s72, s72, 2097152
    v_add_u32 v4, s72, v4
    s_add_u32 s72, s71, 0
    s_cmp_ge_u32 s72, 86
    s_cbranch_scc1 k1_end
    v_cvt_pk_bf16_f32 v48, v160, v161
    v_cvt_pk_bf16_f32 v49, v162, v163
    v_cvt_pk_bf16_f32 v50, v168, v169
    v_cvt_pk_bf16_f32 v51, v170, v171
    v_cvt_pk_bf16_f32 v56, v164, v165
    v_cvt_pk_bf16_f32 v57, v166, v167
    v_cvt_pk_bf16_f32 v58, v172, v173
    v_cvt_pk_bf16_f32 v59, v174, v175
    v_lshlrev_b32 v160, 16, v48
    v_and_b32 v161, 0xffff0000, v48
    v_lshlrev_b32 v168, 16, v50
    v_and_b32 v169, 0xffff0000, v50
    v_lshlrev_b32 v162, 16, v49
    v_and_b32 v163, 0xffff0000, v49
    v_lshlrev_b32 v170, 16, v51
    v_and_b32 v171, 0xffff0000, v51
    v_lshlrev_b32 v164, 16, v56
    v_and_b32 v165, 0xffff0000, v56
    v_lshlrev_b32 v172, 16, v58
    v_and_b32 v173, 0xffff0000, v58
    v_lshlrev_b32 v166, 16, v57
    v_and_b32 v167, 0xffff0000, v57
    v_lshlrev_b32 v174, 16, v59
    v_and_b32 v175, 0xffff0000, v59
    v_pk_mul_f32 v[48:49], v[160:161], s[62:63]
    v_pk_mul_f32 v[50:51], v[162:163], s[62:63]
    v_pk_mul_f32 v[56:57], v[164:165], s[62:63]
    v_pk_mul_f32 v[58:59], v[166:167], s[62:63]
    v_exp_f32 v48, -v48
    v_exp_f32 v49, -v49
    v_exp_f32 v50, -v50
    v_exp_f32 v51, -v51
    v_exp_f32 v56, -v56
    v_exp_f32 v57, -v57
    v_exp_f32 v58, -v58
    v_exp_f32 v59, -v59
    s_nop 0
    v_pk_add_f32 v[48:49], v[48:49], s[64:65]
    v_pk_add_f32 v[50:51], v[50:51], s[64:65]
    v_pk_add_f32 v[56:57], v[56:57], s[64:65]
    v_pk_add_f32 v[58:59], v[58:59], s[64:65]
    v_rcp_f32 v48, v48
    v_rcp_f32 v49, v49
    v_rcp_f32 v50, v50
    v_rcp_f32 v51, v51
    v_rcp_f32 v56, v56
    v_rcp_f32 v57, v57
    v_rcp_f32 v58, v58
    v_rcp_f32 v59, v59
    s_nop 0
    v_pk_mul_f32 v[48:49], v[48:49], v[160:161]
    v_pk_mul_f32 v[50:51], v[50:51], v[162:163]
    v_pk_mul_f32 v[56:57], v[56:57], v[164:165]
    v_pk_mul_f32 v[58:59], v[58:59], v[166:167]
    v_cvt_pk_bf16_f32 v52, v48, v49
    v_cvt_pk_bf16_f32 v53, v50, v51
    v_cvt_pk_bf16_f32 v60, v56, v57
    v_cvt_pk_bf16_f32 v61, v58, v59
    v_lshlrev_b32 v48, 16, v52
    v_and_b32 v49, 0xffff0000, v52
    v_lshlrev_b32 v50, 16, v53
    v_and_b32 v51, 0xffff0000, v53
    v_lshlrev_b32 v56, 16, v60
    v_and_b32 v57, 0xffff0000, v60
    v_lshlrev_b32 v58, 16, v61
    v_and_b32 v59, 0xffff0000, v61
    v_pk_mul_f32 v[48:49], v[48:49], v[168:169]
    v_pk_mul_f32 v[50:51], v[50:51], v[170:171]
    v_pk_mul_f32 v[56:57], v[56:57], v[172:173]
    v_pk_mul_f32 v[58:59], v[58:59], v[174:175]
    v_cvt_pk_bf16_f32 v160, v48, v49
    v_cvt_pk_bf16_f32 v161, v50, v51
    v_cvt_pk_bf16_f32 v162, v56, v57
    v_cvt_pk_bf16_f32 v163, v58, v59
    s_nop 0
    v_permlane16_swap_b32 v160, v162
    v_permlane16_swap_b32 v161, v163
    buffer_store_dwordx4 v[160:163], v4, s[24:27], 0 offen offset:0 sc1
    s_add_u32 s72, s71, 1
    s_cmp_ge_u32 s72, 86
    s_cbranch_scc1 k1_end
    v_cvt_pk_bf16_f32 v48, v176, v177
    v_cvt_pk_bf16_f32 v49, v178, v179
    v_cvt_pk_bf16_f32 v50, v184, v185
    v_cvt_pk_bf16_f32 v51, v186, v187
    v_cvt_pk_bf16_f32 v56, v180, v181
    v_cvt_pk_bf16_f32 v57, v182, v183
    v_cvt_pk_bf16_f32 v58, v188, v189
    v_cvt_pk_bf16_f32 v59, v190, v191
    v_lshlrev_b32 v176, 16, v48
    v_and_b32 v177, 0xffff0000, v48
    v_lshlrev_b32 v184, 16, v50
    v_and_b32 v185, 0xffff0000, v50
    v_lshlrev_b32 v178, 16, v49
    v_and_b32 v179, 0xffff0000, v49
    v_lshlrev_b32 v186, 16, v51
    v_and_b32 v187, 0xffff0000, v51
    v_lshlrev_b32 v180, 16, v56
    v_and_b32 v181, 0xffff0000, v56
    v_lshlrev_b32 v188, 16, v58
    v_and_b32 v189, 0xffff0000, v58
    v_lshlrev_b32 v182, 16, v57
    v_and_b32 v183, 0xffff0000, v57
    v_lshlrev_b32 v190, 16, v59
    v_and_b32 v191, 0xffff0000, v59
    v_pk_mul_f32 v[48:49], v[176:177], s[62:63]
    v_pk_mul_f32 v[50:51], v[178:179], s[62:63]
    v_pk_mul_f32 v[56:57], v[180:181], s[62:63]
    v_pk_mul_f32 v[58:59], v[182:183], s[62:63]
    v_exp_f32 v48, -v48
    v_exp_f32 v49, -v49
    v_exp_f32 v50, -v50
    v_exp_f32 v51, -v51
    v_exp_f32 v56, -v56
    v_exp_f32 v57, -v57
    v_exp_f32 v58, -v58
    v_exp_f32 v59, -v59
    s_nop 0
    v_pk_add_f32 v[48:49], v[48:49], s[64:65]
    v_pk_add_f32 v[50:51], v[50:51], s[64:65]
    v_pk_add_f32 v[56:57], v[56:57], s[64:65]
    v_pk_add_f32 v[58:59], v[58:59], s[64:65]
    v_rcp_f32 v48, v48
    v_rcp_f32 v49, v49
    v_rcp_f32 v50, v50
    v_rcp_f32 v51, v51
    v_rcp_f32 v56, v56
    v_rcp_f32 v57, v57
    v_rcp_f32 v58, v58
    v_rcp_f32 v59, v59
    s_nop 0
    v_pk_mul_f32 v[48:49], v[48:49], v[176:177]
    v_pk_mul_f32 v[50:51], v[50:51], v[178:179]
    v_pk_mul_f32 v[56:57], v[56:57], v[180:181]
    v_pk_mul_f32 v[58:59], v[58:59], v[182:183]
    v_cvt_pk_bf16_f32 v52, v48, v49
    v_cvt_pk_bf16_f32 v53, v50, v51
    v_cvt_pk_bf16_f32 v60, v56, v57
    v_cvt_pk_bf16_f32 v61, v58, v59
    v_lshlrev_b32 v48, 16, v52
    v_and_b32 v49, 0xffff0000, v52
    v_lshlrev_b32 v50, 16, v53
    v_and_b32 v51, 0xffff0000, v53
    v_lshlrev_b32 v56, 16, v60
    v_and_b32 v57, 0xffff0000, v60
    v_lshlrev_b32 v58, 16, v61
    v_and_b32 v59, 0xffff0000, v61
    v_pk_mul_f32 v[48:49], v[48:49], v[184:185]
    v_pk_mul_f32 v[50:51], v[50:51], v[186:187]
    v_pk_mul_f32 v[56:57], v[56:57], v[188:189]
    v_pk_mul_f32 v[58:59], v[58:59], v[190:191]
    v_cvt_pk_bf16_f32 v176, v48, v49
    v_cvt_pk_bf16_f32 v177, v50, v51
    v_cvt_pk_bf16_f32 v178, v56, v57
    v_cvt_pk_bf16_f32 v179, v58, v59
    s_nop 0
    v_permlane16_swap_b32 v176, v178
    v_permlane16_swap_b32 v177, v179
    buffer_store_dwordx4 v[176:179], v4, s[24:27], 0 offen offset:512 sc1
    s_add_u32 s72, s71, 2
    s_cmp_ge_u32 s72, 86
    s_cbranch_scc1 k1_end
    v_cvt_pk_bf16_f32 v48, v192, v193
    v_cvt_pk_bf16_f32 v49, v194, v195
    v_cvt_pk_bf16_f32 v50, v200, v201
    v_cvt_pk_bf16_f32 v51, v202, v203
    v_cvt_pk_bf16_f32 v56, v196, v197
    v_cvt_pk_bf16_f32 v57, v198, v199
    v_cvt_pk_bf16_f32 v58, v204, v205
    v_cvt_pk_bf16_f32 v59, v206, v207
    v_lshlrev_b32 v192, 16, v48
    v_and_b32 v193, 0xffff0000, v48
    v_lshlrev_b32 v200, 16, v50
    v_and_b32 v201, 0xffff0000, v50
    v_lshlrev_b32 v194, 16, v49
    v_and_b32 v195, 0xffff0000, v49
    v_lshlrev_b32 v202, 16, v51
    v_and_b32 v203, 0xffff0000, v51
    v_lshlrev_b32 v196, 16, v56
    v_and_b32 v197, 0xffff0000, v56
    v_lshlrev_b32 v204, 16, v58
    v_and_b32 v205, 0xffff0000, v58
    v_lshlrev_b32 v198, 16, v57
    v_and_b32 v199, 0xffff0000, v57
    v_lshlrev_b32 v206, 16, v59
    v_and_b32 v207, 0xffff0000, v59
    v_pk_mul_f32 v[48:49], v[192:193], s[62:63]
    v_pk_mul_f32 v[50:51], v[194:195], s[62:63]
    v_pk_mul_f32 v[56:57], v[196:197], s[62:63]
    v_pk_mul_f32 v[58:59], v[198:199], s[62:63]
    v_exp_f32 v48, -v48
    v_exp_f32 v49, -v49
    v_exp_f32 v50, -v50
    v_exp_f32 v51, -v51
    v_exp_f32 v56, -v56
    v_exp_f32 v57, -v57
    v_exp_f32 v58, -v58
    v_exp_f32 v59, -v59
    s_nop 0
    v_pk_add_f32 v[48:49], v[48:49], s[64:65]
    v_pk_add_f32 v[50:51], v[50:51], s[64:65]
    v_pk_add_f32 v[56:57], v[56:57], s[64:65]
    v_pk_add_f32 v[58:59], v[58:59], s[64:65]
    v_rcp_f32 v48, v48
    v_rcp_f32 v49, v49
    v_rcp_f32 v50, v50
    v_rcp_f32 v51, v51
    v_rcp_f32 v56, v56
    v_rcp_f32 v57, v57
    v_rcp_f32 v58, v58
    v_rcp_f32 v59, v59
    s_nop 0
    v_pk_mul_f32 v[48:49], v[48:49], v[192:193]
    v_pk_mul_f32 v[50:51], v[50:51], v[194:195]
    v_pk_mul_f32 v[56:57], v[56:57], v[196:197]
    v_pk_mul_f32 v[58:59], v[58:59], v[198:199]
    v_cvt_pk_bf16_f32 v52, v48, v49
    v_cvt_pk_bf16_f32 v53, v50, v51
    v_cvt_pk_bf16_f32 v60, v56, v57
    v_cvt_pk_bf16_f32 v61, v58, v59
    v_lshlrev_b32 v48, 16, v52
    v_and_b32 v49, 0xffff0000, v52
    v_lshlrev_b32 v50, 16, v53
    v_and_b32 v51, 0xffff0000, v53
    v_lshlrev_b32 v56, 16, v60
    v_and_b32 v57, 0xffff0000, v60
    v_lshlrev_b32 v58, 16, v61
    v_and_b32 v59, 0xffff0000, v61
    v_pk_mul_f32 v[48:49], v[48:49], v[200:201]
    v_pk_mul_f32 v[50:51], v[50:51], v[202:203]
    v_pk_mul_f32 v[56:57], v[56:57], v[204:205]
    v_pk_mul_f32 v[58:59], v[58:59], v[206:207]
    v_cvt_pk_bf16_f32 v192, v48, v49
    v_cvt_pk_bf16_f32 v193, v50, v51
    v_cvt_pk_bf16_f32 v194, v56, v57
    v_cvt_pk_bf16_f32 v195, v58, v59
    s_nop 0
    v_permlane16_swap_b32 v192, v194
    v_permlane16_swap_b32 v193, v195
    buffer_store_dwordx4 v[192:195], v4, s[24:27], 0 offen offset:1024 sc1
    s_add_u32 s72, s71, 3
    s_cmp_ge_u32 s72, 86
    s_cbranch_scc1 k1_end
    v_cvt_pk_bf16_f32 v48, v208, v209
    v_cvt_pk_bf16_f32 v49, v210, v211
    v_cvt_pk_bf16_f32 v50, v216, v217
    v_cvt_pk_bf16_f32 v51, v218, v219
    v_cvt_pk_bf16_f32 v56, v212, v213
    v_cvt_pk_bf16_f32 v57, v214, v215
    v_cvt_pk_bf16_f32 v58, v220, v221
    v_cvt_pk_bf16_f32 v59, v222, v223
    v_lshlrev_b32 v208, 16, v48
    v_and_b32 v209, 0xffff0000, v48
    v_lshlrev_b32 v216, 16, v50
    v_and_b32 v217, 0xffff0000, v50
    v_lshlrev_b32 v210, 16, v49
    v_and_b32 v211, 0xffff0000, v49
    v_lshlrev_b32 v218, 16, v51
    v_and_b32 v219, 0xffff0000, v51
    v_lshlrev_b32 v212, 16, v56
    v_and_b32 v213, 0xffff0000, v56
    v_lshlrev_b32 v220, 16, v58
    v_and_b32 v221, 0xffff0000, v58
    v_lshlrev_b32 v214, 16, v57
    v_and_b32 v215, 0xffff0000, v57
    v_lshlrev_b32 v222, 16, v59
    v_and_b32 v223, 0xffff0000, v59
    v_pk_mul_f32 v[48:49], v[208:209], s[62:63]
    v_pk_mul_f32 v[50:51], v[210:211], s[62:63]
    v_pk_mul_f32 v[56:57], v[212:213], s[62:63]
    v_pk_mul_f32 v[58:59], v[214:215], s[62:63]
    v_exp_f32 v48, -v48
    v_exp_f32 v49, -v49
    v_exp_f32 v50, -v50
    v_exp_f32 v51, -v51
    v_exp_f32 v56, -v56
    v_exp_f32 v57, -v57
    v_exp_f32 v58, -v58
    v_exp_f32 v59, -v59
    s_nop 0
    v_pk_add_f32 v[48:49], v[48:49], s[64:65]
    v_pk_add_f32 v[50:51], v[50:51], s[64:65]
    v_pk_add_f32 v[56:57], v[56:57], s[64:65]
    v_pk_add_f32 v[58:59], v[58:59], s[64:65]
    v_rcp_f32 v48, v48
    v_rcp_f32 v49, v49
    v_rcp_f32 v50, v50
    v_rcp_f32 v51, v51
    v_rcp_f32 v56, v56
    v_rcp_f32 v57, v57
    v_rcp_f32 v58, v58
    v_rcp_f32 v59, v59
    s_nop 0
    v_pk_mul_f32 v[48:49], v[48:49], v[208:209]
    v_pk_mul_f32 v[50:51], v[50:51], v[210:211]
    v_pk_mul_f32 v[56:57], v[56:57], v[212:213]
    v_pk_mul_f32 v[58:59], v[58:59], v[214:215]
    v_cvt_pk_bf16_f32 v52, v48, v49
    v_cvt_pk_bf16_f32 v53, v50, v51
    v_cvt_pk_bf16_f32 v60, v56, v57
    v_cvt_pk_bf16_f32 v61, v58, v59
    v_lshlrev_b32 v48, 16, v52
    v_and_b32 v49, 0xffff0000, v52
    v_lshlrev_b32 v50, 16, v53
    v_and_b32 v51, 0xffff0000, v53
    v_lshlrev_b32 v56, 16, v60
    v_and_b32 v57, 0xffff0000, v60
    v_lshlrev_b32 v58, 16, v61
    v_and_b32 v59, 0xffff0000, v61
    v_pk_mul_f32 v[48:49], v[48:49], v[216:217]
    v_pk_mul_f32 v[50:51], v[50:51], v[218:219]
    v_pk_mul_f32 v[56:57], v[56:57], v[220:221]
    v_pk_mul_f32 v[58:59], v[58:59], v[222:223]
    v_cvt_pk_bf16_f32 v208, v48, v49
    v_cvt_pk_bf16_f32 v209, v50, v51
    v_cvt_pk_bf16_f32 v210, v56, v57
    v_cvt_pk_bf16_f32 v211, v58, v59
    s_nop 0
    v_permlane16_swap_b32 v208, v210
    v_permlane16_swap_b32 v209, v211
    buffer_store_dwordx4 v[208:211], v4, s[24:27], 0 offen offset:1536 sc1
    s_add_u32 s72, s71, 4
    s_cmp_ge_u32 s72, 86
    s_cbranch_scc1 k1_end
    v_cvt_pk_bf16_f32 v48, v224, v225
    v_cvt_pk_bf16_f32 v49, v226, v227
    v_cvt_pk_bf16_f32 v50, v232, v233
    v_cvt_pk_bf16_f32 v51, v234, v235
    v_cvt_pk_bf16_f32 v56, v228, v229
    v_cvt_pk_bf16_f32 v57, v230, v231
    v_cvt_pk_bf16_f32 v58, v236, v237
    v_cvt_pk_bf16_f32 v59, v238, v239
    v_lshlrev_b32 v224, 16, v48
    v_and_b32 v225, 0xffff0000, v48
    v_lshlrev_b32 v232, 16, v50
    v_and_b32 v233, 0xffff0000, v50
    v_lshlrev_b32 v226, 16, v49
    v_and_b32 v227, 0xffff0000, v49
    v_lshlrev_b32 v234, 16, v51
    v_and_b32 v235, 0xffff0000, v51
    v_lshlrev_b32 v228, 16, v56
    v_and_b32 v229, 0xffff0000, v56
    v_lshlrev_b32 v236, 16, v58
    v_and_b32 v237, 0xffff0000, v58
    v_lshlrev_b32 v230, 16, v57
    v_and_b32 v231, 0xffff0000, v57
    v_lshlrev_b32 v238, 16, v59
    v_and_b32 v239, 0xffff0000, v59
    v_pk_mul_f32 v[48:49], v[224:225], s[62:63]
    v_pk_mul_f32 v[50:51], v[226:227], s[62:63]
    v_pk_mul_f32 v[56:57], v[228:229], s[62:63]
    v_pk_mul_f32 v[58:59], v[230:231], s[62:63]
    v_exp_f32 v48, -v48
    v_exp_f32 v49, -v49
    v_exp_f32 v50, -v50
    v_exp_f32 v51, -v51
    v_exp_f32 v56, -v56
    v_exp_f32 v57, -v57
    v_exp_f32 v58, -v58
    v_exp_f32 v59, -v59
    s_nop 0
    v_pk_add_f32 v[48:49], v[48:49], s[64:65]
    v_pk_add_f32 v[50:51], v[50:51], s[64:65]
    v_pk_add_f32 v[56:57], v[56:57], s[64:65]
    v_pk_add_f32 v[58:59], v[58:59], s[64:65]
    v_rcp_f32 v48, v48
    v_rcp_f32 v49, v49
    v_rcp_f32 v50, v50
    v_rcp_f32 v51, v51
    v_rcp_f32 v56, v56
    v_rcp_f32 v57, v57
    v_rcp_f32 v58, v58
    v_rcp_f32 v59, v59
    s_nop 0
    v_pk_mul_f32 v[48:49], v[48:49], v[224:225]
    v_pk_mul_f32 v[50:51], v[50:51], v[226:227]
    v_pk_mul_f32 v[56:57], v[56:57], v[228:229]
    v_pk_mul_f32 v[58:59], v[58:59], v[230:231]
    v_cvt_pk_bf16_f32 v52, v48, v49
    v_cvt_pk_bf16_f32 v53, v50, v51
    v_cvt_pk_bf16_f32 v60, v56, v57
    v_cvt_pk_bf16_f32 v61, v58, v59
    v_lshlrev_b32 v48, 16, v52
    v_and_b32 v49, 0xffff0000, v52
    v_lshlrev_b32 v50, 16, v53
    v_and_b32 v51, 0xffff0000, v53
    v_lshlrev_b32 v56, 16, v60
    v_and_b32 v57, 0xffff0000, v60
    v_lshlrev_b32 v58, 16, v61
    v_and_b32 v59, 0xffff0000, v61
    v_pk_mul_f32 v[48:49], v[48:49], v[232:233]
    v_pk_mul_f32 v[50:51], v[50:51], v[234:235]
    v_pk_mul_f32 v[56:57], v[56:57], v[236:237]
    v_pk_mul_f32 v[58:59], v[58:59], v[238:239]
    v_cvt_pk_bf16_f32 v224, v48, v49
    v_cvt_pk_bf16_f32 v225, v50, v51
    v_cvt_pk_bf16_f32 v226, v56, v57
    v_cvt_pk_bf16_f32 v227, v58, v59
    s_nop 0
    v_permlane16_swap_b32 v224, v226
    v_permlane16_swap_b32 v225, v227
    buffer_store_dwordx4 v[224:227], v4, s[24:27], 0 offen offset:2048 sc1
    s_cmp_eq_u32 s70, 1
    s_cbranch_scc1 k1_end
    s_add_u32 s72, s71, 5
    s_cmp_ge_u32 s72, 86
    s_cbranch_scc1 k1_end
    v_cvt_pk_bf16_f32 v48, v240, v241
    v_cvt_pk_bf16_f32 v49, v242, v243
    v_cvt_pk_bf16_f32 v50, v248, v249
    v_cvt_pk_bf16_f32 v51, v250, v251
    v_cvt_pk_bf16_f32 v56, v244, v245
    v_cvt_pk_bf16_f32 v57, v246, v247
    v_cvt_pk_bf16_f32 v58, v252, v253
    v_cvt_pk_bf16_f32 v59, v254, v255
    v_lshlrev_b32 v240, 16, v48
    v_and_b32 v241, 0xffff0000, v48
    v_lshlrev_b32 v248, 16, v50
    v_and_b32 v249, 0xffff0000, v50
    v_lshlrev_b32 v242, 16, v49
    v_and_b32 v243, 0xffff0000, v49
    v_lshlrev_b32 v250, 16, v51
    v_and_b32 v251, 0xffff0000, v51
    v_lshlrev_b32 v244, 16, v56
    v_and_b32 v245, 0xffff0000, v56
    v_lshlrev_b32 v252, 16, v58
    v_and_b32 v253, 0xffff0000, v58
    v_lshlrev_b32 v246, 16, v57
    v_and_b32 v247, 0xffff0000, v57
    v_lshlrev_b32 v254, 16, v59
    v_and_b32 v255, 0xffff0000, v59
    v_pk_mul_f32 v[48:49], v[240:241], s[62:63]
    v_pk_mul_f32 v[50:51], v[242:243], s[62:63]
    v_pk_mul_f32 v[56:57], v[244:245], s[62:63]
    v_pk_mul_f32 v[58:59], v[246:247], s[62:63]
    v_exp_f32 v48, -v48
    v_exp_f32 v49, -v49
    v_exp_f32 v50, -v50
    v_exp_f32 v51, -v51
    v_exp_f32 v56, -v56
    v_exp_f32 v57, -v57
    v_exp_f32 v58, -v58
    v_exp_f32 v59, -v59
    s_nop 0
    v_pk_add_f32 v[48:49], v[48:49], s[64:65]
    v_pk_add_f32 v[50:51], v[50:51], s[64:65]
    v_pk_add_f32 v[56:57], v[56:57], s[64:65]
    v_pk_add_f32 v[58:59], v[58:59], s[64:65]
    v_rcp_f32 v48, v48
    v_rcp_f32 v49, v49
    v_rcp_f32 v50, v50
    v_rcp_f32 v51, v51
    v_rcp_f32 v56, v56
    v_rcp_f32 v57, v57
    v_rcp_f32 v58, v58
    v_rcp_f32 v59, v59
    s_nop 0
    v_pk_mul_f32 v[48:49], v[48:49], v[240:241]
    v_pk_mul_f32 v[50:51], v[50:51], v[242:243]
    v_pk_mul_f32 v[56:57], v[56:57], v[244:245]
    v_pk_mul_f32 v[58:59], v[58:59], v[246:247]
    v_cvt_pk_bf16_f32 v52, v48, v49
    v_cvt_pk_bf16_f32 v53, v50, v51
    v_cvt_pk_bf16_f32 v60, v56, v57
    v_cvt_pk_bf16_f32 v61, v58, v59
    v_lshlrev_b32 v48, 16, v52
    v_and_b32 v49, 0xffff0000, v52
    v_lshlrev_b32 v50, 16, v53
    v_and_b32 v51, 0xffff0000, v53
    v_lshlrev_b32 v56, 16, v60
    v_and_b32 v57, 0xffff0000, v60
    v_lshlrev_b32 v58, 16, v61
    v_and_b32 v59, 0xffff0000, v61
    v_pk_mul_f32 v[48:49], v[48:49], v[248:249]
    v_pk_mul_f32 v[50:51], v[50:51], v[250:251]
    v_pk_mul_f32 v[56:57], v[56:57], v[252:253]
    v_pk_mul_f32 v[58:59], v[58:59], v[254:255]
    v_cvt_pk_bf16_f32 v240, v48, v49
    v_cvt_pk_bf16_f32 v241, v50, v51
    v_cvt_pk_bf16_f32 v242, v56, v57
    v_cvt_pk_bf16_f32 v243, v58, v59
    s_nop 0
    v_permlane16_swap_b32 v240, v242
    v_permlane16_swap_b32 v241, v243
    buffer_store_dwordx4 v[240:243], v4, s[24:27], 0 offen offset:2560 sc1
k1_end:
    s_cmp_ge_u32 s2, 256
    s_cbranch_scc1 k1_end3
    s_cmp_ge_u32 s14, 6
    s_cbranch_scc1 k1_pfoe
    s_mov_b32 s36, s98
    s_and_b32 s37, s99, 0xffff
    s_mov_b32 s38, 1409024
    s_mov_b32 s39, 0x00020000
    s_mul_i32 s71, s15, 6
    s_add_u32 s71, s71, s14
    s_branch k1_pfde
k1_pfoe:
    s_mov_b32 s36, s96
    s_and_b32 s37, s97, 0xffff
    s_mov_b32 s38, 524288
    s_mov_b32 s39, 0x00020000
    s_lshl_b32 s71, s15, 1
    s_add_u32 s71, s71, s14
    s_sub_u32 s71, s71, 6
k1_pfde:
    s_lshl_b32 s71, s71, 13
    v_lshlrev_b32 v30, 7, v2
    buffer_load_dword v31, v30, s[36:39], s71 offen
k1_end3:
    s_endpgm
.p2align 8
.globl k3_kernel
.type k3_kernel,@function
k3_kernel:
    s_cmp_ge_u32 s2, 256
    s_cbranch_scc1 k3_end
    s_load_dwordx2 s[4:5], s[0:1], 0
    s_load_dwordx2 s[6:7], s[0:1], 24
    s_load_dwordx4 s[8:11], s[0:1], 56
    s_load_dwordx2 s[12:13], s[0:1], 80
    v_lshrrev_b32 v1, 6, v0
    v_and_b32 v2, 63, v0
    s_nop 0
    v_readfirstlane_b32 s14, v1
    s_and_b32 s3, s2, 7
    s_lshr_b32 s15, s2, 3
    s_lshr_b32 s62, s15, 3
    s_lshl_b32 s3, s3, 2
    s_add_u32 s62, s62, s3
    s_lshl_b32 s62, s62, 6
    s_and_b32 s63, s15, 7
    s_lshl_b32 s63, s63, 7
    s_mov_b32 s61, 0x3fb8aa3b
    s_waitcnt lgkmcnt(0)
    s_mov_b32 s16, s4
    s_and_b32 s17, s5, 0xffff
    s_mov_b32 s18, 2097152
    s_mov_b32 s19, 0x00020000
    s_mov_b32 s20, s6
    s_and_b32 s21, s7, 0xffff
    s_mov_b32 s22, 524288
    s_mov_b32 s23, 0x00020000
    s_mov_b32 s24, s12
    s_and_b32 s25, s13, 0xffff
    s_mov_b32 s26, 16777216
    s_mov_b32 s27, 0x00020000
    s_mov_b32 s28, s8
    s_and_b32 s29, s9, 0xffff
    s_mov_b32 s30, 1409024
    s_mov_b32 s31, 0x00020000
    s_mov_b32 s32, s10
    s_and_b32 s33, s11, 0xffff
    s_mov_b32 s34, 2097152
    s_mov_b32 s35, 0x00020000
    v_lshrrev_b32 v3, 3, v0
    v_add_u32 v3, s62, v3
    v_lshlrev_b32 v3, 10, v3
    v_and_b32 v4, 7, v0
    v_lshl_add_u32 v3, v4, 4, v3
    v_add_u32 v3, s63, v3
    buffer_load_dwordx4 v[12:15], v3, s[16:19], 0 offen
    v_lshrrev_b32 v8, 2, v2
    v_lshlrev_b32 v8, 7, v8
    v_and_b32 v9, 3, v2
    v_lshl_add_u32 v8, v9, 3, v8
    s_lshl_b32 s64, s14, 14
    v_add_u32 v8, s64, v8
    v_bfe_u32 v9, v2, 3, 2
    v_xor_b32 v10, 0, v9
    v_lshl_add_u32 v4, v10, 5, v8
    v_xor_b32 v10, 1, v9
    v_lshl_add_u32 v5, v10, 5, v8
    v_xor_b32 v10, 2, v9
    v_lshl_add_u32 v6, v10, 5, v8
    v_xor_b32 v10, 3, v9
    v_lshl_add_u32 v7, v10, 5, v8
    v_bfe_u32 v8, v2, 1, 2
    v_bfe_u32 v9, v2, 4, 2
    v_xor_b32 v8, v8, v9
    v_lshlrev_b32 v8, 5, v8
    v_and_b32 v9, 1, v2
    v_lshl_add_u32 v8, v9, 4, v8
    v_add_u32 v8, s63, v8
    s_cmp_lt_u32 s14, 4
    s_cbranch_scc1 k3_swave
    s_sub_u32 s69, s14, 4
    v_lshrrev_b32 v9, 5, v2
    v_lshlrev_b32 v9, 3, v9
    v_bfe_u32 v10, v2, 3, 2
    v_add_u32 v9, v9, v10
    v_lshl_add_u32 v8, v9, 10, v8
    s_mul_i32 s65, s69, 11
    v_lshlrev_b32 v9, 4, v2
    s_lshr_b32 s66, s62, 4
    s_mul_i32 s66, s66, 44032
    s_lshl_b32 s67, s65, 10
    s_add_u32 s66, s66, s67
    s_add_u32 s66, s66, 2097152
    v_add_u32 v160, s66, v9
    v_add_u32 v161, 44032, v160
    v_add_u32 v162, 88064, v160
    v_add_u32 v163, 132096, v160
    s_lshl_b32 s65, s65, 15
    s_movk_i32 s67, 0
    buffer_load_dwordx4 v[80:83], v160, s[24:27], s67 offen
    buffer_load_dwordx4 v[84:87], v161, s[24:27], s67 offen
    buffer_load_dwordx4 v[88:91], v162, s[24:27], s67 offen
    buffer_load_dwordx4 v[92:95], v163, s[24:27], s67 offen
    s_add_u32 m0, s64, 0
    s_add_u32 s66, s65, 0
    buffer_load_dwordx4 v8, s[28:31], s66 offen lds
    s_add_u32 m0, s64, 1024
    s_add_u32 s66, s65, 16384
    buffer_load_dwordx4 v8, s[28:31], s66 offen lds
    s_add_u32 m0, s64, 2048
    s_add_u32 s66, s65, 4096
    buffer_load_dwordx4 v8, s[28:31], s66 offen lds
    s_add_u32 m0, s64, 3072
    s_add_u32 s66, s65, 20480
    buffer_load_dwordx4 v8, s[28:31], s66 offen lds
    s_movk_i32 s67, 1024
    buffer_load_dwordx4 v[96:99], v160, s[24:27], s67 offen
    buffer_load_dwordx4 v[100:103], v161, s[24:27], s67 offen
    buffer_load_dwordx4 v[104:107], v162, s[24:27], s67 offen
    buffer_load_dwordx4 v[108:111], v163, s[24:27], s67 offen
    s_add_u32 m0, s64, 4096
    s_add_u32 s66, s65, 32768
    buffer_load_dwordx4 v8, s[28:31], s66 offen lds
    s_add_u32 m0, s64, 5120
    s_add_u32 s66, s65, 49152
    buffer_load_dwordx4 v8, s[28:31], s66 offen lds
    s_add_u32 m0, s64, 6144
    s_add_u32 s66, s65, 36864
    buffer_load_dwordx4 v8, s[28:31], s66 offen lds
    s_add_u32 m0, s64, 7168
    s_add_u32 s66, s65, 53248
    buffer_load_dwordx4 v8, s[28:31], s66 offen lds
    s_movk_i32 s67, 2048
    buffer_load_dwordx4 v[112:115], v160, s[24:27], s67 offen
    buffer_load_dwordx4 v[116:119], v161, s[24:27], s67 offen
    buffer_load_dwordx4 v[120:123], v162, s[24:27], s67 offen
    buffer_load_dwordx4 v[124:127], v163, s[24:27], s67 offen
    s_add_u32 m0, s64, 8192
    s_add_u32 s66, s65, 65536
    buffer_load_dwordx4 v8, s[28:31], s66 offen lds
    s_add_u32 m0, s64, 9216
    s_add_u32 s66, s65, 81920
    buffer_load_dwordx4 v8, s[28:31], s66 offen lds
    s_add_u32 m0, s64, 10240
    s_add_u32 s66, s65, 69632
    buffer_load_dwordx4 v8, s[28:31], s66 offen lds
    s_add_u32 m0, s64, 11264
    s_add_u32 s66, s65, 86016
    buffer_load_dwordx4 v8, s[28:31], s66 offen lds
    s_waitcnt vmcnt(16)
    ds_read_b64_tr_b16 v[144:145], v4 offset:0
    ds_read_b64_tr_b16 v[146:147], v4 offset:2048
    ds_read_b64_tr_b16 v[148:149], v5 offset:0
    ds_read_b64_tr_b16 v[150:151], v5 offset:2048
    ds_read_b64_tr_b16 v[152:153], v6 offset:0
    ds_read_b64_tr_b16 v[154:155], v6 offset:2048
    ds_read_b64_tr_b16 v[156:157], v7 offset:0
    ds_read_b64_tr_b16 v[158:159], v7 offset:2048
    s_movk_i32 s67, 3072
    buffer_load_dwordx4 v[128:131], v160, s[24:27], s67 offen
    buffer_load_dwordx4 v[132:135], v161, s[24:27], s67 offen
    buffer_load_dwordx4 v[136:139], v162, s[24:27], s67 offen
    buffer_load_dwordx4 v[140:143], v163, s[24:27], s67 offen
    s_add_u32 m0, s64, 12288
    s_add_u32 s66, s65, 98304
    buffer_load_dwordx4 v8, s[28:31], s66 offen lds
    s_add_u32 m0, s64, 13312
    s_add_u32 s66, s65, 114688
    buffer_load_dwordx4 v8, s[28:31], s66 offen lds
    s_add_u32 m0, s64, 14336
    s_add_u32 s66, s65, 102400
    buffer_load_dwordx4 v8, s[28:31], s66 offen lds
    s_add_u32 m0, s64, 15360
    s_add_u32 s66, s65, 118784
    buffer_load_dwordx4 v8, s[28:31], s66 offen lds
    s_waitcnt lgkmcnt(6)
    v_mfma_f32_16x16x32_bf16 v[16:19], v[144:147], v[80:83], 0
    v_mfma_f32_16x16x32_bf16 v[20:23], v[144:147], v[84:87], 0
    v_mfma_f32_16x16x32_bf16 v[24:27], v[144:147], v[88:91], 0
    v_mfma_f32_16x16x32_bf16 v[28:31], v[144:147], v[92:95], 0
    s_waitcnt lgkmcnt(4)
    v_mfma_f32_16x16x32_bf16 v[32:35], v[148:151], v[80:83], 0
    v_mfma_f32_16x16x32_bf16 v[36:39], v[148:151], v[84:87], 0
    v_mfma_f32_16x16x32_bf16 v[40:43], v[148:151], v[88:91], 0
    v_mfma_f32_16x16x32_bf16 v[44:47], v[148:151], v[92:95], 0
    s_waitcnt lgkmcnt(2)
    v_mfma_f32_16x16x32_bf16 v[48:51], v[152:155], v[80:83], 0
    v_mfma_f32_16x16x32_bf16 v[52:55], v[152:155], v[84:87], 0
    v_mfma_f32_16x16x32_bf16 v[56:59], v[152:155], v[88:91], 0
    v_mfma_f32_16x16x32_bf16 v[60:63], v[152:155], v[92:95], 0
    s_waitcnt lgkmcnt(0)
    v_mfma_f32_16x16x32_bf16 v[64:67], v[156:159], v[80:83], 0
    v_mfma_f32_16x16x32_bf16 v[68:71], v[156:159], v[84:87], 0
    v_mfma_f32_16x16x32_bf16 v[72:75], v[156:159], v[88:91], 0
    v_mfma_f32_16x16x32_bf16 v[76:79], v[156:159], v[92:95], 0
    s_waitcnt vmcnt(16)
    ds_read_b64_tr_b16 v[144:145], v4 offset:4096
    ds_read_b64_tr_b16 v[146:147], v4 offset:6144
    ds_read_b64_tr_b16 v[148:149], v5 offset:4096
    ds_read_b64_tr_b16 v[150:151], v5 offset:6144
    ds_read_b64_tr_b16 v[152:153], v6 offset:4096
    ds_read_b64_tr_b16 v[154:155], v6 offset:6144
    ds_read_b64_tr_b16 v[156:157], v7 offset:4096
    ds_read_b64_tr_b16 v[158:159], v7 offset:6144
    s_movk_i32 s67, 4096
    buffer_load_dwordx4 v[80:83], v160, s[24:27], s67 offen
    buffer_load_dwordx4 v[84:87], v161, s[24:27], s67 offen
    buffer_load_dwordx4 v[88:91], v162, s[24:27], s67 offen
    buffer_load_dwordx4 v[92:95], v163, s[24:27], s67 offen
    s_add_u32 m0, s64, 0
    s_add_u32 s66, s65, 131072
    buffer_load_dwordx4 v8, s[28:31], s66 offen lds
    s_add_u32 m0, s64, 1024
    s_add_u32 s66, s65, 147456
    buffer_load_dwordx4 v8, s[28:31], s66 offen lds
    s_add_u32 m0, s64, 2048
    s_add_u32 s66, s65, 135168
    buffer_load_dwordx4 v8, s[28:31], s66 offen lds
    s_add_u32 m0, s64, 3072
    s_add_u32 s66, s65, 151552
    buffer_load_dwordx4 v8, s[28:31], s66 offen lds
    s_waitcnt lgkmcnt(6)
    v_mfma_f32_16x16x32_bf16 v[16:19], v[144:147], v[96:99], v[16:19]
    v_mfma_f32_16x16x32_bf16 v[20:23], v[144:147], v[100:103], v[20:23]
    v_mfma_f32_16x16x32_bf16 v[24:27], v[144:147], v[104:107], v[24:27]
    v_mfma_f32_16x16x32_bf16 v[28:31], v[144:147], v[108:111], v[28:31]
    s_waitcnt lgkmcnt(4)
    v_mfma_f32_16x16x32_bf16 v[32:35], v[148:151], v[96:99], v[32:35]
    v_mfma_f32_16x16x32_bf16 v[36:39], v[148:151], v[100:103], v[36:39]
    v_mfma_f32_16x16x32_bf16 v[40:43], v[148:151], v[104:107], v[40:43]
    v_mfma_f32_16x16x32_bf16 v[44:47], v[148:151], v[108:111], v[44:47]
    s_waitcnt lgkmcnt(2)
    v_mfma_f32_16x16x32_bf16 v[48:51], v[152:155], v[96:99], v[48:51]
    v_mfma_f32_16x16x32_bf16 v[52:55], v[152:155], v[100:103], v[52:55]
    v_mfma_f32_16x16x32_bf16 v[56:59], v[152:155], v[104:107], v[56:59]
    v_mfma_f32_16x16x32_bf16 v[60:63], v[152:155], v[108:111], v[60:63]
    s_waitcnt lgkmcnt(0)
    v_mfma_f32_16x16x32_bf16 v[64:67], v[156:159], v[96:99], v[64:67]
    v_mfma_f32_16x16x32_bf16 v[68:71], v[156:159], v[100:103], v[68:71]
    v_mfma_f32_16x16x32_bf16 v[72:75], v[156:159], v[104:107], v[72:75]
    v_mfma_f32_16x16x32_bf16 v[76:79], v[156:159], v[108:111], v[76:79]
    s_waitcnt vmcnt(16)
    ds_read_b64_tr_b16 v[144:145], v4 offset:8192
    ds_read_b64_tr_b16 v[146:147], v4 offset:10240
    ds_read_b64_tr_b16 v[148:149], v5 offset:8192
    ds_read_b64_tr_b16 v[150:151], v5 offset:10240
    ds_read_b64_tr_b16 v[152:153], v6 offset:8192
    ds_read_b64_tr_b16 v[154:155], v6 offset:10240
    ds_read_b64_tr_b16 v[156:157], v7 offset:8192
    ds_read_b64_tr_b16 v[158:159], v7 offset:10240
    s_movk_i32 s67, 5120
    buffer_load_dwordx4 v[96:99], v160, s[24:27], s67 offen
    buffer_load_dwordx4 v[100:103], v161, s[24:27], s67 offen
    buffer_load_dwordx4 v[104:107], v162, s[24:27], s67 offen
    buffer_load_dwordx4 v[108:111], v163, s[24:27], s67 offen
    s_add_u32 m0, s64, 4096
    s_add_u32 s66, s65, 163840
    buffer_load_dwordx4 v8, s[28:31], s66 offen lds
    s_add_u32 m0, s64, 5120
    s_add_u32 s66, s65, 180224
    buffer_load_dwordx4 v8, s[28:31], s66 offen lds
    s_add_u32 m0, s64, 6144
    s_add_u32 s66, s65, 167936
    buffer_load_dwordx4 v8, s[28:31], s66 offen lds
    s_add_u32 m0, s64, 7168
    s_add_u32 s66, s65, 184320
    buffer_load_dwordx4 v8, s[28:31], s66 offen lds
    s_waitcnt lgkmcnt(6)
    v_mfma_f32_16x16x32_bf16 v[16:19], v[144:147], v[112:115], v[16:19]
    v_mfma_f32_16x16x32_bf16 v[20:23], v[144:147], v[116:119], v[20:23]
    v_mfma_f32_16x16x32_bf16 v[24:27], v[144:147], v[120:123], v[24:27]
    v_mfma_f32_16x16x32_bf16 v[28:31], v[144:147], v[124:127], v[28:31]
    s_waitcnt lgkmcnt(4)
    v_mfma_f32_16x16x32_bf16 v[32:35], v[148:151], v[112:115], v[32:35]
    v_mfma_f32_16x16x32_bf16 v[36:39], v[148:151], v[116:119], v[36:39]
    v_mfma_f32_16x16x32_bf16 v[40:43], v[148:151], v[120:123], v[40:43]
    v_mfma_f32_16x16x32_bf16 v[44:47], v[148:151], v[124:127], v[44:47]
    s_waitcnt lgkmcnt(2)
    v_mfma_f32_16x16x32_bf16 v[48:51], v[152:155], v[112:115], v[48:51]
    v_mfma_f32_16x16x32_bf16 v[52:55], v[152:155], v[116:119], v[52:55]
    v_mfma_f32_16x16x32_bf16 v[56:59], v[152:155], v[120:123], v[56:59]
    v_mfma_f32_16x16x32_bf16 v[60:63], v[152:155], v[124:127], v[60:63]
    s_waitcnt lgkmcnt(0)
    v_mfma_f32_16x16x32_bf16 v[64:67], v[156:159], v[112:115], v[64:67]
    v_mfma_f32_16x16x32_bf16 v[68:71], v[156:159], v[116:119], v[68:71]
    v_mfma_f32_16x16x32_bf16 v[72:75], v[156:159], v[120:123], v[72:75]
    v_mfma_f32_16x16x32_bf16 v[76:79], v[156:159], v[124:127], v[76:79]
    s_waitcnt vmcnt(16)
    ds_read_b64_tr_b16 v[144:145], v4 offset:12288
    ds_read_b64_tr_b16 v[146:147], v4 offset:14336
    ds_read_b64_tr_b16 v[148:149], v5 offset:12288
    ds_read_b64_tr_b16 v[150:151], v5 offset:14336
    ds_read_b64_tr_b16 v[152:153], v6 offset:12288
    ds_read_b64_tr_b16 v[154:155], v6 offset:14336
    ds_read_b64_tr_b16 v[156:157], v7 offset:12288
    ds_read_b64_tr_b16 v[158:159], v7 offset:14336
    s_movk_i32 s67, 6144
    buffer_load_dwordx4 v[112:115], v160, s[24:27], s67 offen
    buffer_load_dwordx4 v[116:119], v161, s[24:27], s67 offen
    buffer_load_dwordx4 v[120:123], v162, s[24:27], s67 offen
    buffer_load_dwordx4 v[124:127], v163, s[24:27], s67 offen
    s_add_u32 m0, s64, 8192
    s_add_u32 s66, s65, 196608
    buffer_load_dwordx4 v8, s[28:31], s66 offen lds
    s_add_u32 m0, s64, 9216
    s_add_u32 s66, s65, 212992
    buffer_load_dwordx4 v8, s[28:31], s66 offen lds
    s_add_u32 m0, s64, 10240
    s_add_u32 s66, s65, 200704
    buffer_load_dwordx4 v8, s[28:31], s66 offen lds
    s_add_u32 m0, s64, 11264
    s_add_u32 s66, s65, 217088
    buffer_load_dwordx4 v8, s[28:31], s66 offen lds
    s_waitcnt lgkmcnt(6)
    v_mfma_f32_16x16x32_bf16 v[16:19], v[144:147], v[128:131], v[16:19]
    v_mfma_f32_16x16x32_bf16 v[20:23], v[144:147], v[132:135], v[20:23]
    v_mfma_f32_16x16x32_bf16 v[24:27], v[144:147], v[136:139], v[24:27]
    v_mfma_f32_16x16x32_bf16 v[28:31], v[144:147], v[140:143], v[28:31]
    s_waitcnt lgkmcnt(4)
    v_mfma_f32_16x16x32_bf16 v[32:35], v[148:151], v[128:131], v[32:35]
    v_mfma_f32_16x16x32_bf16 v[36:39], v[148:151], v[132:135], v[36:39]
    v_mfma_f32_16x16x32_bf16 v[40:43], v[148:151], v[136:139], v[40:43]
    v_mfma_f32_16x16x32_bf16 v[44:47], v[148:151], v[140:143], v[44:47]
    s_waitcnt lgkmcnt(2)
    v_mfma_f32_16x16x32_bf16 v[48:51], v[152:155], v[128:131], v[48:51]
    v_mfma_f32_16x16x32_bf16 v[52:55], v[152:155], v[132:135], v[52:55]
    v_mfma_f32_16x16x32_bf16 v[56:59], v[152:155], v[136:139], v[56:59]
    v_mfma_f32_16x16x32_bf16 v[60:63], v[152:155], v[140:143], v[60:63]
    s_waitcnt lgkmcnt(0)
    v_mfma_f32_16x16x32_bf16 v[64:67], v[156:159], v[128:131], v[64:67]
    v_mfma_f32_16x16x32_bf16 v[68:71], v[156:159], v[132:135], v[68:71]
    v_mfma_f32_16x16x32_bf16 v[72:75], v[156:159], v[136:139], v[72:75]
    v_mfma_f32_16x16x32_bf16 v[76:79], v[156:159], v[140:143], v[76:79]
    s_waitcnt vmcnt(16)
    ds_read_b64_tr_b16 v[144:145], v4 offset:0
    ds_read_b64_tr_b16 v[146:147], v4 offset:2048
    ds_read_b64_tr_b16 v[148:149], v5 offset:0
    ds_read_b64_tr_b16 v[150:151], v5 offset:2048
    ds_read_b64_tr_b16 v[152:153], v6 offset:0
    ds_read_b64_tr_b16 v[154:155], v6 offset:2048
    ds_read_b64_tr_b16 v[156:157], v7 offset:0
    ds_read_b64_tr_b16 v[158:159], v7 offset:2048
    s_movk_i32 s67, 7168
    buffer_load_dwordx4 v[128:131], v160, s[24:27], s67 offen
    buffer_load_dwordx4 v[132:135], v161, s[24:27], s67 offen
    buffer_load_dwordx4 v[136:139], v162, s[24:27], s67 offen
    buffer_load_dwordx4 v[140:143], v163, s[24:27], s67 offen
    s_add_u32 m0, s64, 12288
    s_add_u32 s66, s65, 229376
    buffer_load_dwordx4 v8, s[28:31], s66 offen lds
    s_add_u32 m0, s64, 13312
    s_add_u32 s66, s65, 245760
    buffer_load_dwordx4 v8, s[28:31], s66 offen lds
    s_add_u32 m0, s64, 14336
    s_add_u32 s66, s65, 233472
    buffer_load_dwordx4 v8, s[28:31], s66 offen lds
    s_add_u32 m0, s64, 15360
    s_add_u32 s66, s65, 249856
    buffer_load_dwordx4 v8, s[28:31], s66 offen lds
    s_waitcnt lgkmcnt(6)
    v_mfma_f32_16x16x32_bf16 v[16:19], v[144:147], v[80:83], v[16:19]
    v_mfma_f32_16x16x32_bf16 v[20:23], v[144:147], v[84:87], v[20:23]
    v_mfma_f32_16x16x32_bf16 v[24:27], v[144:147], v[88:91], v[24:27]
    v_mfma_f32_16x16x32_bf16 v[28:31], v[144:147], v[92:95], v[28:31]
    s_waitcnt lgkmcnt(4)
    v_mfma_f32_16x16x32_bf16 v[32:35], v[148:151], v[80:83], v[32:35]
    v_mfma_f32_16x16x32_bf16 v[36:39], v[148:151], v[84:87], v[36:39]
    v_mfma_f32_16x16x32_bf16 v[40:43], v[148:151], v[88:91], v[40:43]
    v_mfma_f32_16x16x32_bf16 v[44:47], v[148:151], v[92:95], v[44:47]
    s_waitcnt lgkmcnt(2)
    v_mfma_f32_16x16x32_bf16 v[48:51], v[152:155], v[80:83], v[48:51]
    v_mfma_f32_16x16x32_bf16 v[52:55], v[152:155], v[84:87], v[52:55]
    v_mfma_f32_16x16x32_bf16 v[56:59], v[152:155], v[88:91], v[56:59]
    v_mfma_f32_16x16x32_bf16 v[60:63], v[152:155], v[92:95], v[60:63]
    s_waitcnt lgkmcnt(0)
    v_mfma_f32_16x16x32_bf16 v[64:67], v[156:159], v[80:83], v[64:67]
    v_mfma_f32_16x16x32_bf16 v[68:71], v[156:159], v[84:87], v[68:71]
    v_mfma_f32_16x16x32_bf16 v[72:75], v[156:159], v[88:91], v[72:75]
    v_mfma_f32_16x16x32_bf16 v[76:79], v[156:159], v[92:95], v[76:79]
    s_waitcnt vmcnt(16)
    ds_read_b64_tr_b16 v[144:145], v4 offset:4096
    ds_read_b64_tr_b16 v[146:147], v4 offset:6144
    ds_read_b64_tr_b16 v[148:149], v5 offset:4096
    ds_read_b64_tr_b16 v[150:151], v5 offset:6144
    ds_read_b64_tr_b16 v[152:153], v6 offset:4096
    ds_read_b64_tr_b16 v[154:155], v6 offset:6144
    ds_read_b64_tr_b16 v[156:157], v7 offset:4096
    ds_read_b64_tr_b16 v[158:159], v7 offset:6144
    s_movk_i32 s67, 8192
    buffer_load_dwordx4 v[80:83], v160, s[24:27], s67 offen
    buffer_load_dwordx4 v[84:87], v161, s[24:27], s67 offen
    buffer_load_dwordx4 v[88:91], v162, s[24:27], s67 offen
    buffer_load_dwordx4 v[92:95], v163, s[24:27], s67 offen
    s_add_u32 m0, s64, 0
    s_add_u32 s66, s65, 262144
    buffer_load_dwordx4 v8, s[28:31], s66 offen lds
    s_add_u32 m0, s64, 1024
    s_add_u32 s66, s65, 278528
    buffer_load_dwordx4 v8, s[28:31], s66 offen lds
    s_add_u32 m0, s64, 2048
    s_add_u32 s66, s65, 266240
    buffer_load_dwordx4 v8, s[28:31], s66 offen lds
    s_add_u32 m0, s64, 3072
    s_add_u32 s66, s65, 282624
    buffer_load_dwordx4 v8, s[28:31], s66 offen lds
    s_waitcnt lgkmcnt(6)
    v_mfma_f32_16x16x32_bf16 v[16:19], v[144:147], v[96:99], v[16:19]
    v_mfma_f32_16x16x32_bf16 v[20:23], v[144:147], v[100:103], v[20:23]
    v_mfma_f32_16x16x32_bf16 v[24:27], v[144:147], v[104:107], v[24:27]
    v_mfma_f32_16x16x32_bf16 v[28:31], v[144:147], v[108:111], v[28:31]
    s_waitcnt lgkmcnt(4)
    v_mfma_f32_16x16x32_bf16 v[32:35], v[148:151], v[96:99], v[32:35]
    v_mfma_f32_16x16x32_bf16 v[36:39], v[148:151], v[100:103], v[36:39]
    v_mfma_f32_16x16x32_bf16 v[40:43], v[148:151], v[104:107], v[40:43]
    v_mfma_f32_16x16x32_bf16 v[44:47], v[148:151], v[108:111], v[44:47]
    s_waitcnt lgkmcnt(2)
    v_mfma_f32_16x16x32_bf16 v[48:51], v[152:155], v[96:99], v[48:51]
    v_mfma_f32_16x16x32_bf16 v[52:55], v[152:155], v[100:103], v[52:55]
    v_mfma_f32_16x16x32_bf16 v[56:59], v[152:155], v[104:107], v[56:59]
    v_mfma_f32_16x16x32_bf16 v[60:63], v[152:155], v[108:111], v[60:63]
    s_waitcnt lgkmcnt(0)
    v_mfma_f32_16x16x32_bf16 v[64:67], v[156:159], v[96:99], v[64:67]
    v_mfma_f32_16x16x32_bf16 v[68:71], v[156:159], v[100:103], v[68:71]
    v_mfma_f32_16x16x32_bf16 v[72:75], v[156:159], v[104:107], v[72:75]
    v_mfma_f32_16x16x32_bf16 v[76:79], v[156:159], v[108:111], v[76:79]
    s_waitcnt vmcnt(16)
    ds_read_b64_tr_b16 v[144:145], v4 offset:8192
    ds_read_b64_tr_b16 v[146:147], v4 offset:10240
    ds_read_b64_tr_b16 v[148:149], v5 offset:8192
    ds_read_b64_tr_b16 v[150:151], v5 offset:10240
    ds_read_b64_tr_b16 v[152:153], v6 offset:8192
    ds_read_b64_tr_b16 v[154:155], v6 offset:10240
    ds_read_b64_tr_b16 v[156:157], v7 offset:8192
    ds_read_b64_tr_b16 v[158:159], v7 offset:10240
    s_movk_i32 s67, 9216
    buffer_load_dwordx4 v[96:99], v160, s[24:27], s67 offen
    buffer_load_dwordx4 v[100:103], v161, s[24:27], s67 offen
    buffer_load_dwordx4 v[104:107], v162, s[24:27], s67 offen
    buffer_load_dwordx4 v[108:111], v163, s[24:27], s67 offen
    s_add_u32 m0, s64, 4096
    s_add_u32 s66, s65, 294912
    buffer_load_dwordx4 v8, s[28:31], s66 offen lds
    s_add_u32 m0, s64, 5120
    s_add_u32 s66, s65, 311296
    buffer_load_dwordx4 v8, s[28:31], s66 offen lds
    s_add_u32 m0, s64, 6144
    s_add_u32 s66, s65, 299008
    buffer_load_dwordx4 v8, s[28:31], s66 offen lds
    s_add_u32 m0, s64, 7168
    s_add_u32 s66, s65, 315392
    buffer_load_dwordx4 v8, s[28:31], s66 offen lds
    s_waitcnt lgkmcnt(6)
    v_mfma_f32_16x16x32_bf16 v[16:19], v[144:147], v[112:115], v[16:19]
    v_mfma_f32_16x16x32_bf16 v[20:23], v[144:147], v[116:119], v[20:23]
    v_mfma_f32_16x16x32_bf16 v[24:27], v[144:147], v[120:123], v[24:27]
    v_mfma_f32_16x16x32_bf16 v[28:31], v[144:147], v[124:127], v[28:31]
    s_waitcnt lgkmcnt(4)
    v_mfma_f32_16x16x32_bf16 v[32:35], v[148:151], v[112:115], v[32:35]
    v_mfma_f32_16x16x32_bf16 v[36:39], v[148:151], v[116:119], v[36:39]
    v_mfma_f32_16x16x32_bf16 v[40:43], v[148:151], v[120:123], v[40:43]
    v_mfma_f32_16x16x32_bf16 v[44:47], v[148:151], v[124:127], v[44:47]
    s_waitcnt lgkmcnt(2)
    v_mfma_f32_16x16x32_bf16 v[48:51], v[152:155], v[112:115], v[48:51]
    v_mfma_f32_16x16x32_bf16 v[52:55], v[152:155], v[116:119], v[52:55]
    v_mfma_f32_16x16x32_bf16 v[56:59], v[152:155], v[120:123], v[56:59]
    v_mfma_f32_16x16x32_bf16 v[60:63], v[152:155], v[124:127], v[60:63]
    s_waitcnt lgkmcnt(0)
    v_mfma_f32_16x16x32_bf16 v[64:67], v[156:159], v[112:115], v[64:67]
    v_mfma_f32_16x16x32_bf16 v[68:71], v[156:159], v[116:119], v[68:71]
    v_mfma_f32_16x16x32_bf16 v[72:75], v[156:159], v[120:123], v[72:75]
    v_mfma_f32_16x16x32_bf16 v[76:79], v[156:159], v[124:127], v[76:79]
    s_waitcnt vmcnt(16)
    ds_read_b64_tr_b16 v[144:145], v4 offset:12288
    ds_read_b64_tr_b16 v[146:147], v4 offset:14336
    ds_read_b64_tr_b16 v[148:149], v5 offset:12288
    ds_read_b64_tr_b16 v[150:151], v5 offset:14336
    ds_read_b64_tr_b16 v[152:153], v6 offset:12288
    ds_read_b64_tr_b16 v[154:155], v6 offset:14336
    ds_read_b64_tr_b16 v[156:157], v7 offset:12288
    ds_read_b64_tr_b16 v[158:159], v7 offset:14336
    s_movk_i32 s67, 10240
    buffer_load_dwordx4 v[112:115], v160, s[24:27], s67 offen
    buffer_load_dwordx4 v[116:119], v161, s[24:27], s67 offen
    buffer_load_dwordx4 v[120:123], v162, s[24:27], s67 offen
    buffer_load_dwordx4 v[124:127], v163, s[24:27], s67 offen
    s_add_u32 m0, s64, 8192
    s_add_u32 s66, s65, 327680
    buffer_load_dwordx4 v8, s[28:31], s66 offen lds
    s_add_u32 m0, s64, 9216
    s_add_u32 s66, s65, 344064
    buffer_load_dwordx4 v8, s[28:31], s66 offen lds
    s_add_u32 m0, s64, 10240
    s_add_u32 s66, s65, 331776
    buffer_load_dwordx4 v8, s[28:31], s66 offen lds
    s_add_u32 m0, s64, 11264
    s_add_u32 s66, s65, 348160
    buffer_load_dwordx4 v8, s[28:31], s66 offen lds
    s_waitcnt lgkmcnt(6)
    v_mfma_f32_16x16x32_bf16 v[16:19], v[144:147], v[128:131], v[16:19]
    v_mfma_f32_16x16x32_bf16 v[20:23], v[144:147], v[132:135], v[20:23]
    v_mfma_f32_16x16x32_bf16 v[24:27], v[144:147], v[136:139], v[24:27]
    v_mfma_f32_16x16x32_bf16 v[28:31], v[144:147], v[140:143], v[28:31]
    s_waitcnt lgkmcnt(4)
    v_mfma_f32_16x16x32_bf16 v[32:35], v[148:151], v[128:131], v[32:35]
    v_mfma_f32_16x16x32_bf16 v[36:39], v[148:151], v[132:135], v[36:39]
    v_mfma_f32_16x16x32_bf16 v[40:43], v[148:151], v[136:139], v[40:43]
    v_mfma_f32_16x16x32_bf16 v[44:47], v[148:151], v[140:143], v[44:47]
    s_waitcnt lgkmcnt(2)
    v_mfma_f32_16x16x32_bf16 v[48:51], v[152:155], v[128:131], v[48:51]
    v_mfma_f32_16x16x32_bf16 v[52:55], v[152:155], v[132:135], v[52:55]
    v_mfma_f32_16x16x32_bf16 v[56:59], v[152:155], v[136:139], v[56:59]
    v_mfma_f32_16x16x32_bf16 v[60:63], v[152:155], v[140:143], v[60:63]
    s_waitcnt lgkmcnt(0)
    v_mfma_f32_16x16x32_bf16 v[64:67], v[156:159], v[128:131], v[64:67]
    v_mfma_f32_16x16x32_bf16 v[68:71], v[156:159], v[132:135], v[68:71]
    v_mfma_f32_16x16x32_bf16 v[72:75], v[156:159], v[136:139], v[72:75]
    v_mfma_f32_16x16x32_bf16 v[76:79], v[156:159], v[140:143], v[76:79]
    s_waitcnt vmcnt(16)
    ds_read_b64_tr_b16 v[144:145], v4 offset:0
    ds_read_b64_tr_b16 v[146:147], v4 offset:2048
    ds_read_b64_tr_b16 v[148:149], v5 offset:0
    ds_read_b64_tr_b16 v[150:151], v5 offset:2048
    ds_read_b64_tr_b16 v[152:153], v6 offset:0
    ds_read_b64_tr_b16 v[154:155], v6 offset:2048
    ds_read_b64_tr_b16 v[156:157], v7 offset:0
    ds_read_b64_tr_b16 v[158:159], v7 offset:2048
    s_waitcnt lgkmcnt(6)
    v_mfma_f32_16x16x32_bf16 v[16:19], v[144:147], v[80:83], v[16:19]
    v_mfma_f32_16x16x32_bf16 v[20:23], v[144:147], v[84:87], v[20:23]
    v_mfma_f32_16x16x32_bf16 v[24:27], v[144:147], v[88:91], v[24:27]
    v_mfma_f32_16x16x32_bf16 v[28:31], v[144:147], v[92:95], v[28:31]
    s_waitcnt lgkmcnt(4)
    v_mfma_f32_16x16x32_bf16 v[32:35], v[148:151], v[80:83], v[32:35]
    v_mfma_f32_16x16x32_bf16 v[36:39], v[148:151], v[84:87], v[36:39]
    v_mfma_f32_16x16x32_bf16 v[40:43], v[148:151], v[88:91], v[40:43]
    v_mfma_f32_16x16x32_bf16 v[44:47], v[148:151], v[92:95], v[44:47]
    s_waitcnt lgkmcnt(2)
    v_mfma_f32_16x16x32_bf16 v[48:51], v[152:155], v[80:83], v[48:51]
    v_mfma_f32_16x16x32_bf16 v[52:55], v[152:155], v[84:87], v[52:55]
    v_mfma_f32_16x16x32_bf16 v[56:59], v[152:155], v[88:91], v[56:59]
    v_mfma_f32_16x16x32_bf16 v[60:63], v[152:155], v[92:95], v[60:63]
    s_waitcnt lgkmcnt(0)
    v_mfma_f32_16x16x32_bf16 v[64:67], v[156:159], v[80:83], v[64:67]
    v_mfma_f32_16x16x32_bf16 v[68:71], v[156:159], v[84:87], v[68:71]
    v_mfma_f32_16x16x32_bf16 v[72:75], v[156:159], v[88:91], v[72:75]
    v_mfma_f32_16x16x32_bf16 v[76:79], v[156:159], v[92:95], v[76:79]
    s_waitcnt vmcnt(8)
    ds_read_b64_tr_b16 v[144:145], v4 offset:4096
    ds_read_b64_tr_b16 v[146:147], v4 offset:6144
    ds_read_b64_tr_b16 v[148:149], v5 offset:4096
    ds_read_b64_tr_b16 v[150:151], v5 offset:6144
    ds_read_b64_tr_b16 v[152:153], v6 offset:4096
    ds_read_b64_tr_b16 v[154:155], v6 offset:6144
    ds_read_b64_tr_b16 v[156:157], v7 offset:4096
    ds_read_b64_tr_b16 v[158:159], v7 offset:6144
    s_waitcnt lgkmcnt(6)
    v_mfma_f32_16x16x32_bf16 v[16:19], v[144:147], v[96:99], v[16:19]
    v_mfma_f32_16x16x32_bf16 v[20:23], v[144:147], v[100:103], v[20:23]
    v_mfma_f32_16x16x32_bf16 v[24:27], v[144:147], v[104:107], v[24:27]
    v_mfma_f32_16x16x32_bf16 v[28:31], v[144:147], v[108:111], v[28:31]
    s_waitcnt lgkmcnt(4)
    v_mfma_f32_16x16x32_bf16 v[32:35], v[148:151], v[96:99], v[32:35]
    v_mfma_f32_16x16x32_bf16 v[36:39], v[148:151], v[100:103], v[36:39]
    v_mfma_f32_16x16x32_bf16 v[40:43], v[148:151], v[104:107], v[40:43]
    v_mfma_f32_16x16x32_bf16 v[44:47], v[148:151], v[108:111], v[44:47]
    s_waitcnt lgkmcnt(2)
    v_mfma_f32_16x16x32_bf16 v[48:51], v[152:155], v[96:99], v[48:51]
    v_mfma_f32_16x16x32_bf16 v[52:55], v[152:155], v[100:103], v[52:55]
    v_mfma_f32_16x16x32_bf16 v[56:59], v[152:155], v[104:107], v[56:59]
    v_mfma_f32_16x16x32_bf16 v[60:63], v[152:155], v[108:111], v[60:63]
    s_waitcnt lgkmcnt(0)
    v_mfma_f32_16x16x32_bf16 v[64:67], v[156:159], v[96:99], v[64:67]
    v_mfma_f32_16x16x32_bf16 v[68:71], v[156:159], v[100:103], v[68:71]
    v_mfma_f32_16x16x32_bf16 v[72:75], v[156:159], v[104:107], v[72:75]
    v_mfma_f32_16x16x32_bf16 v[76:79], v[156:159], v[108:111], v[76:79]
    s_waitcnt vmcnt(0)
    s_cmp_eq_u32 s14, 7
    s_cbranch_scc1 k3_red
    ds_read_b64_tr_b16 v[144:145], v4 offset:8192
    ds_read_b64_tr_b16 v[146:147], v4 offset:10240
    ds_read_b64_tr_b16 v[148:149], v5 offset:8192
    ds_read_b64_tr_b16 v[150:151], v5 offset:10240
    ds_read_b64_tr_b16 v[152:153], v6 offset:8192
    ds_read_b64_tr_b16 v[154:155], v6 offset:10240
    ds_read_b64_tr_b16 v[156:157], v7 offset:8192
    ds_read_b64_tr_b16 v[158:159], v7 offset:10240
    s_waitcnt lgkmcnt(6)
    v_mfma_f32_16x16x32_bf16 v[16:19], v[144:147], v[112:115], v[16:19]
    v_mfma_f32_16x16x32_bf16 v[20:23], v[144:147], v[116:119], v[20:23]
    v_mfma_f32_16x16x32_bf16 v[24:27], v[144:147], v[120:123], v[24:27]
    v_mfma_f32_16x16x32_bf16 v[28:31], v[144:147], v[124:127], v[28:31]
    s_waitcnt lgkmcnt(4)
    v_mfma_f32_16x16x32_bf16 v[32:35], v[148:151], v[112:115], v[32:35]
    v_mfma_f32_16x16x32_bf16 v[36:39], v[148:151], v[116:119], v[36:39]
    v_mfma_f32_16x16x32_bf16 v[40:43], v[148:151], v[120:123], v[40:43]
    v_mfma_f32_16x16x32_bf16 v[44:47], v[148:151], v[124:127], v[44:47]
    s_waitcnt lgkmcnt(2)
    v_mfma_f32_16x16x32_bf16 v[48:51], v[152:155], v[112:115], v[48:51]
    v_mfma_f32_16x16x32_bf16 v[52:55], v[152:155], v[116:119], v[52:55]
    v_mfma_f32_16x16x32_bf16 v[56:59], v[152:155], v[120:123], v[56:59]
    v_mfma_f32_16x16x32_bf16 v[60:63], v[152:155], v[124:127], v[60:63]
    s_waitcnt lgkmcnt(0)
    v_mfma_f32_16x16x32_bf16 v[64:67], v[156:159], v[112:115], v[64:67]
    v_mfma_f32_16x16x32_bf16 v[68:71], v[156:159], v[116:119], v[68:71]
    v_mfma_f32_16x16x32_bf16 v[72:75], v[156:159], v[120:123], v[72:75]
    v_mfma_f32_16x16x32_bf16 v[76:79], v[156:159], v[124:127], v[76:79]
    s_branch k3_red
k3_swave:
    v_lshrrev_b32 v9, 3, v2
    v_lshl_add_u32 v8, v9, 10, v8
    s_mov_b32 s65, s14
    s_lshl_b32 s66, s65, 17
    s_lshl_b32 s67, s65, 10
    s_add_u32 m0, s67, 131072
    s_add_u32 s67, s67, 12648448
    v_lshlrev_b32 v9, 4, v2
    buffer_load_dwordx4 v9, s[24:27], s67 offen lds
    s_add_u32 m0, s64, 0
    s_add_u32 s67, s66, 0
    buffer_load_dwordx4 v8, s[20:23], s67 offen lds
    s_add_u32 m0, s64, 1024
    s_add_u32 s67, s66, 8192
    buffer_load_dwordx4 v8, s[20:23], s67 offen lds
    s_add_u32 m0, s64, 2048
    s_add_u32 s67, s66, 16384
    buffer_load_dwordx4 v8, s[20:23], s67 offen lds
    s_add_u32 m0, s64, 3072
    s_add_u32 s67, s66, 24576
    buffer_load_dwordx4 v8, s[20:23], s67 offen lds
    s_add_u32 m0, s64, 4096
    s_add_u32 s67, s66, 32768
    buffer_load_dwordx4 v8, s[20:23], s67 offen lds
    s_add_u32 m0, s64, 5120
    s_add_u32 s67, s66, 40960
    buffer_load_dwordx4 v8, s[20:23], s67 offen lds
    s_add_u32 m0, s64, 6144
    s_add_u32 s67, s66, 49152
    buffer_load_dwordx4 v8, s[20:23], s67 offen lds
    s_add_u32 m0, s64, 7168
    s_add_u32 s67, s66, 57344
    buffer_load_dwordx4 v8, s[20:23], s67 offen lds
    s_add_u32 m0, s64, 8192
    s_add_u32 s67, s66, 65536
    buffer_load_dwordx4 v8, s[20:23], s67 offen lds
    s_add_u32 m0, s64, 9216
    s_add_u32 s67, s66, 73728
    buffer_load_dwordx4 v8, s[20:23], s67 offen lds
    s_add_u32 m0, s64, 10240
    s_add_u32 s67, s66, 81920
    buffer_load_dwordx4 v8, s[20:23], s67 offen lds
    s_add_u32 m0, s64, 11264
    s_add_u32 s67, s66, 90112
    buffer_load_dwordx4 v8, s[20:23], s67 offen lds
    s_add_u32 m0, s64, 12288
    s_add_u32 s67, s66, 98304
    buffer_load_dwordx4 v8, s[20:23], s67 offen lds
    s_add_u32 m0, s64, 13312
    s_add_u32 s67, s66, 106496
    buffer_load_dwordx4 v8, s[20:23], s67 offen lds
    s_add_u32 m0, s64, 14336
    s_add_u32 s67, s66, 114688
    buffer_load_dwordx4 v8, s[20:23], s67 offen lds
    s_add_u32 m0, s64, 15360
    s_add_u32 s67, s66, 122880
    buffer_load_dwordx4 v8, s[20:23], s67 offen lds
    v_lshlrev_b32 v9, 4, v2
    v_lshrrev_b32 v10, 4, v2
    s_lshl_b32 s67, s65, 13
    s_lshl_b32 s68, s62, 11
    s_add_u32 s67, s67, s68
    s_add_u32 s67, s67, 8388608
    v_add_u32 v240, s67, v9
    v_add_u32 v241, 32768, v240
    v_add_u32 v242, 65536, v240
    v_add_u32 v243, 98304, v240
    v_and_b32 v9, 15, v2
    v_lshlrev_b32 v9, 7, v9
    v_lshl_add_u32 v9, v10, 5, v9
    s_lshl_b32 s67, s65, 14
    s_add_u32 s67, s67, 12582912
    v_add_u32 v244, s67, v9
    s_lshl_b32 s67, s65, 10
    s_add_u32 s67, s67, 131072
    v_lshlrev_b32 v9, 5, v10
    v_add_u32 v245, s67, v9
    s_movk_i32 s67, 0
    buffer_load_dwordx4 v[80:83], v240, s[24:27], s67 offen
    buffer_load_dwordx4 v[84:87], v241, s[24:27], s67 offen
    buffer_load_dwordx4 v[88:91], v242, s[24:27], s67 offen
    buffer_load_dwordx4 v[92:95], v243, s[24:27], s67 offen
    s_movk_i32 s67, 0
    buffer_load_dwordx4 v[96:99], v244, s[24:27], s67 offen offset:0
    buffer_load_dwordx4 v[100:103], v244, s[24:27], s67 offen offset:16
    s_movk_i32 s67, 1024
    buffer_load_dwordx4 v[112:115], v240, s[24:27], s67 offen
    buffer_load_dwordx4 v[116:119], v241, s[24:27], s67 offen
    buffer_load_dwordx4 v[120:123], v242, s[24:27], s67 offen
    buffer_load_dwordx4 v[124:127], v243, s[24:27], s67 offen
    s_movk_i32 s67, 2048
    buffer_load_dwordx4 v[128:131], v244, s[24:27], s67 offen offset:0
    buffer_load_dwordx4 v[132:135], v244, s[24:27], s67 offen offset:16
    s_movk_i32 s67, 2048
    buffer_load_dwordx4 v[144:147], v240, s[24:27], s67 offen
    buffer_load_dwordx4 v[148:151], v241, s[24:27], s67 offen
    buffer_load_dwordx4 v[152:155], v242, s[24:27], s67 offen
    buffer_load_dwordx4 v[156:159], v243, s[24:27], s67 offen
    s_movk_i32 s67, 4096
    buffer_load_dwordx4 v[160:163], v244, s[24:27], s67 offen offset:0
    buffer_load_dwordx4 v[164:167], v244, s[24:27], s67 offen offset:16
    s_movk_i32 s67, 3072
    buffer_load_dwordx4 v[176:179], v240, s[24:27], s67 offen
    buffer_load_dwordx4 v[180:183], v241, s[24:27], s67 offen
    buffer_load_dwordx4 v[184:187], v242, s[24:27], s67 offen
    buffer_load_dwordx4 v[188:191], v243, s[24:27], s67 offen
    s_movk_i32 s67, 6144
    buffer_load_dwordx4 v[192:195], v244, s[24:27], s67 offen offset:0
    buffer_load_dwordx4 v[196:199], v244, s[24:27], s67 offen offset:16
    s_waitcnt vmcnt(12)
    ds_read_b128 v[104:107], v245 offset:0
    ds_read_b128 v[108:111], v245 offset:16
    ds_read_b128 v[136:139], v245 offset:128
    ds_read_b128 v[140:143], v245 offset:144
    s_waitcnt lgkmcnt(0)
    v_cvt_pk_bf16_f32 v224, v96, v97
    v_cvt_pk_bf16_f32 v225, v98, v99
    v_cvt_pk_bf16_f32 v226, v100, v101
    v_cvt_pk_bf16_f32 v227, v102, v103
    v_cvt_pk_bf16_f32 v228, v104, v105
    v_cvt_pk_bf16_f32 v229, v106, v107
    v_cvt_pk_bf16_f32 v230, v108, v109
    v_cvt_pk_bf16_f32 v231, v110, v111
    v_cvt_pk_bf16_f32 v232, v128, v129
    v_cvt_pk_bf16_f32 v233, v130, v131
    v_cvt_pk_bf16_f32 v234, v132, v133
    v_cvt_pk_bf16_f32 v235, v134, v135
    v_cvt_pk_bf16_f32 v236, v136, v137
    v_cvt_pk_bf16_f32 v237, v138, v139
    v_cvt_pk_bf16_f32 v238, v140, v141
    v_cvt_pk_bf16_f32 v239, v142, v143
    s_nop 1
    v_mfma_f32_16x16x32_bf16 v[96:99], v[224:227], v[80:83], 0
    v_mfma_f32_16x16x32_bf16 v[128:131], v[228:231], v[80:83], 0
    v_mfma_f32_16x16x32_bf16 v[100:103], v[224:227], v[84:87], 0
    v_mfma_f32_16x16x32_bf16 v[132:135], v[228:231], v[84:87], 0
    v_mfma_f32_16x16x32_bf16 v[104:107], v[224:227], v[88:91], 0
    v_mfma_f32_16x16x32_bf16 v[136:139], v[228:231], v[88:91], 0
    v_mfma_f32_16x16x32_bf16 v[108:111], v[224:227], v[92:95], 0
    v_mfma_f32_16x16x32_bf16 v[140:143], v[228:231], v[92:95], 0
    s_nop 7
    v_cvt_pk_bf16_f32 v128, v128, v128
    v_cvt_pk_bf16_f32 v132, v132, v132
    v_cvt_pk_bf16_f32 v136, v136, v136
    v_cvt_pk_bf16_f32 v140, v140, v140
    v_cvt_pk_bf16_f32 v129, v96, v97
    v_cvt_pk_bf16_f32 v130, v98, v99
    v_cvt_pk_bf16_f32 v133, v100, v101
    v_cvt_pk_bf16_f32 v134, v102, v103
    v_cvt_pk_bf16_f32 v137, v104, v105
    v_cvt_pk_bf16_f32 v138, v106, v107
    v_cvt_pk_bf16_f32 v141, v108, v109
    v_cvt_pk_bf16_f32 v142, v110, v111
    v_lshlrev_b32 v128, 16, v128
    v_lshlrev_b32 v132, 16, v132
    v_lshlrev_b32 v136, 16, v136
    v_lshlrev_b32 v140, 16, v140
    v_add_f32 v128, 0x358637bd, v128
    v_add_f32 v132, 0x358637bd, v132
    v_add_f32 v136, 0x358637bd, v136
    v_add_f32 v140, 0x358637bd, v140
    v_cvt_pk_bf16_f32 v128, v128, v128
    v_cvt_pk_bf16_f32 v132, v132, v132
    v_cvt_pk_bf16_f32 v136, v136, v136
    v_cvt_pk_bf16_f32 v140, v140, v140
    v_lshlrev_b32 v128, 16, v128
    v_lshlrev_b32 v132, 16, v132
    v_lshlrev_b32 v136, 16, v136
    v_lshlrev_b32 v140, 16, v140
    v_rcp_f32 v128, v128
    v_rcp_f32 v132, v132
    v_rcp_f32 v136, v136
    v_rcp_f32 v140, v140
    v_lshlrev_b32 v96, 16, v129
    v_and_b32 v97, 0xffff0000, v129
    v_lshlrev_b32 v98, 16, v130
    v_and_b32 v99, 0xffff0000, v130
    v_lshlrev_b32 v100, 16, v133
    v_and_b32 v101, 0xffff0000, v133
    v_lshlrev_b32 v102, 16, v134
    v_and_b32 v103, 0xffff0000, v134
    v_lshlrev_b32 v104, 16, v137
    v_and_b32 v105, 0xffff0000, v137
    v_lshlrev_b32 v106, 16, v138
    v_and_b32 v107, 0xffff0000, v138
    v_lshlrev_b32 v108, 16, v141
    v_and_b32 v109, 0xffff0000, v141
    v_lshlrev_b32 v110, 16, v142
    v_and_b32 v111, 0xffff0000, v142
    v_mul_f32 v96, v96, v128
    v_mul_f32 v97, v97, v128
    v_mul_f32 v98, v98, v128
    v_mul_f32 v99, v99, v128
    v_mul_f32 v100, v100, v132
    v_mul_f32 v101, v101, v132
    v_mul_f32 v102, v102, v132
    v_mul_f32 v103, v103, v132
    v_mul_f32 v104, v104, v136
    v_mul_f32 v105, v105, v136
    v_mul_f32 v106, v106, v136
    v_mul_f32 v107, v107, v136
    v_mul_f32 v108, v108, v140
    v_mul_f32 v109, v109, v140
    v_mul_f32 v110, v110, v140
    v_mul_f32 v111, v111, v140
    v_cvt_pk_bf16_f32 v208, v96, v97
    v_cvt_pk_bf16_f32 v209, v98, v99
    v_cvt_pk_bf16_f32 v212, v100, v101
    v_cvt_pk_bf16_f32 v213, v102, v103
    v_cvt_pk_bf16_f32 v216, v104, v105
    v_cvt_pk_bf16_f32 v217, v106, v107
    v_cvt_pk_bf16_f32 v220, v108, v109
    v_cvt_pk_bf16_f32 v221, v110, v111
    v_mfma_f32_16x16x32_bf16 v[96:99], v[232:235], v[112:115], 0
    v_mfma_f32_16x16x32_bf16 v[128:131], v[236:239], v[112:115], 0
    v_mfma_f32_16x16x32_bf16 v[100:103], v[232:235], v[116:119], 0
    v_mfma_f32_16x16x32_bf16 v[132:135], v[236:239], v[116:119], 0
    v_mfma_f32_16x16x32_bf16 v[104:107], v[232:235], v[120:123], 0
    v_mfma_f32_16x16x32_bf16 v[136:139], v[236:239], v[120:123], 0
    v_mfma_f32_16x16x32_bf16 v[108:111], v[232:235], v[124:127], 0
    v_mfma_f32_16x16x32_bf16 v[140:143], v[236:239], v[124:127], 0
    s_nop 7
    v_cvt_pk_bf16_f32 v128, v128, v128
    v_cvt_pk_bf16_f32 v132, v132, v132
    v_cvt_pk_bf16_f32 v136, v136, v136
    v_cvt_pk_bf16_f32 v140, v140, v140
    v_cvt_pk_bf16_f32 v129, v96, v97
    v_cvt_pk_bf16_f32 v130, v98, v99
    v_cvt_pk_bf16_f32 v133, v100, v101
    v_cvt_pk_bf16_f32 v134, v102, v103
    v_cvt_pk_bf16_f32 v137, v104, v105
    v_cvt_pk_bf16_f32 v138, v106, v107
    v_cvt_pk_bf16_f32 v141, v108, v109
    v_cvt_pk_bf16_f32 v142, v110, v111
    v_lshlrev_b32 v128, 16, v128
    v_lshlrev_b32 v132, 16, v132
    v_lshlrev_b32 v136, 16, v136
    v_lshlrev_b32 v140, 16, v140
    v_add_f32 v128, 0x358637bd, v128
    v_add_f32 v132, 0x358637bd, v132
    v_add_f32 v136, 0x358637bd, v136
    v_add_f32 v140, 0x358637bd, v140
    v_cvt_pk_bf16_f32 v128, v128, v128
    v_cvt_pk_bf16_f32 v132, v132, v132
    v_cvt_pk_bf16_f32 v136, v136, v136
    v_cvt_pk_bf16_f32 v140, v140, v140
    v_lshlrev_b32 v128, 16, v128
    v_lshlrev_b32 v132, 16, v132
    v_lshlrev_b32 v136, 16, v136
    v_lshlrev_b32 v140, 16, v140
    v_rcp_f32 v128, v128
    v_rcp_f32 v132, v132
    v_rcp_f32 v136, v136
    v_rcp_f32 v140, v140
    v_lshlrev_b32 v96, 16, v129
    v_and_b32 v97, 0xffff0000, v129
    v_lshlrev_b32 v98, 16, v130
    v_and_b32 v99, 0xffff0000, v130
    v_lshlrev_b32 v100, 16, v133
    v_and_b32 v101, 0xffff0000, v133
    v_lshlrev_b32 v102, 16, v134
    v_and_b32 v103, 0xffff0000, v134
    v_lshlrev_b32 v104, 16, v137
    v_and_b32 v105, 0xffff0000, v137
    v_lshlrev_b32 v106, 16, v138
    v_and_b32 v107, 0xffff0000, v138
    v_lshlrev_b32 v108, 16, v141
    v_and_b32 v109, 0xffff0000, v141
    v_lshlrev_b32 v110, 16, v142
    v_and_b32 v111, 0xffff0000, v142
    v_mul_f32 v96, v96, v128
    v_mul_f32 v97, v97, v128
    v_mul_f32 v98, v98, v128
    v_mul_f32 v99, v99, v128
    v_mul_f32 v100, v100, v132
    v_mul_f32 v101, v101, v132
    v_mul_f32 v102, v102, v132
    v_mul_f32 v103, v103, v132
    v_mul_f32 v104, v104, v136
    v_mul_f32 v105, v105, v136
    v_mul_f32 v106, v106, v136
    v_mul_f32 v107, v107, v136
    v_mul_f32 v108, v108, v140
    v_mul_f32 v109, v109, v140
    v_mul_f32 v110, v110, v140
    v_mul_f32 v111, v111, v140
    v_cvt_pk_bf16_f32 v210, v96, v97
    v_cvt_pk_bf16_f32 v211, v98, v99
    v_cvt_pk_bf16_f32 v214, v100, v101
    v_cvt_pk_bf16_f32 v215, v102, v103
    v_cvt_pk_bf16_f32 v218, v104, v105
    v_cvt_pk_bf16_f32 v219, v106, v107
    v_cvt_pk_bf16_f32 v222, v108, v109
    v_cvt_pk_bf16_f32 v223, v110, v111
    s_movk_i32 s67, 4096
    buffer_load_dwordx4 v[80:83], v240, s[24:27], s67 offen
    buffer_load_dwordx4 v[84:87], v241, s[24:27], s67 offen
    buffer_load_dwordx4 v[88:91], v242, s[24:27], s67 offen
    buffer_load_dwordx4 v[92:95], v243, s[24:27], s67 offen
    s_movk_i32 s67, 8192
    buffer_load_dwordx4 v[96:99], v244, s[24:27], s67 offen offset:0
    buffer_load_dwordx4 v[100:103], v244, s[24:27], s67 offen offset:16
    s_movk_i32 s67, 5120
    buffer_load_dwordx4 v[112:115], v240, s[24:27], s67 offen
    buffer_load_dwordx4 v[116:119], v241, s[24:27], s67 offen
    buffer_load_dwordx4 v[120:123], v242, s[24:27], s67 offen
    buffer_load_dwordx4 v[124:127], v243, s[24:27], s67 offen
    s_movk_i32 s67, 10240
    buffer_load_dwordx4 v[128:131], v244, s[24:27], s67 offen offset:0
    buffer_load_dwordx4 v[132:135], v244, s[24:27], s67 offen offset:16
    ds_read_b64_tr_b16 v[224:225], v4 offset:0
    ds_read_b64_tr_b16 v[226:227], v4 offset:2048
    ds_read_b64_tr_b16 v[228:229], v5 offset:0
    ds_read_b64_tr_b16 v[230:231], v5 offset:2048
    ds_read_b64_tr_b16 v[232:233], v6 offset:0
    ds_read_b64_tr_b16 v[234:235], v6 offset:2048
    ds_read_b64_tr_b16 v[236:237], v7 offset:0
    ds_read_b64_tr_b16 v[238:239], v7 offset:2048
    s_waitcnt lgkmcnt(6)
    v_mfma_f32_16x16x32_bf16 v[16:19], v[224:227], v[208:211], 0
    v_mfma_f32_16x16x32_bf16 v[20:23], v[224:227], v[212:215], 0
    v_mfma_f32_16x16x32_bf16 v[24:27], v[224:227], v[216:219], 0
    v_mfma_f32_16x16x32_bf16 v[28:31], v[224:227], v[220:223], 0
    s_waitcnt lgkmcnt(4)
    v_mfma_f32_16x16x32_bf16 v[32:35], v[228:231], v[208:211], 0
    v_mfma_f32_16x16x32_bf16 v[36:39], v[228:231], v[212:215], 0
    v_mfma_f32_16x16x32_bf16 v[40:43], v[228:231], v[216:219], 0
    v_mfma_f32_16x16x32_bf16 v[44:47], v[228:231], v[220:223], 0
    s_waitcnt lgkmcnt(2)
    v_mfma_f32_16x16x32_bf16 v[48:51], v[232:235], v[208:211], 0
    v_mfma_f32_16x16x32_bf16 v[52:55], v[232:235], v[212:215], 0
    v_mfma_f32_16x16x32_bf16 v[56:59], v[232:235], v[216:219], 0
    v_mfma_f32_16x16x32_bf16 v[60:63], v[232:235], v[220:223], 0
    s_waitcnt lgkmcnt(0)
    v_mfma_f32_16x16x32_bf16 v[64:67], v[236:239], v[208:211], 0
    v_mfma_f32_16x16x32_bf16 v[68:71], v[236:239], v[212:215], 0
    v_mfma_f32_16x16x32_bf16 v[72:75], v[236:239], v[216:219], 0
    v_mfma_f32_16x16x32_bf16 v[76:79], v[236:239], v[220:223], 0
    s_waitcnt vmcnt(12)
    ds_read_b128 v[168:171], v245 offset:256
    ds_read_b128 v[172:175], v245 offset:272
    ds_read_b128 v[200:203], v245 offset:384
    ds_read_b128 v[204:207], v245 offset:400
    s_waitcnt lgkmcnt(0)
    v_cvt_pk_bf16_f32 v224, v160, v161
    v_cvt_pk_bf16_f32 v225, v162, v163
    v_cvt_pk_bf16_f32 v226, v164, v165
    v_cvt_pk_bf16_f32 v227, v166, v167
    v_cvt_pk_bf16_f32 v228, v168, v169
    v_cvt_pk_bf16_f32 v229, v170, v171
    v_cvt_pk_bf16_f32 v230, v172, v173
    v_cvt_pk_bf16_f32 v231, v174, v175
    v_cvt_pk_bf16_f32 v232, v192, v193
    v_cvt_pk_bf16_f32 v233, v194, v195
    v_cvt_pk_bf16_f32 v234, v196, v197
    v_cvt_pk_bf16_f32 v235, v198, v199
    v_cvt_pk_bf16_f32 v236, v200, v201
    v_cvt_pk_bf16_f32 v237, v202, v203
    v_cvt_pk_bf16_f32 v238, v204, v205
    v_cvt_pk_bf16_f32 v239, v206, v207
    s_nop 1
    v_mfma_f32_16x16x32_bf16 v[160:163], v[224:227], v[144:147], 0
    v_mfma_f32_16x16x32_bf16 v[192:195], v[228:231], v[144:147], 0
    v_mfma_f32_16x16x32_bf16 v[164:167], v[224:227], v[148:151], 0
    v_mfma_f32_16x16x32_bf16 v[196:199], v[228:231], v[148:151], 0
    v_mfma_f32_16x16x32_bf16 v[168:171], v[224:227], v[152:155], 0
    v_mfma_f32_16x16x32_bf16 v[200:203], v[228:231], v[152:155], 0
    v_mfma_f32_16x16x32_bf16 v[172:175], v[224:227], v[156:159], 0
    v_mfma_f32_16x16x32_bf16 v[204:207], v[228:231], v[156:159], 0
    s_nop 7
    v_cvt_pk_bf16_f32 v192, v192, v192
    v_cvt_pk_bf16_f32 v196, v196, v196
    v_cvt_pk_bf16_f32 v200, v200, v200
    v_cvt_pk_bf16_f32 v204, v204, v204
    v_cvt_pk_bf16_f32 v193, v160, v161
    v_cvt_pk_bf16_f32 v194, v162, v163
    v_cvt_pk_bf16_f32 v197, v164, v165
    v_cvt_pk_bf16_f32 v198, v166, v167
    v_cvt_pk_bf16_f32 v201, v168, v169
    v_cvt_pk_bf16_f32 v202, v170, v171
    v_cvt_pk_bf16_f32 v205, v172, v173
    v_cvt_pk_bf16_f32 v206, v174, v175
    v_lshlrev_b32 v192, 16, v192
    v_lshlrev_b32 v196, 16, v196
    v_lshlrev_b32 v200, 16, v200
    v_lshlrev_b32 v204, 16, v204
    v_add_f32 v192, 0x358637bd, v192
    v_add_f32 v196, 0x358637bd, v196
    v_add_f32 v200, 0x358637bd, v200
    v_add_f32 v204, 0x358637bd, v204
    v_cvt_pk_bf16_f32 v192, v192, v192
    v_cvt_pk_bf16_f32 v196, v196, v196
    v_cvt_pk_bf16_f32 v200, v200, v200
    v_cvt_pk_bf16_f32 v204, v204, v204
    v_lshlrev_b32 v192, 16, v192
    v_lshlrev_b32 v196, 16, v196
    v_lshlrev_b32 v200, 16, v200
    v_lshlrev_b32 v204, 16, v204
    v_rcp_f32 v192, v192
    v_rcp_f32 v196, v196
    v_rcp_f32 v200, v200
    v_rcp_f32 v204, v204
    v_lshlrev_b32 v160, 16, v193
    v_and_b32 v161, 0xffff0000, v193
    v_lshlrev_b32 v162, 16, v194
    v_and_b32 v163, 0xffff0000, v194
    v_lshlrev_b32 v164, 16, v197
    v_and_b32 v165, 0xffff0000, v197
    v_lshlrev_b32 v166, 16, v198
    v_and_b32 v167, 0xffff0000, v198
    v_lshlrev_b32 v168, 16, v201
    v_and_b32 v169, 0xffff0000, v201
    v_lshlrev_b32 v170, 16, v202
    v_and_b32 v171, 0xffff0000, v202
    v_lshlrev_b32 v172, 16, v205
    v_and_b32 v173, 0xffff0000, v205
    v_lshlrev_b32 v174, 16, v206
    v_and_b32 v175, 0xffff0000, v206
    v_mul_f32 v160, v160, v192
    v_mul_f32 v161, v161, v192
    v_mul_f32 v162, v162, v192
    v_mul_f32 v163, v163, v192
    v_mul_f32 v164, v164, v196
    v_mul_f32 v165, v165, v196
    v_mul_f32 v166, v166, v196
    v_mul_f32 v167, v167, v196
    v_mul_f32 v168, v168, v200
    v_mul_f32 v169, v169, v200
    v_mul_f32 v170, v170, v200
    v_mul_f32 v171, v171, v200
    v_mul_f32 v172, v172, v204
    v_mul_f32 v173, v173, v204
    v_mul_f32 v174, v174, v204
    v_mul_f32 v175, v175, v204
    v_cvt_pk_bf16_f32 v208, v160, v161
    v_cvt_pk_bf16_f32 v209, v162, v163
    v_cvt_pk_bf16_f32 v212, v164, v165
    v_cvt_pk_bf16_f32 v213, v166, v167
    v_cvt_pk_bf16_f32 v216, v168, v169
    v_cvt_pk_bf16_f32 v217, v170, v171
    v_cvt_pk_bf16_f32 v220, v172, v173
    v_cvt_pk_bf16_f32 v221, v174, v175
    v_mfma_f32_16x16x32_bf16 v[160:163], v[232:235], v[176:179], 0
    v_mfma_f32_16x16x32_bf16 v[192:195], v[236:239], v[176:179], 0
    v_mfma_f32_16x16x32_bf16 v[164:167], v[232:235], v[180:183], 0
    v_mfma_f32_16x16x32_bf16 v[196:199], v[236:239], v[180:183], 0
    v_mfma_f32_16x16x32_bf16 v[168:171], v[232:235], v[184:187], 0
    v_mfma_f32_16x16x32_bf16 v[200:203], v[236:239], v[184:187], 0
    v_mfma_f32_16x16x32_bf16 v[172:175], v[232:235], v[188:191], 0
    v_mfma_f32_16x16x32_bf16 v[204:207], v[236:239], v[188:191], 0
    s_nop 7
    v_cvt_pk_bf16_f32 v192, v192, v192
    v_cvt_pk_bf16_f32 v196, v196, v196
    v_cvt_pk_bf16_f32 v200, v200, v200
    v_cvt_pk_bf16_f32 v204, v204, v204
    v_cvt_pk_bf16_f32 v193, v160, v161
    v_cvt_pk_bf16_f32 v194, v162, v163
    v_cvt_pk_bf16_f32 v197, v164, v165
    v_cvt_pk_bf16_f32 v198, v166, v167
    v_cvt_pk_bf16_f32 v201, v168, v169
    v_cvt_pk_bf16_f32 v202, v170, v171
    v_cvt_pk_bf16_f32 v205, v172, v173
    v_cvt_pk_bf16_f32 v206, v174, v175
    v_lshlrev_b32 v192, 16, v192
    v_lshlrev_b32 v196, 16, v196
    v_lshlrev_b32 v200, 16, v200
    v_lshlrev_b32 v204, 16, v204
    v_add_f32 v192, 0x358637bd, v192
    v_add_f32 v196, 0x358637bd, v196
    v_add_f32 v200, 0x358637bd, v200
    v_add_f32 v204, 0x358637bd, v204
    v_cvt_pk_bf16_f32 v192, v192, v192
    v_cvt_pk_bf16_f32 v196, v196, v196
    v_cvt_pk_bf16_f32 v200, v200, v200
    v_cvt_pk_bf16_f32 v204, v204, v204
    v_lshlrev_b32 v192, 16, v192
    v_lshlrev_b32 v196, 16, v196
    v_lshlrev_b32 v200, 16, v200
    v_lshlrev_b32 v204, 16, v204
    v_rcp_f32 v192, v192
    v_rcp_f32 v196, v196
    v_rcp_f32 v200, v200
    v_rcp_f32 v204, v204
    v_lshlrev_b32 v160, 16, v193
    v_and_b32 v161, 0xffff0000, v193
    v_lshlrev_b32 v162, 16, v194
    v_and_b32 v163, 0xffff0000, v194
    v_lshlrev_b32 v164, 16, v197
    v_and_b32 v165, 0xffff0000, v197
    v_lshlrev_b32 v166, 16, v198
    v_and_b32 v167, 0xffff0000, v198
    v_lshlrev_b32 v168, 16, v201
    v_and_b32 v169, 0xffff0000, v201
    v_lshlrev_b32 v170, 16, v202
    v_and_b32 v171, 0xffff0000, v202
    v_lshlrev_b32 v172, 16, v205
    v_and_b32 v173, 0xffff0000, v205
    v_lshlrev_b32 v174, 16, v206
    v_and_b32 v175, 0xffff0000, v206
    v_mul_f32 v160, v160, v192
    v_mul_f32 v161, v161, v192
    v_mul_f32 v162, v162, v192
    v_mul_f32 v163, v163, v192
    v_mul_f32 v164, v164, v196
    v_mul_f32 v165, v165, v196
    v_mul_f32 v166, v166, v196
    v_mul_f32 v167, v167, v196
    v_mul_f32 v168, v168, v200
    v_mul_f32 v169, v169, v200
    v_mul_f32 v170, v170, v200
    v_mul_f32 v171, v171, v200
    v_mul_f32 v172, v172, v204
    v_mul_f32 v173, v173, v204
    v_mul_f32 v174, v174, v204
    v_mul_f32 v175, v175, v204
    v_cvt_pk_bf16_f32 v210, v160, v161
    v_cvt_pk_bf16_f32 v211, v162, v163
    v_cvt_pk_bf16_f32 v214, v164, v165
    v_cvt_pk_bf16_f32 v215, v166, v167
    v_cvt_pk_bf16_f32 v218, v168, v169
    v_cvt_pk_bf16_f32 v219, v170, v171
    v_cvt_pk_bf16_f32 v222, v172, v173
    v_cvt_pk_bf16_f32 v223, v174, v175
    s_movk_i32 s67, 6144
    buffer_load_dwordx4 v[144:147], v240, s[24:27], s67 offen
    buffer_load_dwordx4 v[148:151], v241, s[24:27], s67 offen
    buffer_load_dwordx4 v[152:155], v242, s[24:27], s67 offen
    buffer_load_dwordx4 v[156:159], v243, s[24:27], s67 offen
    s_movk_i32 s67, 12288
    buffer_load_dwordx4 v[160:163], v244, s[24:27], s67 offen offset:0
    buffer_load_dwordx4 v[164:167], v244, s[24:27], s67 offen offset:16
    s_movk_i32 s67, 7168
    buffer_load_dwordx4 v[176:179], v240, s[24:27], s67 offen
    buffer_load_dwordx4 v[180:183], v241, s[24:27], s67 offen
    buffer_load_dwordx4 v[184:187], v242, s[24:27], s67 offen
    buffer_load_dwordx4 v[188:191], v243, s[24:27], s67 offen
    s_movk_i32 s67, 14336
    buffer_load_dwordx4 v[192:195], v244, s[24:27], s67 offen offset:0
    buffer_load_dwordx4 v[196:199], v244, s[24:27], s67 offen offset:16
    ds_read_b64_tr_b16 v[224:225], v4 offset:4096
    ds_read_b64_tr_b16 v[226:227], v4 offset:6144
    ds_read_b64_tr_b16 v[228:229], v5 offset:4096
    ds_read_b64_tr_b16 v[230:231], v5 offset:6144
    ds_read_b64_tr_b16 v[232:233], v6 offset:4096
    ds_read_b64_tr_b16 v[234:235], v6 offset:6144
    ds_read_b64_tr_b16 v[236:237], v7 offset:4096
    ds_read_b64_tr_b16 v[238:239], v7 offset:6144
    s_waitcnt lgkmcnt(6)
    v_mfma_f32_16x16x32_bf16 v[16:19], v[224:227], v[208:211], v[16:19]
    v_mfma_f32_16x16x32_bf16 v[20:23], v[224:227], v[212:215], v[20:23]
    v_mfma_f32_16x16x32_bf16 v[24:27], v[224:227], v[216:219], v[24:27]
    v_mfma_f32_16x16x32_bf16 v[28:31], v[224:227], v[220:223], v[28:31]
    s_waitcnt lgkmcnt(4)
    v_mfma_f32_16x16x32_bf16 v[32:35], v[228:231], v[208:211], v[32:35]
    v_mfma_f32_16x16x32_bf16 v[36:39], v[228:231], v[212:215], v[36:39]
    v_mfma_f32_16x16x32_bf16 v[40:43], v[228:231], v[216:219], v[40:43]
    v_mfma_f32_16x16x32_bf16 v[44:47], v[228:231], v[220:223], v[44:47]
    s_waitcnt lgkmcnt(2)
    v_mfma_f32_16x16x32_bf16 v[48:51], v[232:235], v[208:211], v[48:51]
    v_mfma_f32_16x16x32_bf16 v[52:55], v[232:235], v[212:215], v[52:55]
    v_mfma_f32_16x16x32_bf16 v[56:59], v[232:235], v[216:219], v[56:59]
    v_mfma_f32_16x16x32_bf16 v[60:63], v[232:235], v[220:223], v[60:63]
    s_waitcnt lgkmcnt(0)
    v_mfma_f32_16x16x32_bf16 v[64:67], v[236:239], v[208:211], v[64:67]
    v_mfma_f32_16x16x32_bf16 v[68:71], v[236:239], v[212:215], v[68:71]
    v_mfma_f32_16x16x32_bf16 v[72:75], v[236:239], v[216:219], v[72:75]
    v_mfma_f32_16x16x32_bf16 v[76:79], v[236:239], v[220:223], v[76:79]
    s_waitcnt vmcnt(12)
    ds_read_b128 v[104:107], v245 offset:512
    ds_read_b128 v[108:111], v245 offset:528
    ds_read_b128 v[136:139], v245 offset:640
    ds_read_b128 v[140:143], v245 offset:656
    s_waitcnt lgkmcnt(0)
    v_cvt_pk_bf16_f32 v224, v96, v97
    v_cvt_pk_bf16_f32 v225, v98, v99
    v_cvt_pk_bf16_f32 v226, v100, v101
    v_cvt_pk_bf16_f32 v227, v102, v103
    v_cvt_pk_bf16_f32 v228, v104, v105
    v_cvt_pk_bf16_f32 v229, v106, v107
    v_cvt_pk_bf16_f32 v230, v108, v109
    v_cvt_pk_bf16_f32 v231, v110, v111
    v_cvt_pk_bf16_f32 v232, v128, v129
    v_cvt_pk_bf16_f32 v233, v130, v131
    v_cvt_pk_bf16_f32 v234, v132, v133
    v_cvt_pk_bf16_f32 v235, v134, v135
    v_cvt_pk_bf16_f32 v236, v136, v137
    v_cvt_pk_bf16_f32 v237, v138, v139
    v_cvt_pk_bf16_f32 v238, v140, v141
    v_cvt_pk_bf16_f32 v239, v142, v143
    s_nop 1
    v_mfma_f32_16x16x32_bf16 v[96:99], v[224:227], v[80:83], 0
    v_mfma_f32_16x16x32_bf16 v[128:131], v[228:231], v[80:83], 0
    v_mfma_f32_16x16x32_bf16 v[100:103], v[224:227], v[84:87], 0
    v_mfma_f32_16x16x32_bf16 v[132:135], v[228:231], v[84:87], 0
    v_mfma_f32_16x16x32_bf16 v[104:107], v[224:227], v[88:91], 0
    v_mfma_f32_16x16x32_bf16 v[136:139], v[228:231], v[88:91], 0
    v_mfma_f32_16x16x32_bf16 v[108:111], v[224:227], v[92:95], 0
    v_mfma_f32_16x16x32_bf16 v[140:143], v[228:231], v[92:95], 0
    s_nop 7
    v_cvt_pk_bf16_f32 v128, v128, v128
    v_cvt_pk_bf16_f32 v132, v132, v132
    v_cvt_pk_bf16_f32 v136, v136, v136
    v_cvt_pk_bf16_f32 v140, v140, v140
    v_cvt_pk_bf16_f32 v129, v96, v97
    v_cvt_pk_bf16_f32 v130, v98, v99
    v_cvt_pk_bf16_f32 v133, v100, v101
    v_cvt_pk_bf16_f32 v134, v102, v103
    v_cvt_pk_bf16_f32 v137, v104, v105
    v_cvt_pk_bf16_f32 v138, v106, v107
    v_cvt_pk_bf16_f32 v141, v108, v109
    v_cvt_pk_bf16_f32 v142, v110, v111
    v_lshlrev_b32 v128, 16, v128
    v_lshlrev_b32 v132, 16, v132
    v_lshlrev_b32 v136, 16, v136
    v_lshlrev_b32 v140, 16, v140
    v_add_f32 v128, 0x358637bd, v128
    v_add_f32 v132, 0x358637bd, v132
    v_add_f32 v136, 0x358637bd, v136
    v_add_f32 v140, 0x358637bd, v140
    v_cvt_pk_bf16_f32 v128, v128, v128
    v_cvt_pk_bf16_f32 v132, v132, v132
    v_cvt_pk_bf16_f32 v136, v136, v136
    v_cvt_pk_bf16_f32 v140, v140, v140
    v_lshlrev_b32 v128, 16, v128
    v_lshlrev_b32 v132, 16, v132
    v_lshlrev_b32 v136, 16, v136
    v_lshlrev_b32 v140, 16, v140
    v_rcp_f32 v128, v128
    v_rcp_f32 v132, v132
    v_rcp_f32 v136, v136
    v_rcp_f32 v140, v140
    v_lshlrev_b32 v96, 16, v129
    v_and_b32 v97, 0xffff0000, v129
    v_lshlrev_b32 v98, 16, v130
    v_and_b32 v99, 0xffff0000, v130
    v_lshlrev_b32 v100, 16, v133
    v_and_b32 v101, 0xffff0000, v133
    v_lshlrev_b32 v102, 16, v134
    v_and_b32 v103, 0xffff0000, v134
    v_lshlrev_b32 v104, 16, v137
    v_and_b32 v105, 0xffff0000, v137
    v_lshlrev_b32 v106, 16, v138
    v_and_b32 v107, 0xffff0000, v138
    v_lshlrev_b32 v108, 16, v141
    v_and_b32 v109, 0xffff0000, v141
    v_lshlrev_b32 v110, 16, v142
    v_and_b32 v111, 0xffff0000, v142
    v_mul_f32 v96, v96, v128
    v_mul_f32 v97, v97, v128
    v_mul_f32 v98, v98, v128
    v_mul_f32 v99, v99, v128
    v_mul_f32 v100, v100, v132
    v_mul_f32 v101, v101, v132
    v_mul_f32 v102, v102, v132
    v_mul_f32 v103, v103, v132
    v_mul_f32 v104, v104, v136
    v_mul_f32 v105, v105, v136
    v_mul_f32 v106, v106, v136
    v_mul_f32 v107, v107, v136
    v_mul_f32 v108, v108, v140
    v_mul_f32 v109, v109, v140
    v_mul_f32 v110, v110, v140
    v_mul_f32 v111, v111, v140
    v_cvt_pk_bf16_f32 v208, v96, v97
    v_cvt_pk_bf16_f32 v209, v98, v99
    v_cvt_pk_bf16_f32 v212, v100, v101
    v_cvt_pk_bf16_f32 v213, v102, v103
    v_cvt_pk_bf16_f32 v216, v104, v105
    v_cvt_pk_bf16_f32 v217, v106, v107
    v_cvt_pk_bf16_f32 v220, v108, v109
    v_cvt_pk_bf16_f32 v221, v110, v111
    v_mfma_f32_16x16x32_bf16 v[96:99], v[232:235], v[112:115], 0
    v_mfma_f32_16x16x32_bf16 v[128:131], v[236:239], v[112:115], 0
    v_mfma_f32_16x16x32_bf16 v[100:103], v[232:235], v[116:119], 0
    v_mfma_f32_16x16x32_bf16 v[132:135], v[236:239], v[116:119], 0
    v_mfma_f32_16x16x32_bf16 v[104:107], v[232:235], v[120:123], 0
    v_mfma_f32_16x16x32_bf16 v[136:139], v[236:239], v[120:123], 0
    v_mfma_f32_16x16x32_bf16 v[108:111], v[232:235], v[124:127], 0
    v_mfma_f32_16x16x32_bf16 v[140:143], v[236:239], v[124:127], 0
    s_nop 7
    v_cvt_pk_bf16_f32 v128, v128, v128
    v_cvt_pk_bf16_f32 v132, v132, v132
    v_cvt_pk_bf16_f32 v136, v136, v136
    v_cvt_pk_bf16_f32 v140, v140, v140
    v_cvt_pk_bf16_f32 v129, v96, v97
    v_cvt_pk_bf16_f32 v130, v98, v99
    v_cvt_pk_bf16_f32 v133, v100, v101
    v_cvt_pk_bf16_f32 v134, v102, v103
    v_cvt_pk_bf16_f32 v137, v104, v105
    v_cvt_pk_bf16_f32 v138, v106, v107
    v_cvt_pk_bf16_f32 v141, v108, v109
    v_cvt_pk_bf16_f32 v142, v110, v111
    v_lshlrev_b32 v128, 16, v128
    v_lshlrev_b32 v132, 16, v132
    v_lshlrev_b32 v136, 16, v136
    v_lshlrev_b32 v140, 16, v140
    v_add_f32 v128, 0x358637bd, v128
    v_add_f32 v132, 0x358637bd, v132
    v_add_f32 v136, 0x358637bd, v136
    v_add_f32 v140, 0x358637bd, v140
    v_cvt_pk_bf16_f32 v128, v128, v128
    v_cvt_pk_bf16_f32 v132, v132, v132
    v_cvt_pk_bf16_f32 v136, v136, v136
    v_cvt_pk_bf16_f32 v140, v140, v140
    v_lshlrev_b32 v128, 16, v128
    v_lshlrev_b32 v132, 16, v132
    v_lshlrev_b32 v136, 16, v136
    v_lshlrev_b32 v140, 16, v140
    v_rcp_f32 v128, v128
    v_rcp_f32 v132, v132
    v_rcp_f32 v136, v136
    v_rcp_f32 v140, v140
    v_lshlrev_b32 v96, 16, v129
    v_and_b32 v97, 0xffff0000, v129
    v_lshlrev_b32 v98, 16, v130
    v_and_b32 v99, 0xffff0000, v130
    v_lshlrev_b32 v100, 16, v133
    v_and_b32 v101, 0xffff0000, v133
    v_lshlrev_b32 v102, 16, v134
    v_and_b32 v103, 0xffff0000, v134
    v_lshlrev_b32 v104, 16, v137
    v_and_b32 v105, 0xffff0000, v137
    v_lshlrev_b32 v106, 16, v138
    v_and_b32 v107, 0xffff0000, v138
    v_lshlrev_b32 v108, 16, v141
    v_and_b32 v109, 0xffff0000, v141
    v_lshlrev_b32 v110, 16, v142
    v_and_b32 v111, 0xffff0000, v142
    v_mul_f32 v96, v96, v128
    v_mul_f32 v97, v97, v128
    v_mul_f32 v98, v98, v128
    v_mul_f32 v99, v99, v128
    v_mul_f32 v100, v100, v132
    v_mul_f32 v101, v101, v132
    v_mul_f32 v102, v102, v132
    v_mul_f32 v103, v103, v132
    v_mul_f32 v104, v104, v136
    v_mul_f32 v105, v105, v136
    v_mul_f32 v106, v106, v136
    v_mul_f32 v107, v107, v136
    v_mul_f32 v108, v108, v140
    v_mul_f32 v109, v109, v140
    v_mul_f32 v110, v110, v140
    v_mul_f32 v111, v111, v140
    v_cvt_pk_bf16_f32 v210, v96, v97
    v_cvt_pk_bf16_f32 v211, v98, v99
    v_cvt_pk_bf16_f32 v214, v100, v101
    v_cvt_pk_bf16_f32 v215, v102, v103
    v_cvt_pk_bf16_f32 v218, v104, v105
    v_cvt_pk_bf16_f32 v219, v106, v107
    v_cvt_pk_bf16_f32 v222, v108, v109
    v_cvt_pk_bf16_f32 v223, v110, v111
    ds_read_b64_tr_b16 v[224:225], v4 offset:8192
    ds_read_b64_tr_b16 v[226:227], v4 offset:10240
    ds_read_b64_tr_b16 v[228:229], v5 offset:8192
    ds_read_b64_tr_b16 v[230:231], v5 offset:10240
    ds_read_b64_tr_b16 v[232:233], v6 offset:8192
    ds_read_b64_tr_b16 v[234:235], v6 offset:10240
    ds_read_b64_tr_b16 v[236:237], v7 offset:8192
    ds_read_b64_tr_b16 v[238:239], v7 offset:10240
    s_waitcnt lgkmcnt(6)
    v_mfma_f32_16x16x32_bf16 v[16:19], v[224:227], v[208:211], v[16:19]
    v_mfma_f32_16x16x32_bf16 v[20:23], v[224:227], v[212:215], v[20:23]
    v_mfma_f32_16x16x32_bf16 v[24:27], v[224:227], v[216:219], v[24:27]
    v_mfma_f32_16x16x32_bf16 v[28:31], v[224:227], v[220:223], v[28:31]
    s_waitcnt lgkmcnt(4)
    v_mfma_f32_16x16x32_bf16 v[32:35], v[228:231], v[208:211], v[32:35]
    v_mfma_f32_16x16x32_bf16 v[36:39], v[228:231], v[212:215], v[36:39]
    v_mfma_f32_16x16x32_bf16 v[40:43], v[228:231], v[216:219], v[40:43]
    v_mfma_f32_16x16x32_bf16 v[44:47], v[228:231], v[220:223], v[44:47]
    s_waitcnt lgkmcnt(2)
    v_mfma_f32_16x16x32_bf16 v[48:51], v[232:235], v[208:211], v[48:51]
    v_mfma_f32_16x16x32_bf16 v[52:55], v[232:235], v[212:215], v[52:55]
    v_mfma_f32_16x16x32_bf16 v[56:59], v[232:235], v[216:219], v[56:59]
    v_mfma_f32_16x16x32_bf16 v[60:63], v[232:235], v[220:223], v[60:63]
    s_waitcnt lgkmcnt(0)
    v_mfma_f32_16x16x32_bf16 v[64:67], v[236:239], v[208:211], v[64:67]
    v_mfma_f32_16x16x32_bf16 v[68:71], v[236:239], v[212:215], v[68:71]
    v_mfma_f32_16x16x32_bf16 v[72:75], v[236:239], v[216:219], v[72:75]
    v_mfma_f32_16x16x32_bf16 v[76:79], v[236:239], v[220:223], v[76:79]
    s_waitcnt vmcnt(0)
    ds_read_b128 v[168:171], v245 offset:768
    ds_read_b128 v[172:175], v245 offset:784
    ds_read_b128 v[200:203], v245 offset:896
    ds_read_b128 v[204:207], v245 offset:912
    s_waitcnt lgkmcnt(0)
    v_cvt_pk_bf16_f32 v224, v160, v161
    v_cvt_pk_bf16_f32 v225, v162, v163
    v_cvt_pk_bf16_f32 v226, v164, v165
    v_cvt_pk_bf16_f32 v227, v166, v167
    v_cvt_pk_bf16_f32 v228, v168, v169
    v_cvt_pk_bf16_f32 v229, v170, v171
    v_cvt_pk_bf16_f32 v230, v172, v173
    v_cvt_pk_bf16_f32 v231, v174, v175
    v_cvt_pk_bf16_f32 v232, v192, v193
    v_cvt_pk_bf16_f32 v233, v194, v195
    v_cvt_pk_bf16_f32 v234, v196, v197
    v_cvt_pk_bf16_f32 v235, v198, v199
    v_cvt_pk_bf16_f32 v236, v200, v201
    v_cvt_pk_bf16_f32 v237, v202, v203
    v_cvt_pk_bf16_f32 v238, v204, v205
    v_cvt_pk_bf16_f32 v239, v206, v207
    s_nop 1
    v_mfma_f32_16x16x32_bf16 v[160:163], v[224:227], v[144:147], 0
    v_mfma_f32_16x16x32_bf16 v[192:195], v[228:231], v[144:147], 0
    v_mfma_f32_16x16x32_bf16 v[164:167], v[224:227], v[148:151], 0
    v_mfma_f32_16x16x32_bf16 v[196:199], v[228:231], v[148:151], 0
    v_mfma_f32_16x16x32_bf16 v[168:171], v[224:227], v[152:155], 0
    v_mfma_f32_16x16x32_bf16 v[200:203], v[228:231], v[152:155], 0
    v_mfma_f32_16x16x32_bf16 v[172:175], v[224:227], v[156:159], 0
    v_mfma_f32_16x16x32_bf16 v[204:207], v[228:231], v[156:159], 0
    s_nop 7
    v_cvt_pk_bf16_f32 v192, v192, v192
    v_cvt_pk_bf16_f32 v196, v196, v196
    v_cvt_pk_bf16_f32 v200, v200, v200
    v_cvt_pk_bf16_f32 v204, v204, v204
    v_cvt_pk_bf16_f32 v193, v160, v161
    v_cvt_pk_bf16_f32 v194, v162, v163
    v_cvt_pk_bf16_f32 v197, v164, v165
    v_cvt_pk_bf16_f32 v198, v166, v167
    v_cvt_pk_bf16_f32 v201, v168, v169
    v_cvt_pk_bf16_f32 v202, v170, v171
    v_cvt_pk_bf16_f32 v205, v172, v173
    v_cvt_pk_bf16_f32 v206, v174, v175
    v_lshlrev_b32 v192, 16, v192
    v_lshlrev_b32 v196, 16, v196
    v_lshlrev_b32 v200, 16, v200
    v_lshlrev_b32 v204, 16, v204
    v_add_f32 v192, 0x358637bd, v192
    v_add_f32 v196, 0x358637bd, v196
    v_add_f32 v200, 0x358637bd, v200
    v_add_f32 v204, 0x358637bd, v204
    v_cvt_pk_bf16_f32 v192, v192, v192
    v_cvt_pk_bf16_f32 v196, v196, v196
    v_cvt_pk_bf16_f32 v200, v200, v200
    v_cvt_pk_bf16_f32 v204, v204, v204
    v_lshlrev_b32 v192, 16, v192
    v_lshlrev_b32 v196, 16, v196
    v_lshlrev_b32 v200, 16, v200
    v_lshlrev_b32 v204, 16, v204
    v_rcp_f32 v192, v192
    v_rcp_f32 v196, v196
    v_rcp_f32 v200, v200
    v_rcp_f32 v204, v204
    v_lshlrev_b32 v160, 16, v193
    v_and_b32 v161, 0xffff0000, v193
    v_lshlrev_b32 v162, 16, v194
    v_and_b32 v163, 0xffff0000, v194
    v_lshlrev_b32 v164, 16, v197
    v_and_b32 v165, 0xffff0000, v197
    v_lshlrev_b32 v166, 16, v198
    v_and_b32 v167, 0xffff0000, v198
    v_lshlrev_b32 v168, 16, v201
    v_and_b32 v169, 0xffff0000, v201
    v_lshlrev_b32 v170, 16, v202
    v_and_b32 v171, 0xffff0000, v202
    v_lshlrev_b32 v172, 16, v205
    v_and_b32 v173, 0xffff0000, v205
    v_lshlrev_b32 v174, 16, v206
    v_and_b32 v175, 0xffff0000, v206
    v_mul_f32 v160, v160, v192
    v_mul_f32 v161, v161, v192
    v_mul_f32 v162, v162, v192
    v_mul_f32 v163, v163, v192
    v_mul_f32 v164, v164, v196
    v_mul_f32 v165, v165, v196
    v_mul_f32 v166, v166, v196
    v_mul_f32 v167, v167, v196
    v_mul_f32 v168, v168, v200
    v_mul_f32 v169, v169, v200
    v_mul_f32 v170, v170, v200
    v_mul_f32 v171, v171, v200
    v_mul_f32 v172, v172, v204
    v_mul_f32 v173, v173, v204
    v_mul_f32 v174, v174, v204
    v_mul_f32 v175, v175, v204
    v_cvt_pk_bf16_f32 v208, v160, v161
    v_cvt_pk_bf16_f32 v209, v162, v163
    v_cvt_pk_bf16_f32 v212, v164, v165
    v_cvt_pk_bf16_f32 v213, v166, v167
    v_cvt_pk_bf16_f32 v216, v168, v169
    v_cvt_pk_bf16_f32 v217, v170, v171
    v_cvt_pk_bf16_f32 v220, v172, v173
    v_cvt_pk_bf16_f32 v221, v174, v175
    v_mfma_f32_16x16x32_bf16 v[160:163], v[232:235], v[176:179], 0
    v_mfma_f32_16x16x32_bf16 v[192:195], v[236:239], v[176:179], 0
    v_mfma_f32_16x16x32_bf16 v[164:167], v[232:235], v[180:183], 0
    v_mfma_f32_16x16x32_bf16 v[196:199], v[236:239], v[180:183], 0
    v_mfma_f32_16x16x32_bf16 v[168:171], v[232:235], v[184:187], 0
    v_mfma_f32_16x16x32_bf16 v[200:203], v[236:239], v[184:187], 0
    v_mfma_f32_16x16x32_bf16 v[172:175], v[232:235], v[188:191], 0
    v_mfma_f32_16x16x32_bf16 v[204:207], v[236:239], v[188:191], 0
    s_nop 7
    v_cvt_pk_bf16_f32 v192, v192, v192
    v_cvt_pk_bf16_f32 v196, v196, v196
    v_cvt_pk_bf16_f32 v200, v200, v200
    v_cvt_pk_bf16_f32 v204, v204, v204
    v_cvt_pk_bf16_f32 v193, v160, v161
    v_cvt_pk_bf16_f32 v194, v162, v163
    v_cvt_pk_bf16_f32 v197, v164, v165
    v_cvt_pk_bf16_f32 v198, v166, v167
    v_cvt_pk_bf16_f32 v201, v168, v169
    v_cvt_pk_bf16_f32 v202, v170, v171
    v_cvt_pk_bf16_f32 v205, v172, v173
    v_cvt_pk_bf16_f32 v206, v174, v175
    v_lshlrev_b32 v192, 16, v192
    v_lshlrev_b32 v196, 16, v196
    v_lshlrev_b32 v200, 16, v200
    v_lshlrev_b32 v204, 16, v204
    v_add_f32 v192, 0x358637bd, v192
    v_add_f32 v196, 0x358637bd, v196
    v_add_f32 v200, 0x358637bd, v200
    v_add_f32 v204, 0x358637bd, v204
    v_cvt_pk_bf16_f32 v192, v192, v192
    v_cvt_pk_bf16_f32 v196, v196, v196
    v_cvt_pk_bf16_f32 v200, v200, v200
    v_cvt_pk_bf16_f32 v204, v204, v204
    v_lshlrev_b32 v192, 16, v192
    v_lshlrev_b32 v196, 16, v196
    v_lshlrev_b32 v200, 16, v200
    v_lshlrev_b32 v204, 16, v204
    v_rcp_f32 v192, v192
    v_rcp_f32 v196, v196
    v_rcp_f32 v200, v200
    v_rcp_f32 v204, v204
    v_lshlrev_b32 v160, 16, v193
    v_and_b32 v161, 0xffff0000, v193
    v_lshlrev_b32 v162, 16, v194
    v_and_b32 v163, 0xffff0000, v194
    v_lshlrev_b32 v164, 16, v197
    v_and_b32 v165, 0xffff0000, v197
    v_lshlrev_b32 v166, 16, v198
    v_and_b32 v167, 0xffff0000, v198
    v_lshlrev_b32 v168, 16, v201
    v_and_b32 v169, 0xffff0000, v201
    v_lshlrev_b32 v170, 16, v202
    v_and_b32 v171, 0xffff0000, v202
    v_lshlrev_b32 v172, 16, v205
    v_and_b32 v173, 0xffff0000, v205
    v_lshlrev_b32 v174, 16, v206
    v_and_b32 v175, 0xffff0000, v206
    v_mul_f32 v160, v160, v192
    v_mul_f32 v161, v161, v192
    v_mul_f32 v162, v162, v192
    v_mul_f32 v163, v163, v192
    v_mul_f32 v164, v164, v196
    v_mul_f32 v165, v165, v196
    v_mul_f32 v166, v166, v196
    v_mul_f32 v167, v167, v196
    v_mul_f32 v168, v168, v200
    v_mul_f32 v169, v169, v200
    v_mul_f32 v170, v170, v200
    v_mul_f32 v171, v171, v200
    v_mul_f32 v172, v172, v204
    v_mul_f32 v173, v173, v204
    v_mul_f32 v174, v174, v204
    v_mul_f32 v175, v175, v204
    v_cvt_pk_bf16_f32 v210, v160, v161
    v_cvt_pk_bf16_f32 v211, v162, v163
    v_cvt_pk_bf16_f32 v214, v164, v165
    v_cvt_pk_bf16_f32 v215, v166, v167
    v_cvt_pk_bf16_f32 v218, v168, v169
    v_cvt_pk_bf16_f32 v219, v170, v171
    v_cvt_pk_bf16_f32 v222, v172, v173
    v_cvt_pk_bf16_f32 v223, v174, v175
    ds_read_b64_tr_b16 v[224:225], v4 offset:12288
    ds_read_b64_tr_b16 v[226:227], v4 offset:14336
    ds_read_b64_tr_b16 v[228:229], v5 offset:12288
    ds_read_b64_tr_b16 v[230:231], v5 offset:14336
    ds_read_b64_tr_b16 v[232:233], v6 offset:12288
    ds_read_b64_tr_b16 v[234:235], v6 offset:14336
    ds_read_b64_tr_b16 v[236:237], v7 offset:12288
    ds_read_b64_tr_b16 v[238:239], v7 offset:14336
    s_waitcnt lgkmcnt(6)
    v_mfma_f32_16x16x32_bf16 v[16:19], v[224:227], v[208:211], v[16:19]
    v_mfma_f32_16x16x32_bf16 v[20:23], v[224:227], v[212:215], v[20:23]
    v_mfma_f32_16x16x32_bf16 v[24:27], v[224:227], v[216:219], v[24:27]
    v_mfma_f32_16x16x32_bf16 v[28:31], v[224:227], v[220:223], v[28:31]
    s_waitcnt lgkmcnt(4)
    v_mfma_f32_16x16x32_bf16 v[32:35], v[228:231], v[208:211], v[32:35]
    v_mfma_f32_16x16x32_bf16 v[36:39], v[228:231], v[212:215], v[36:39]
    v_mfma_f32_16x16x32_bf16 v[40:43], v[228:231], v[216:219], v[40:43]
    v_mfma_f32_16x16x32_bf16 v[44:47], v[228:231], v[220:223], v[44:47]
    s_waitcnt lgkmcnt(2)
    v_mfma_f32_16x16x32_bf16 v[48:51], v[232:235], v[208:211], v[48:51]
    v_mfma_f32_16x16x32_bf16 v[52:55], v[232:235], v[212:215], v[52:55]
    v_mfma_f32_16x16x32_bf16 v[56:59], v[232:235], v[216:219], v[56:59]
    v_mfma_f32_16x16x32_bf16 v[60:63], v[232:235], v[220:223], v[60:63]
    s_waitcnt lgkmcnt(0)
    v_mfma_f32_16x16x32_bf16 v[64:67], v[236:239], v[208:211], v[64:67]
    v_mfma_f32_16x16x32_bf16 v[68:71], v[236:239], v[212:215], v[68:71]
    v_mfma_f32_16x16x32_bf16 v[72:75], v[236:239], v[216:219], v[72:75]
    v_mfma_f32_16x16x32_bf16 v[76:79], v[236:239], v[220:223], v[76:79]
k3_red:
    s_nop 7
    v_and_b32 v8, 15, v2
    v_lshrrev_b32 v9, 4, v2
    v_and_b32 v10, 7, v2
    v_lshlrev_b32 v8, 8, v8
    v_add_u32 v8, s64, v8
    v_add_u32 v11, 0, v9
    v_xor_b32 v11, v11, v10
    v_lshl_add_u32 v4, v11, 4, v8
    v_add_u32 v11, 4, v9
    v_xor_b32 v11, v11, v10
    v_lshl_add_u32 v5, v11, 4, v8
    v_add_u32 v11, 8, v9
    v_xor_b32 v11, v11, v10
    v_lshl_add_u32 v6, v11, 4, v8
    v_add_u32 v11, 12, v9
    v_xor_b32 v11, v11, v10
    v_lshl_add_u32 v7, v11, 4, v8
    ds_write_b128 v4, v[16:19] offset:0
    ds_write_b128 v4, v[20:23] offset:4096
    ds_write_b128 v4, v[24:27] offset:8192
    ds_write_b128 v4, v[28:31] offset:12288
    ds_write_b128 v5, v[32:35] offset:0
    ds_write_b128 v5, v[36:39] offset:4096
    ds_write_b128 v5, v[40:43] offset:8192
    ds_write_b128 v5, v[44:47] offset:12288
    ds_write_b128 v6, v[48:51] offset:0
    ds_write_b128 v6, v[52:55] offset:4096
    ds_write_b128 v6, v[56:59] offset:8192
    ds_write_b128 v6, v[60:63] offset:12288
    ds_write_b128 v7, v[64:67] offset:0
    ds_write_b128 v7, v[68:71] offset:4096
    ds_write_b128 v7, v[72:75] offset:8192
    ds_write_b128 v7, v[76:79] offset:12288
    s_waitcnt lgkmcnt(0)
    s_barrier
    v_lshrrev_b32 v8, 3, v0
    v_and_b32 v10, 7, v8
    v_lshlrev_b32 v8, 8, v8
    v_and_b32 v9, 7, v0
    v_lshlrev_b32 v9, 1, v9
    v_xor_b32 v11, v9, v10
    v_lshl_add_u32 v4, v11, 4, v8
    v_add_u32 v9, 1, v9
    v_xor_b32 v11, v9, v10
    v_lshl_add_u32 v5, v11, 4, v8
    v_add_u32 v6, 65536, v4
    v_add_u32 v7, 65536, v5
    ds_read_b128 v[16:19], v6 offset:0
    ds_read_b128 v[20:23], v7 offset:0
    ds_read_b128 v[24:27], v6 offset:16384
    ds_read_b128 v[28:31], v7 offset:16384
    ds_read_b128 v[32:35], v6 offset:32768
    ds_read_b128 v[36:39], v7 offset:32768
    ds_read_b128 v[40:43], v6 offset:49152
    ds_read_b128 v[44:47], v7 offset:49152
    ds_read_b128 v[48:51], v4 offset:0
    ds_read_b128 v[52:55], v5 offset:0
    ds_read_b128 v[56:59], v4 offset:16384
    ds_read_b128 v[60:63], v5 offset:16384
    ds_read_b128 v[64:67], v4 offset:32768
    ds_read_b128 v[68:71], v5 offset:32768
    ds_read_b128 v[72:75], v4 offset:49152
    ds_read_b128 v[76:79], v5 offset:49152
    s_waitcnt lgkmcnt(0)
    v_add_f32 v16, v16, v24
    v_add_f32 v32, v32, v40
    v_add_f32 v48, v48, v56
    v_add_f32 v64, v64, v72
    v_add_f32 v17, v17, v25
    v_add_f32 v33, v33, v41
    v_add_f32 v49, v49, v57
    v_add_f32 v65, v65, v73
    v_add_f32 v18, v18, v26
    v_add_f32 v34, v34, v42
    v_add_f32 v50, v50, v58
    v_add_f32 v66, v66, v74
    v_add_f32 v19, v19, v27
    v_add_f32 v35, v35, v43
    v_add_f32 v51, v51, v59
    v_add_f32 v67, v67, v75
    v_add_f32 v20, v20, v28
    v_add_f32 v36, v36, v44
    v_add_f32 v52, v52, v60
    v_add_f32 v68, v68, v76
    v_add_f32 v21, v21, v29
    v_add_f32 v37, v37, v45
    v_add_f32 v53, v53, v61
    v_add_f32 v69, v69, v77
    v_add_f32 v22, v22, v30
    v_add_f32 v38, v38, v46
    v_add_f32 v54, v54, v62
    v_add_f32 v70, v70, v78
    v_add_f32 v23, v23, v31
    v_add_f32 v39, v39, v47
    v_add_f32 v55, v55, v63
    v_add_f32 v71, v71, v79
    v_add_f32 v16, v16, v32
    v_add_f32 v48, v48, v64
    v_add_f32 v17, v17, v33
    v_add_f32 v49, v49, v65
    v_add_f32 v18, v18, v34
    v_add_f32 v50, v50, v66
    v_add_f32 v19, v19, v35
    v_add_f32 v51, v51, v67
    v_add_f32 v20, v20, v36
    v_add_f32 v52, v52, v68
    v_add_f32 v21, v21, v37
    v_add_f32 v53, v53, v69
    v_add_f32 v22, v22, v38
    v_add_f32 v54, v54, v70
    v_add_f32 v23, v23, v39
    v_add_f32 v55, v55, v71
    v_cvt_pk_bf16_f32 v80, v16, v17
    v_lshlrev_b32 v16, 16, v80
    v_and_b32 v17, 0xffff0000, v80
    v_cvt_pk_bf16_f32 v80, v48, v49
    v_lshlrev_b32 v48, 16, v80
    v_and_b32 v49, 0xffff0000, v80
    v_cvt_pk_bf16_f32 v80, v18, v19
    v_lshlrev_b32 v18, 16, v80
    v_and_b32 v19, 0xffff0000, v80
    v_cvt_pk_bf16_f32 v80, v50, v51
    v_lshlrev_b32 v50, 16, v80
    v_and_b32 v51, 0xffff0000, v80
    v_cvt_pk_bf16_f32 v80, v20, v21
    v_lshlrev_b32 v20, 16, v80
    v_and_b32 v21, 0xffff0000, v80
    v_cvt_pk_bf16_f32 v80, v52, v53
    v_lshlrev_b32 v52, 16, v80
    v_and_b32 v53, 0xffff0000, v80
    v_cvt_pk_bf16_f32 v80, v22, v23
    v_lshlrev_b32 v22, 16, v80
    v_and_b32 v23, 0xffff0000, v80
    v_cvt_pk_bf16_f32 v80, v54, v55
    v_lshlrev_b32 v54, 16, v80
    v_and_b32 v55, 0xffff0000, v80
    v_mul_f32 v32, s61, v16
    v_mul_f32 v33, s61, v17
    v_mul_f32 v34, s61, v18
    v_mul_f32 v35, s61, v19
    v_mul_f32 v36, s61, v20
    v_mul_f32 v37, s61, v21
    v_mul_f32 v38, s61, v22
    v_mul_f32 v39, s61, v23
    v_exp_f32 v32, -v32
    v_exp_f32 v33, -v33
    v_exp_f32 v34, -v34
    v_exp_f32 v35, -v35
    v_exp_f32 v36, -v36
    v_exp_f32 v37, -v37
    v_exp_f32 v38, -v38
    v_exp_f32 v39, -v39
    s_nop 0
    v_add_f32 v32, 1.0, v32
    v_add_f32 v33, 1.0, v33
    v_add_f32 v34, 1.0, v34
    v_add_f32 v35, 1.0, v35
    v_add_f32 v36, 1.0, v36
    v_add_f32 v37, 1.0, v37
    v_add_f32 v38, 1.0, v38
    v_add_f32 v39, 1.0, v39
    v_rcp_f32 v32, v32
    v_rcp_f32 v33, v33
    v_rcp_f32 v34, v34
    v_rcp_f32 v35, v35
    v_rcp_f32 v36, v36
    v_rcp_f32 v37, v37
    v_rcp_f32 v38, v38
    v_rcp_f32 v39, v39
    s_nop 0
    v_mul_f32 v32, v32, v16
    v_mul_f32 v33, v33, v17
    v_mul_f32 v34, v34, v18
    v_mul_f32 v35, v35, v19
    v_mul_f32 v36, v36, v20
    v_mul_f32 v37, v37, v21
    v_mul_f32 v38, v38, v22
    v_mul_f32 v39, v39, v23
    v_cvt_pk_bf16_f32 v80, v32, v33
    v_lshlrev_b32 v32, 16, v80
    v_and_b32 v33, 0xffff0000, v80
    v_cvt_pk_bf16_f32 v80, v34, v35
    v_lshlrev_b32 v34, 16, v80
    v_and_b32 v35, 0xffff0000, v80
    v_cvt_pk_bf16_f32 v80, v36, v37
    v_lshlrev_b32 v36, 16, v80
    v_and_b32 v37, 0xffff0000, v80
    v_cvt_pk_bf16_f32 v80, v38, v39
    v_lshlrev_b32 v38, 16, v80
    v_and_b32 v39, 0xffff0000, v80
    v_mul_f32 v32, v32, v48
    v_mul_f32 v33, v33, v49
    v_mul_f32 v34, v34, v50
    v_mul_f32 v35, v35, v51
    v_mul_f32 v36, v36, v52
    v_mul_f32 v37, v37, v53
    v_mul_f32 v38, v38, v54
    v_mul_f32 v39, v39, v55
    v_cvt_pk_bf16_f32 v80, v32, v33
    v_lshlrev_b32 v32, 16, v80
    v_and_b32 v33, 0xffff0000, v80
    v_cvt_pk_bf16_f32 v80, v34, v35
    v_lshlrev_b32 v34, 16, v80
    v_and_b32 v35, 0xffff0000, v80
    v_cvt_pk_bf16_f32 v80, v36, v37
    v_lshlrev_b32 v36, 16, v80
    v_and_b32 v37, 0xffff0000, v80
    v_cvt_pk_bf16_f32 v80, v38, v39
    v_lshlrev_b32 v38, 16, v80
    v_and_b32 v39, 0xffff0000, v80
    s_waitcnt vmcnt(0)
    v_lshlrev_b32 v64, 16, v12
    v_and_b32 v65, 0xffff0000, v12
    v_lshlrev_b32 v66, 16, v13
    v_and_b32 v67, 0xffff0000, v13
    v_lshlrev_b32 v68, 16, v14
    v_and_b32 v69, 0xffff0000, v14
    v_lshlrev_b32 v70, 16, v15
    v_and_b32 v71, 0xffff0000, v15
    v_add_f32 v32, v32, v64
    v_add_f32 v33, v33, v65
    v_add_f32 v34, v34, v66
    v_add_f32 v35, v35, v67
    v_add_f32 v36, v36, v68
    v_add_f32 v37, v37, v69
    v_add_f32 v38, v38, v70
    v_add_f32 v39, v39, v71
    v_cvt_pk_bf16_f32 v12, v32, v33
    v_cvt_pk_bf16_f32 v13, v34, v35
    v_cvt_pk_bf16_f32 v14, v36, v37
    v_cvt_pk_bf16_f32 v15, v38, v39
    buffer_store_dwordx4 v[12:15], v3, s[32:35], 0 offen sc1
k3_end:
    s_endpgm
.section .rodata,"a"
.p2align 6
.amdhsa_kernel k0_kernel
  .amdhsa_next_free_vgpr 136
  .amdhsa_next_free_sgpr 100
  .amdhsa_accum_offset 136
  .amdhsa_group_segment_fixed_size 0
  .amdhsa_kernarg_size 88
  .amdhsa_user_sgpr_count 2
  .amdhsa_user_sgpr_kernarg_segment_ptr 1
  .amdhsa_system_sgpr_workgroup_id_x 1
.end_amdhsa_kernel
.p2align 6
.amdhsa_kernel k1_kernel
  .amdhsa_next_free_vgpr 256
  .amdhsa_next_free_sgpr 100
  .amdhsa_accum_offset 256
  .amdhsa_group_segment_fixed_size 0
  .amdhsa_kernarg_size 88
  .amdhsa_user_sgpr_count 2
  .amdhsa_user_sgpr_kernarg_segment_ptr 1
  .amdhsa_system_sgpr_workgroup_id_x 1
.end_amdhsa_kernel
.p2align 6
.amdhsa_kernel k3_kernel
  .amdhsa_next_free_vgpr 256
  .amdhsa_next_free_sgpr 100
  .amdhsa_accum_offset 256
  .amdhsa_group_segment_fixed_size 0
  .amdhsa_kernarg_size 88
  .amdhsa_user_sgpr_count 2
  .amdhsa_user_sgpr_kernarg_segment_ptr 1
  .amdhsa_system_sgpr_workgroup_id_x 1
.end_amdhsa_kernel
```
